```python
import torch

def _softmax(x, axis=-1):
    return torch.softmax(x, dim=axis)
def _gelu(x):
    return torch.nn.functional.gelu(x, approximate="tanh")
def _silu(x):
    return torch.nn.functional.silu(x)
def _sigmoid(x):
    return torch.sigmoid(x)
def _layernorm(x, axis=-1, eps=1e-5):
    m = x.mean(dim=axis, keepdim=True)
    v = x.var(dim=axis, keepdim=True, unbiased=False)
    return (x - m) / torch.sqrt(v + eps)
def _scatter_add(tgt, idx, src, axis=0):
    return tgt.clone().index_add_(axis, idx, src)
def _segment_sum(src, seg, n):
    out = torch.zeros((n,) + src.shape[1:], dtype=src.dtype)
    return out.index_add_(0, seg, src)
def _pad(x, pw):
    flat = tuple(v for pair in reversed(pw) for v in pair)
    return torch.nn.functional.pad(x, flat)

kernel_name = 'parallel_sum__sliding_block__dense_activation_gelu__prompt'

def setup_inputs():

    _w = (lambda a: (lambda t: t.to(torch.bfloat16) if t.is_floating_point() else t)(torch.as_tensor(a)))
    def _A_setup():
        B, S, D = 1, 2048, 1024
        return {
            "x": _w((lambda *s: torch.randn(*s, dtype=torch.bfloat16) * 0.05)(B, S, D)),
            "wqkv": _w((lambda *s: torch.randn(*s, dtype=torch.bfloat16) * 0.05)(D, 3 * D)),
            "wo": _w((lambda *s: torch.randn(*s, dtype=torch.bfloat16) * 0.05)(D, D)),
        }
    _A_in = _A_setup()

    def _B_setup():
        B, S, D, F = 1, 2048, 1024, 3584
        return {
            "x": _w((lambda *s: torch.randn(*s, dtype=torch.bfloat16) * 0.05)(B, S, D)),
            "w1": _w((lambda *s: torch.randn(*s, dtype=torch.bfloat16) * 3.2)(D, F) * (D ** -0.5)),
            "b1": _w((lambda *s: torch.randn(*s, dtype=torch.bfloat16) * 3.2)(F) * 0.01),
            "w2": _w((lambda *s: torch.randn(*s, dtype=torch.bfloat16) * 0.4)(F, D) * (F ** -0.5)),
            "b2": _w((lambda *s: torch.randn(*s, dtype=torch.bfloat16) * 0.4)(D) * 0.01),
        }
    _B_in = _B_setup()

    return {
        "A_x": _A_in["x"],
        "A_wqkv": _A_in["wqkv"],
        "A_wo": _A_in["wo"],
        "B_x": _B_in["x"],
        "B_w1": _B_in["w1"],
        "B_b1": _B_in["b1"],
        "B_w2": _B_in["w2"],
        "B_b2": _B_in["b2"],
    }

def reference(A_x, A_wqkv, A_wo, B_x, B_w1, B_b1, B_w2, B_b2):
    def _A_ref(x, wqkv, wo):
        B, S, D = x.shape
        H = 32; Dh = D // H; W = 256
        qkv = (lambda x, *d: x.permute(*d))((x @ wqkv).reshape(B, S, 3, H, Dh), 2, 0, 3, 1, 4)
        q, k, v = qkv[0], qkv[1], qkv[2]
        scores = torch.einsum("bhqd,bhkd->bhqk", q, k) * (Dh ** -0.5)
        idx = torch.arange(S)
        mask = (idx[:, None] - idx[None, :] >= 0) & (idx[:, None] - idx[None, :] < W)
        scores = torch.where(mask[None, None], scores, -1e9)
        p = _softmax(scores, axis=-1)
        o = torch.einsum("bhqk,bhkd->bhqd", p, v)
        return (lambda x, *d: x.permute(*d))(o, 0, 2, 1, 3).reshape(B, S, D) @ wo

    def _B_ref(x, w1, b1, w2, b2):
        h = torch.einsum("bsd,df->bsf", x, w1) + b1
        h = _gelu(h)
        return torch.einsum("bsf,fd->bsd", h, w2) + b2

    x = A_x
    xn = _layernorm(x, axis=-1)
    return x + _A_ref(xn, A_wqkv, A_wo) + _B_ref(xn, B_w1, B_b1, B_w2, B_b2)
```

```asm
; @launch grid=(256,1,1) block=(256,1,1) lds=163840
.amdgcn_target "amdgcn-amd-amdhsa--gfx950"
.text
.globl parallel_sum__sliding_block__dense_activation_gelu__prompt_kernel
.p2align 8
.type parallel_sum__sliding_block__dense_activation_gelu__prompt_kernel,@function
parallel_sum__sliding_block__dense_activation_gelu__prompt_kernel:
    s_cmp_ge_u32 s2, 256
    s_cbranch_scc1 L_end
    s_load_dwordx16 s[4:19], s[0:1], 0
    s_load_dwordx4 s[20:23], s[0:1], 64
    s_load_dwordx2 s[24:25], s[0:1], 80
    v_mov_b32 v39, v0
    v_lshrrev_b32 v1, 6, v0
    v_and_b32 v0, 63, v0
    v_mov_b32 v46, 0
    v_readfirstlane_b32 s26, v1
    v_lshlrev_b32 v1, 4, v0
    s_getpc_b64 s[40:41]
L_pc:
    s_lshr_b32 s80, s2, 3
    s_lshl_b32 s80, s80, 2
    s_add_u32 s80, s80, s26
    s_and_b32 s80, s80, 63
    s_lshl_b32 s80, s80, 10
    v_add_u32 v32, s80, v1
    v_min_u32 v32, L_end-L_pc-16, v32
    v_mov_b32 v33, s41
    v_add_co_u32 v32, vcc, s40, v32
    s_nop 1
    v_addc_co_u32 v33, vcc, 0, v33, vcc
    global_load_dwordx4 a[240:243], v[32:33], off
    s_and_b32 s27, s2, 1
    s_lshl_b32 s27, s27, 2
    s_bfe_u32 s28, s2, 0x20003
    s_add_u32 s27, s27, s28
    s_bfe_u32 s28, s2, 0x20001
    s_lshl_b32 s28, s28, 3
    s_lshr_b32 s29, s2, 5
    s_add_u32 s28, s28, s29
    s_and_b32 s3, s28, 5
    s_cmp_eq_u32 s3, 4
    s_cselect_b32 s3, 2, 0
    s_xor_b32 s3, s28, s3
    s_and_b32 s29, s3, 1
    v_lshrrev_b32 v30, 5, v39
    v_and_b32 v31, 31, v39
    v_lshlrev_b32 v3, 11, v30
    v_lshl_add_u32 v3, v31, 4, v3
    s_lshl_b32 s78, s27, 5
    s_add_u32 s78, s78, s28
    s_lshl_b32 s79, s78, 14
    s_waitcnt lgkmcnt(0)
    s_mov_b32 s48, s4
    s_and_b32 s49, s5, 0xffff
    s_mov_b32 s50, 0x400000
    s_mov_b32 s51, 0x20000
    buffer_load_dwordx4 v[128:131], v3, s[48:51], s79 offen offset:0
    buffer_load_dwordx4 v[132:135], v3, s[48:51], s79 offen offset:512
    buffer_load_dwordx4 v[136:139], v3, s[48:51], s79 offen offset:1024
    buffer_load_dwordx4 v[140:143], v3, s[48:51], s79 offen offset:1536
    s_mov_b32 s72, s16
    s_and_b32 s73, s17, 0xffff
    s_mov_b32 s74, 0x700000
    s_mov_b32 s75, 0x20000
    s_lshl_b32 s76, s2, 12
    s_lshl_b32 s77, s26, 10
    s_add_u32 s76, s76, s77
    s_mov_b32 s77, s76
    buffer_load_dwordx4 a[244:247], v1, s[72:75], s76 offen
    s_add_u32 s76, s76, 1048576
    buffer_load_dwordx4 a[244:247], v1, s[72:75], s76 offen
    s_add_u32 s76, s76, 1048576
    buffer_load_dwordx4 a[244:247], v1, s[72:75], s76 offen
    s_add_u32 s76, s76, 1048576
    s_mov_b32 s44, s24
    s_and_b32 s45, s25, 0xffff
    s_mov_b32 s46, 0x10000000
    s_mov_b32 s47, 0x20000
    s_or_b32 s80, s2, s26
    s_cmp_lg_u32 s80, 0
    s_cbranch_scc1 L_nolead
    s_memrealtime s[96:97]
    s_mov_b32 s48, s22
    s_and_b32 s49, s23, 0xffff
    s_mov_b32 s50, 0x100
    s_mov_b32 s51, 0x20000
    s_waitcnt lgkmcnt(0)
    s_or_b32 s98, s96, 1
    s_or_b32 s99, s97, 0x40000000
    v_mov_b32 v44, s98
    v_mov_b32 v45, s99
    s_mov_b64 exec, 1
    buffer_store_dwordx2 v[44:45], v46, s[48:51], 0 offen sc1
    s_mov_b64 exec, -1
L_nolead:
    s_xor_b32 s68, s27, s28
    s_and_b32 s68, s68, 3
    s_mul_i32 s81, s3, 224
    s_lshl_b32 s66, s26, 12
    s_lshl_b32 s69, s26, 11
    s_cmp_ge_u32 s26, 2
    s_cbranch_scc1 L_w1setup
    v_add_u32 v32, 0, v0
    v_mul_u32_u24 v33, 43691, v32
    v_lshrrev_b32 v33, 19, v33
    v_mul_u32_u24 v34, 12, v33
    v_sub_u32 v34, v32, v34
    v_lshrrev_b32 v35, 2, v34
    v_and_b32 v34, 3, v34
    v_bfe_u32 v36, v33, 2, 1
    v_lshlrev_b32 v36, 1, v36
    v_xor_b32 v34, v34, v36
    v_mul_u32_u24 v33, 6144, v33
    v_lshl_add_u32 v33, v35, 11, v33
    v_lshl_add_u32 v33, v34, 4, v33
    v_subrev_u32 v12, 0, v33
    v_add_u32 v32, 64, v0
    v_mul_u32_u24 v33, 43691, v32
    v_lshrrev_b32 v33, 19, v33
    v_mul_u32_u24 v34, 12, v33
    v_sub_u32 v34, v32, v34
    v_lshrrev_b32 v35, 2, v34
    v_and_b32 v34, 3, v34
    v_bfe_u32 v36, v33, 2, 1
    v_lshlrev_b32 v36, 1, v36
    v_xor_b32 v34, v34, v36
    v_mul_u32_u24 v33, 6144, v33
    v_lshl_add_u32 v33, v35, 11, v33
    v_lshl_add_u32 v33, v34, 4, v33
    v_subrev_u32 v13, 1024, v33
    v_add_u32 v32, 128, v0
    v_mul_u32_u24 v33, 43691, v32
    v_lshrrev_b32 v33, 19, v33
    v_mul_u32_u24 v34, 12, v33
    v_sub_u32 v34, v32, v34
    v_lshrrev_b32 v35, 2, v34
    v_and_b32 v34, 3, v34
    v_bfe_u32 v36, v33, 2, 1
    v_lshlrev_b32 v36, 1, v36
    v_xor_b32 v34, v34, v36
    v_mul_u32_u24 v33, 6144, v33
    v_lshl_add_u32 v33, v35, 11, v33
    v_lshl_add_u32 v33, v34, 4, v33
    v_subrev_u32 v14, 2048, v33
    v_mov_b32 v15, v1
    s_mov_b32 s64, 196608
    s_mul_i32 s82, s26, 98304
    s_lshl_b32 s83, s28, 6
    s_add_u32 s82, s82, s83
    s_mov_b32 s36, s6
    s_and_b32 s37, s7, 0xffff
    s_mov_b32 s38, 0x600000
    s_mov_b32 s39, 0x20000
    s_cmp_eq_u32 s26, 0
    s_cselect_b32 s40, s6, s16
    s_cselect_b32 s41, s7, s17
    s_mov_b32 s83, 0
    s_cselect_b32 s83, 0, s83
    s_cselect_b32 s84, 1569792, 0
    s_and_b32 s41, s41, 0xffff
    s_mov_b32 s42, s83
    s_mov_b32 s43, 0x20000
    s_branch L_setupdone
L_w1setup:
    s_sub_u32 s82, s26, 2
    s_lshl_b32 s82, s82, 8
    v_add_u32 v32, 0, v0
    v_add_u32 v32, s82, v32
    v_mul_u32_u24 v33, 4682, v32
    v_lshrrev_b32 v33, 16, v33
    v_mul_u32_u24 v34, 14, v33
    v_sub_u32 v34, v32, v34
    v_lshl_add_u32 v34, s29, 1, v34
    v_subrev_u32 v35, 14, v34
    v_cmp_le_u32 vcc, 14, v34
    s_nop 1
    v_cndmask_b32 v34, v34, v35, vcc
    v_mul_u32_u24 v35, 7168, v33
    v_lshl_add_u32 v35, v34, 4, v35
    v_subrev_u32 v12, 0, v35
    v_add_u32 v32, 64, v0
    v_add_u32 v32, s82, v32
    v_mul_u32_u24 v33, 4682, v32
    v_lshrrev_b32 v33, 16, v33
    v_mul_u32_u24 v34, 14, v33
    v_sub_u32 v34, v32, v34
    v_lshl_add_u32 v34, s29, 1, v34
    v_subrev_u32 v35, 14, v34
    v_cmp_le_u32 vcc, 14, v34
    s_nop 1
    v_cndmask_b32 v34, v34, v35, vcc
    v_mul_u32_u24 v35, 7168, v33
    v_lshl_add_u32 v35, v34, 4, v35
    v_subrev_u32 v13, 1024, v35
    v_add_u32 v32, 128, v0
    v_add_u32 v32, s82, v32
    v_mul_u32_u24 v33, 4682, v32
    v_lshrrev_b32 v33, 16, v33
    v_mul_u32_u24 v34, 14, v33
    v_sub_u32 v34, v32, v34
    v_lshl_add_u32 v34, s29, 1, v34
    v_subrev_u32 v35, 14, v34
    v_cmp_le_u32 vcc, 14, v34
    s_nop 1
    v_cndmask_b32 v34, v34, v35, vcc
    v_mul_u32_u24 v35, 7168, v33
    v_lshl_add_u32 v35, v34, 4, v35
    v_subrev_u32 v14, 2048, v35
    v_add_u32 v32, 192, v0
    v_add_u32 v32, s82, v32
    v_mul_u32_u24 v33, 4682, v32
    v_lshrrev_b32 v33, 16, v33
    v_mul_u32_u24 v34, 14, v33
    v_sub_u32 v34, v32, v34
    v_lshl_add_u32 v34, s29, 1, v34
    v_subrev_u32 v35, 14, v34
    v_cmp_le_u32 vcc, 14, v34
    s_nop 1
    v_cndmask_b32 v34, v34, v35, vcc
    v_mul_u32_u24 v35, 7168, v33
    v_lshl_add_u32 v35, v34, 4, v35
    v_subrev_u32 v15, 3072, v35
    s_mov_b32 s64, 229376
    s_mov_b32 s82, s81
    s_mov_b32 s36, s12
    s_and_b32 s37, s13, 0xffff
    s_mov_b32 s38, 0x700000
    s_mov_b32 s39, 0x20000
    s_cmp_eq_u32 s26, 2
    s_cselect_b32 s83, 7340032, 0
    s_mov_b32 s40, s12
    s_and_b32 s41, s13, 0xffff
    s_mov_b32 s42, s83
    s_mov_b32 s43, 0x20000
    s_mov_b32 s84, 1831936
    s_cmp_eq_u32 s26, 2
    s_cbranch_scc1 L_setupdone
    v_mov_b32 v15, v1
L_setupdone:
    s_cmp_eq_u32 s26, 2
    s_cselect_b64 s[62:63], -1, 0
    s_mov_b64 vcc, s[62:63]
    s_mov_b32 s52, 0
    s_lshl_b32 s53, s68, 12
    s_mov_b32 s54, s53
    s_mov_b32 s56, 0
    s_mov_b32 s57, s82
    s_mul_i32 s58, s68, s64
    s_add_u32 s58, s58, s57
    v_lshrrev_b32 v5, 2, v31
    v_and_b32 v32, 1, v31
    v_and_b32 v7, 3, v5
    v_lshl_add_u32 v7, v7, 1, v32
    v_xor_b32 v7, v7, v30
    v_lshlrev_b32 v4, 9, v5
    v_lshl_add_u32 v4, v32, 8, v4
    v_lshl_add_u32 v4, v7, 4, v4
    v_bfe_u32 v32, v31, 1, 1
    v_lshl_add_u32 v4, v32, 3, v4
    v_add_u32 v4, 98304, v4
    v_and_b32 v7, 3, v30
    v_bfe_u32 v32, v39, 4, 1
    v_lshl_add_u32 v7, v7, 1, v32
    v_and_b32 v32, 7, v39
    v_xor_b32 v7, v7, v32
    v_lshlrev_b32 v5, 12, v30
    v_bfe_u32 v32, v39, 3, 2
    v_lshl_add_u32 v5, v32, 8, v5
    v_lshl_add_u32 v5, v7, 4, v5
    v_lshlrev_b32 v6, 4, v39
    v_add_u32 v6, 98304, v6
    s_lshr_b32 s79, s78, 3
    s_lshl_b32 s85, s79, 7
    s_and_b32 s80, s78, 7
    s_lshl_b32 s80, s80, 4
    s_add_u32 s85, s85, s80
    s_add_u32 s85, s85, 40894464
    s_lshl_b32 s79, s79, 17
    s_bfe_u32 s80, s78, 0x20001
    s_lshl_b32 s80, s80, 10
    s_add_u32 s79, s79, s80
    s_and_b32 s80, s78, 1
    s_lshl_b32 s80, s80, 7
    s_add_u32 s79, s79, s80
    s_waitcnt vmcnt(6)
    v_lshlrev_b32 v144, 16, v128
    v_and_b32 v145, 0xffff0000, v128
    v_lshlrev_b32 v146, 16, v129
    v_and_b32 v147, 0xffff0000, v129
    v_lshlrev_b32 v148, 16, v130
    v_and_b32 v149, 0xffff0000, v130
    v_lshlrev_b32 v150, 16, v131
    v_and_b32 v151, 0xffff0000, v131
    s_waitcnt vmcnt(5)
    v_lshlrev_b32 v152, 16, v132
    v_and_b32 v153, 0xffff0000, v132
    v_lshlrev_b32 v154, 16, v133
    v_and_b32 v155, 0xffff0000, v133
    v_lshlrev_b32 v156, 16, v134
    v_and_b32 v157, 0xffff0000, v134
    v_lshlrev_b32 v158, 16, v135
    v_and_b32 v159, 0xffff0000, v135
    s_waitcnt vmcnt(4)
    v_lshlrev_b32 v160, 16, v136
    v_and_b32 v161, 0xffff0000, v136
    v_lshlrev_b32 v162, 16, v137
    v_and_b32 v163, 0xffff0000, v137
    v_lshlrev_b32 v164, 16, v138
    v_and_b32 v165, 0xffff0000, v138
    v_lshlrev_b32 v166, 16, v139
    v_and_b32 v167, 0xffff0000, v139
    s_waitcnt vmcnt(3)
    v_lshlrev_b32 v168, 16, v140
    v_and_b32 v169, 0xffff0000, v140
    v_lshlrev_b32 v170, 16, v141
    v_and_b32 v171, 0xffff0000, v141
    v_lshlrev_b32 v172, 16, v142
    v_and_b32 v173, 0xffff0000, v142
    v_lshlrev_b32 v174, 16, v143
    v_and_b32 v175, 0xffff0000, v143
    v_pk_add_f32 v[176:177], v[144:145], v[146:147]
    v_pk_add_f32 v[178:179], v[148:149], v[150:151]
    v_pk_add_f32 v[176:177], v[176:177], v[152:153]
    v_pk_add_f32 v[178:179], v[178:179], v[154:155]
    v_pk_add_f32 v[176:177], v[176:177], v[156:157]
    v_pk_add_f32 v[178:179], v[178:179], v[158:159]
    v_pk_add_f32 v[176:177], v[176:177], v[160:161]
    v_pk_add_f32 v[178:179], v[178:179], v[162:163]
    v_pk_add_f32 v[176:177], v[176:177], v[164:165]
    v_pk_add_f32 v[178:179], v[178:179], v[166:167]
    v_pk_add_f32 v[176:177], v[176:177], v[168:169]
    v_pk_add_f32 v[178:179], v[178:179], v[170:171]
    v_pk_add_f32 v[176:177], v[176:177], v[172:173]
    v_pk_add_f32 v[178:179], v[178:179], v[174:175]
    v_pk_add_f32 v[176:177], v[176:177], v[178:179]
    v_add_f32 v176, v176, v177
    s_nop 1
    v_add_f32_dpp v176, v176, v176 row_ror:8 row_mask:0xf bank_mask:0xf
    s_nop 1
    v_add_f32_dpp v176, v176, v176 row_ror:4 row_mask:0xf bank_mask:0xf
    s_nop 1
    v_add_f32_dpp v176, v176, v176 row_ror:2 row_mask:0xf bank_mask:0xf
    s_nop 1
    v_add_f32_dpp v176, v176, v176 row_ror:1 row_mask:0xf bank_mask:0xf
    v_mov_b32 v177, v176
    s_nop 1
    v_permlane16_swap_b32 v176, v177
    s_nop 1
    v_add_f32 v176, v176, v177
    v_mul_f32 v176, 0x3a800000, v176
    v_pk_add_f32 v[144:145], v[144:145], v[176:177] op_sel_hi:[1,0] neg_lo:[0,1] neg_hi:[0,1]
    v_pk_add_f32 v[146:147], v[146:147], v[176:177] op_sel_hi:[1,0] neg_lo:[0,1] neg_hi:[0,1]
    v_pk_add_f32 v[148:149], v[148:149], v[176:177] op_sel_hi:[1,0] neg_lo:[0,1] neg_hi:[0,1]
    v_pk_add_f32 v[150:151], v[150:151], v[176:177] op_sel_hi:[1,0] neg_lo:[0,1] neg_hi:[0,1]
    v_pk_add_f32 v[152:153], v[152:153], v[176:177] op_sel_hi:[1,0] neg_lo:[0,1] neg_hi:[0,1]
    v_pk_add_f32 v[154:155], v[154:155], v[176:177] op_sel_hi:[1,0] neg_lo:[0,1] neg_hi:[0,1]
    v_pk_add_f32 v[156:157], v[156:157], v[176:177] op_sel_hi:[1,0] neg_lo:[0,1] neg_hi:[0,1]
    v_pk_add_f32 v[158:159], v[158:159], v[176:177] op_sel_hi:[1,0] neg_lo:[0,1] neg_hi:[0,1]
    v_pk_add_f32 v[160:161], v[160:161], v[176:177] op_sel_hi:[1,0] neg_lo:[0,1] neg_hi:[0,1]
    v_pk_add_f32 v[162:163], v[162:163], v[176:177] op_sel_hi:[1,0] neg_lo:[0,1] neg_hi:[0,1]
    v_pk_add_f32 v[164:165], v[164:165], v[176:177] op_sel_hi:[1,0] neg_lo:[0,1] neg_hi:[0,1]
    v_pk_add_f32 v[166:167], v[166:167], v[176:177] op_sel_hi:[1,0] neg_lo:[0,1] neg_hi:[0,1]
    v_pk_add_f32 v[168:169], v[168:169], v[176:177] op_sel_hi:[1,0] neg_lo:[0,1] neg_hi:[0,1]
    v_pk_add_f32 v[170:171], v[170:171], v[176:177] op_sel_hi:[1,0] neg_lo:[0,1] neg_hi:[0,1]
    v_pk_add_f32 v[172:173], v[172:173], v[176:177] op_sel_hi:[1,0] neg_lo:[0,1] neg_hi:[0,1]
    v_pk_add_f32 v[174:175], v[174:175], v[176:177] op_sel_hi:[1,0] neg_lo:[0,1] neg_hi:[0,1]
    v_pk_mul_f32 v[178:179], v[144:145], v[144:145]
    v_pk_mul_f32 v[180:181], v[146:147], v[146:147]
    v_pk_fma_f32 v[178:179], v[148:149], v[148:149], v[178:179]
    v_pk_fma_f32 v[180:181], v[150:151], v[150:151], v[180:181]
    v_pk_fma_f32 v[178:179], v[152:153], v[152:153], v[178:179]
    v_pk_fma_f32 v[180:181], v[154:155], v[154:155], v[180:181]
    v_pk_fma_f32 v[178:179], v[156:157], v[156:157], v[178:179]
    v_pk_fma_f32 v[180:181], v[158:159], v[158:159], v[180:181]
    v_pk_fma_f32 v[178:179], v[160:161], v[160:161], v[178:179]
    v_pk_fma_f32 v[180:181], v[162:163], v[162:163], v[180:181]
    v_pk_fma_f32 v[178:179], v[164:165], v[164:165], v[178:179]
    v_pk_fma_f32 v[180:181], v[166:167], v[166:167], v[180:181]
    v_pk_fma_f32 v[178:179], v[168:169], v[168:169], v[178:179]
    v_pk_fma_f32 v[180:181], v[170:171], v[170:171], v[180:181]
    v_pk_fma_f32 v[178:179], v[172:173], v[172:173], v[178:179]
    v_pk_fma_f32 v[180:181], v[174:175], v[174:175], v[180:181]
    v_pk_add_f32 v[178:179], v[178:179], v[180:181]
    v_add_f32 v178, v178, v179
    s_nop 1
    v_add_f32_dpp v178, v178, v178 row_ror:8 row_mask:0xf bank_mask:0xf
    s_nop 1
    v_add_f32_dpp v178, v178, v178 row_ror:4 row_mask:0xf bank_mask:0xf
    s_nop 1
    v_add_f32_dpp v178, v178, v178 row_ror:2 row_mask:0xf bank_mask:0xf
    s_nop 1
    v_add_f32_dpp v178, v178, v178 row_ror:1 row_mask:0xf bank_mask:0xf
    v_mov_b32 v179, v178
    s_nop 1
    v_permlane16_swap_b32 v178, v179
    s_nop 1
    v_add_f32 v178, v178, v179
    v_mov_b32 v179, 0x3727c5ac
    v_fmac_f32 v179, 0x3a800000, v178
    v_rsq_f32 v178, v179
    s_nop 0
    v_pk_mul_f32 v[144:145], v[144:145], v[178:179] op_sel_hi:[1,0]
    v_pk_mul_f32 v[146:147], v[146:147], v[178:179] op_sel_hi:[1,0]
    v_pk_mul_f32 v[148:149], v[148:149], v[178:179] op_sel_hi:[1,0]
    v_pk_mul_f32 v[150:151], v[150:151], v[178:179] op_sel_hi:[1,0]
    v_cvt_pk_bf16_f32 v128, v144, v145
    v_cvt_pk_bf16_f32 v129, v146, v147
    v_cvt_pk_bf16_f32 v130, v148, v149
    v_cvt_pk_bf16_f32 v131, v150, v151
    ds_write_b64 v4, v[128:129] offset:0
    ds_write_b64 v4, v[130:131] offset:128
    v_pk_mul_f32 v[152:153], v[152:153], v[178:179] op_sel_hi:[1,0]
    v_pk_mul_f32 v[154:155], v[154:155], v[178:179] op_sel_hi:[1,0]
    v_pk_mul_f32 v[156:157], v[156:157], v[178:179] op_sel_hi:[1,0]
    v_pk_mul_f32 v[158:159], v[158:159], v[178:179] op_sel_hi:[1,0]
    v_cvt_pk_bf16_f32 v132, v152, v153
    v_cvt_pk_bf16_f32 v133, v154, v155
    v_cvt_pk_bf16_f32 v134, v156, v157
    v_cvt_pk_bf16_f32 v135, v158, v159
    ds_write_b64 v4, v[132:133] offset:4096
    ds_write_b64 v4, v[134:135] offset:4224
    v_pk_mul_f32 v[160:161], v[160:161], v[178:179] op_sel_hi:[1,0]
    v_pk_mul_f32 v[162:163], v[162:163], v[178:179] op_sel_hi:[1,0]
    v_pk_mul_f32 v[164:165], v[164:165], v[178:179] op_sel_hi:[1,0]
    v_pk_mul_f32 v[166:167], v[166:167], v[178:179] op_sel_hi:[1,0]
    v_cvt_pk_bf16_f32 v136, v160, v161
    v_cvt_pk_bf16_f32 v137, v162, v163
    v_cvt_pk_bf16_f32 v138, v164, v165
    v_cvt_pk_bf16_f32 v139, v166, v167
    ds_write_b64 v4, v[136:137] offset:8192
    ds_write_b64 v4, v[138:139] offset:8320
    v_pk_mul_f32 v[168:169], v[168:169], v[178:179] op_sel_hi:[1,0]
    v_pk_mul_f32 v[170:171], v[170:171], v[178:179] op_sel_hi:[1,0]
    v_pk_mul_f32 v[172:173], v[172:173], v[178:179] op_sel_hi:[1,0]
    v_pk_mul_f32 v[174:175], v[174:175], v[178:179] op_sel_hi:[1,0]
    v_cvt_pk_bf16_f32 v140, v168, v169
    v_cvt_pk_bf16_f32 v141, v170, v171
    v_cvt_pk_bf16_f32 v142, v172, v173
    v_cvt_pk_bf16_f32 v143, v174, v175
    ds_write_b64 v4, v[140:141] offset:12288
    ds_write_b64 v4, v[142:143] offset:12416
    s_mov_b32 s48, s22
    s_and_b32 s49, s23, 0xffff
    s_mov_b32 s50, 0x100
    s_mov_b32 s51, 0x20000
    buffer_load_dwordx2 v[44:45], v46, s[48:51], 0 offen sc1
    s_waitcnt lgkmcnt(0)
    s_barrier
    ds_read_b128 v[144:147], v6 offset:0
    ds_read_b128 v[148:151], v6 offset:4096
    ds_read_b128 v[152:155], v6 offset:8192
    ds_read_b128 v[156:159], v6 offset:12288
    s_waitcnt lgkmcnt(3)
    buffer_store_dwordx4 v[144:147], v5, s[44:47], s79 offen sc1
    s_add_u32 s79, s79, 32768
    s_waitcnt lgkmcnt(2)
    buffer_store_dwordx4 v[148:151], v5, s[44:47], s79 offen sc1
    s_add_u32 s79, s79, 32768
    s_waitcnt lgkmcnt(1)
    buffer_store_dwordx4 v[152:155], v5, s[44:47], s79 offen sc1
    s_add_u32 s79, s79, 32768
    s_waitcnt lgkmcnt(0)
    buffer_store_dwordx4 v[156:159], v5, s[44:47], s79 offen sc1
    s_add_u32 m0, s66, 0
    s_add_u32 s56, s56, 1
    buffer_load_dwordx4 v12, s[36:39], s58 offen offset:0  lds
    s_xor_b32 s59, s56, s68
    buffer_load_dwordx4 v13, s[36:39], s58 offen offset:1024  lds
    s_mul_i32 s59, s59, s64
    buffer_load_dwordx4 v14, s[36:39], s58 offen offset:2048  lds
    s_cbranch_vccz 2
    buffer_load_dwordx4 v15, s[40:43], s58 offen offset:3072  lds
    s_add_u32 s58, s59, s57
    s_mov_b32 s32, s14
    s_and_b32 s33, s15, 0xffff
    s_mov_b32 s34, 0x1c00
    s_mov_b32 s35, 0x20000
    v_lshrrev_b32 v2, 4, v0
    v_lshlrev_b32 v2, 3, v2
    s_lshl_b32 s83, s29, 5
    s_add_u32 s83, s83, s81
    s_cmp_eq_u32 s29, 0
    s_cselect_b32 s84, 192, 0
    s_add_u32 s84, s84, s81
    buffer_load_dwordx2 v[16:17], v2, s[32:35], s83 offen offset:0
    buffer_load_dwordx2 v[18:19], v2, s[32:35], s83 offen offset:32
    buffer_load_dwordx2 v[20:21], v2, s[32:35], s83 offen offset:64
    buffer_load_dwordx2 v[22:23], v2, s[32:35], s83 offen offset:96
    buffer_load_dwordx2 v[24:25], v2, s[32:35], s83 offen offset:128
    buffer_load_dwordx2 v[26:27], v2, s[32:35], s83 offen offset:160
    buffer_load_dwordx2 v[28:29], v2, s[32:35], s84 offen
    s_lshl_b32 s80, s27, 2
    s_add_u32 s80, s80, s26
    s_lshl_b32 s86, s80, 7
    s_add_u32 s86, s86, 40894464
    s_lshl_b32 s80, s80, 17
    s_add_u32 s32, s24, s80
    s_addc_u32 s33, s25, 0
    s_and_b32 s33, s33, 0xffff
    s_mov_b32 s34, 0x20000
    s_mov_b32 s35, 0x20000
    v_lshrrev_b32 v2, 2, v0
    v_and_b32 v3, 3, v0
    v_lshlrev_b32 v3, 3, v3
    v_mul_u32_u24 v4, 192, v2
    v_add_u32 v4, v4, v3
    v_bfe_u32 v5, v0, 4, 1
    v_lshl_add_u32 v6, v5, 5, v4
    v_xor_b32 v5, 1, v5
    v_lshl_add_u32 v7, v5, 5, v4
    v_mul_u32_u24 v8, 224, v2
    v_add_u32 v8, v8, v3
    v_add_u32 v8, 8192, v8
    v_add_u32 v9, 0x10000, v6
    v_add_u32 v10, 0x10000, v7
    v_add_u32 v11, 0x10000, v8
    v_and_b32 v38, 7, v0
    v_lshlrev_b32 v38, 4, v38
    s_waitcnt vmcnt(14)
    s_mov_b32 s95, 0x40000
L_nonce:
    v_readfirstlane_b32 s70, v44
    v_readfirstlane_b32 s71, v45
    s_sub_u32 s95, s95, 1
    s_cmp_eq_u32 s95, 0
    s_cbranch_scc1 L_nonce_ok
    s_min_u32 s80, s70, s71
    s_cmp_lg_u32 s80, 0
    s_cbranch_scc1 L_nonce_ok
    s_sleep 1
    buffer_load_dwordx2 v[44:45], v46, s[48:51], 0 offen sc1
    s_waitcnt vmcnt(0)
    s_branch L_nonce
L_nonce_ok:
    s_waitcnt vmcnt(10)
    s_barrier
    s_cmp_lg_u32 s26, 0
    s_cbranch_scc1 L_nof0
    s_mov_b64 exec, 1
    buffer_store_dwordx2 v[44:45], v46, s[44:47], s85 offen sc1
    s_mov_b64 exec, -1
L_nof0:
    s_add_u32 m0, s66, 16384
    s_add_u32 s56, s56, 1
    buffer_load_dwordx4 v12, s[36:39], s58 offen offset:0  lds
    s_xor_b32 s59, s56, s68
    buffer_load_dwordx4 v13, s[36:39], s58 offen offset:1024  lds
    s_mul_i32 s59, s59, s64
    buffer_load_dwordx4 v14, s[36:39], s58 offen offset:2048  lds
    s_cbranch_vccz 2
    buffer_load_dwordx4 v15, s[40:43], s58 offen offset:3072  lds
    s_add_u32 s58, s59, s57
    s_add_u32 m0, s66, 32768
    s_add_u32 s56, s56, 1
    buffer_load_dwordx4 v12, s[36:39], s58 offen offset:0  lds
    s_xor_b32 s59, s56, s68
    buffer_load_dwordx4 v13, s[36:39], s58 offen offset:1024  lds
    s_mul_i32 s59, s59, s64
    buffer_load_dwordx4 v14, s[36:39], s58 offen offset:2048  lds
    s_cbranch_vccz 2
    buffer_load_dwordx4 v15, s[40:43], s58 offen offset:3072  lds
    s_add_u32 s58, s59, s57
    s_add_u32 m0, s66, 49152
    s_add_u32 s56, s56, 1
    buffer_load_dwordx4 v12, s[36:39], s58 offen offset:0  lds
    s_xor_b32 s59, s56, s68
    buffer_load_dwordx4 v13, s[36:39], s58 offen offset:1024  lds
    s_mul_i32 s59, s59, s64
    buffer_load_dwordx4 v14, s[36:39], s58 offen offset:2048  lds
    s_cbranch_vccz 2
    buffer_load_dwordx4 v15, s[40:43], s58 offen offset:3072  lds
    s_add_u32 s58, s59, s57
    s_mov_b32 s48, s8
    s_and_b32 s49, s9, 0xffff
    s_mov_b32 s50, 0x200000
    s_mov_b32 s51, 0x20000
    v_mov_b32 v48, 0
    v_mov_b32 v49, 0
    v_mov_b32 v50, 0
    v_mov_b32 v51, 0
    v_mov_b32 v52, 0
    v_mov_b32 v53, 0
    v_mov_b32 v54, 0
    v_mov_b32 v55, 0
    v_mov_b32 v56, 0
    v_mov_b32 v57, 0
    v_mov_b32 v58, 0
    v_mov_b32 v59, 0
    v_mov_b32 v60, 0
    v_mov_b32 v61, 0
    v_mov_b32 v62, 0
    v_mov_b32 v63, 0
    v_mov_b32 v64, 0
    v_mov_b32 v65, 0
    v_mov_b32 v66, 0
    v_mov_b32 v67, 0
    v_mov_b32 v68, 0
    v_mov_b32 v69, 0
    v_mov_b32 v70, 0
    v_mov_b32 v71, 0
    v_mov_b32 v72, 0
    v_mov_b32 v73, 0
    v_mov_b32 v74, 0
    v_mov_b32 v75, 0
    v_mov_b32 v76, 0
    v_mov_b32 v77, 0
    v_mov_b32 v78, 0
    v_mov_b32 v79, 0
    v_mov_b32 v80, 0
    v_mov_b32 v81, 0
    v_mov_b32 v82, 0
    v_mov_b32 v83, 0
    v_mov_b32 v84, 0
    v_mov_b32 v85, 0
    v_mov_b32 v86, 0
    v_mov_b32 v87, 0
    v_mov_b32 v88, 0
    v_mov_b32 v89, 0
    v_mov_b32 v90, 0
    v_mov_b32 v91, 0
    v_mov_b32 v92, 0
    v_mov_b32 v93, 0
    v_mov_b32 v94, 0
    v_mov_b32 v95, 0
    v_mov_b32 v96, 0
    v_mov_b32 v97, 0
    v_mov_b32 v98, 0
    v_mov_b32 v99, 0
    v_mov_b32 v100, 0
    v_mov_b32 v101, 0
    v_mov_b32 v102, 0
    v_mov_b32 v103, 0
    v_mov_b32 v104, 0
    v_mov_b32 v105, 0
    v_mov_b32 v106, 0
    v_mov_b32 v107, 0
    v_mov_b32 v108, 0
    v_mov_b32 v109, 0
    v_mov_b32 v110, 0
    v_mov_b32 v111, 0
    v_mov_b32 v112, 0
    v_mov_b32 v113, 0
    v_mov_b32 v114, 0
    v_mov_b32 v115, 0
    v_mov_b32 v116, 0
    v_mov_b32 v117, 0
    v_mov_b32 v118, 0
    v_mov_b32 v119, 0
    v_mov_b32 v120, 0
    v_mov_b32 v121, 0
    v_mov_b32 v122, 0
    v_mov_b32 v123, 0
    v_mov_b32 v124, 0
    v_mov_b32 v125, 0
    v_mov_b32 v126, 0
    v_mov_b32 v127, 0
    v_mov_b32 v128, 0
    v_mov_b32 v129, 0
    v_mov_b32 v130, 0
    v_mov_b32 v131, 0
    v_mov_b32 v132, 0
    v_mov_b32 v133, 0
    v_mov_b32 v134, 0
    v_mov_b32 v135, 0
    v_mov_b32 v136, 0
    v_mov_b32 v137, 0
    v_mov_b32 v138, 0
    v_mov_b32 v139, 0
    v_mov_b32 v140, 0
    v_mov_b32 v141, 0
    v_mov_b32 v142, 0
    v_mov_b32 v143, 0
    buffer_load_dwordx2 v[36:37], v38, s[44:47], s86 offen sc1
    s_waitcnt vmcnt(10)
    s_barrier
    ds_read_b64_tr_b16 a[96:97], v6 offset:0
    ds_read_b64_tr_b16 a[98:99], v6 offset:4096
    ds_read_b64_tr_b16 a[100:101], v7 offset:0
    ds_read_b64_tr_b16 a[102:103], v7 offset:4096
    ds_read_b64_tr_b16 a[104:105], v6 offset:64
    ds_read_b64_tr_b16 a[106:107], v6 offset:4160
    ds_read_b64_tr_b16 a[108:109], v7 offset:64
    ds_read_b64_tr_b16 a[110:111], v7 offset:4160
    ds_read_b64_tr_b16 a[112:113], v6 offset:128
    ds_read_b64_tr_b16 a[114:115], v6 offset:4224
    ds_read_b64_tr_b16 a[116:117], v7 offset:128
    ds_read_b64_tr_b16 a[118:119], v7 offset:4224
    ds_read_b64_tr_b16 a[120:121], v8 offset:0
    ds_read_b64_tr_b16 a[122:123], v8 offset:3584
    ds_read_b64_tr_b16 a[124:125], v8 offset:32
    ds_read_b64_tr_b16 a[126:127], v8 offset:3616
    ds_read_b64_tr_b16 a[128:129], v8 offset:64
    ds_read_b64_tr_b16 a[130:131], v8 offset:3648
    ds_read_b64_tr_b16 a[132:133], v8 offset:96
    ds_read_b64_tr_b16 a[134:135], v8 offset:3680
    ds_read_b64_tr_b16 a[136:137], v8 offset:128
    ds_read_b64_tr_b16 a[138:139], v8 offset:3712
    ds_read_b64_tr_b16 a[140:141], v8 offset:160
    ds_read_b64_tr_b16 a[142:143], v8 offset:3744
    ds_read_b64_tr_b16 a[144:145], v8 offset:192
    ds_read_b64_tr_b16 a[146:147], v8 offset:3776
    s_waitcnt vmcnt(0)
    v_cmp_ne_u64 vcc, s[70:71], v[36:37]
    s_mov_b32 s95, 0x40000
    s_nop 0
    s_cmp_eq_u64 vcc, 0
    s_cbranch_scc1 L_pf0_ok
L_pf0_spin:
    s_sleep 1
    buffer_load_dwordx2 v[36:37], v38, s[44:47], s86 offen sc1
    s_waitcnt vmcnt(0)
    v_cmp_ne_u64 vcc, s[70:71], v[36:37]
    s_sub_u32 s95, s95, 1
    s_cmp_eq_u32 s95, 0
    s_cbranch_scc1 L_pf0_ok
    s_cmp_lg_u64 vcc, 0
    s_cbranch_scc1 L_pf0_spin
L_pf0_ok:
    s_mov_b64 vcc, s[62:63]
    buffer_load_dwordx4 a[0:3], v1, s[32:35], s54 offen offset:0 sc1
    s_add_u32 s52, s52, 4096
    buffer_load_dwordx4 a[4:7], v1, s[32:35], s54 offen offset:1024 sc1
    buffer_load_dwordx4 a[8:11], v1, s[32:35], s54 offen offset:2048 sc1
    buffer_load_dwordx4 a[12:15], v1, s[32:35], s54 offen offset:3072 sc1
    s_xor_b32 s54, s52, s53
    buffer_load_dwordx4 a[16:19], v1, s[32:35], s54 offen offset:0 sc1
    s_add_u32 s52, s52, 4096
    buffer_load_dwordx4 a[20:23], v1, s[32:35], s54 offen offset:1024 sc1
    buffer_load_dwordx4 a[24:27], v1, s[32:35], s54 offen offset:2048 sc1
    buffer_load_dwordx4 a[28:31], v1, s[32:35], s54 offen offset:3072 sc1
    s_xor_b32 s54, s52, s53
    v_lshlrev_b32 v144, 16, v16
    v_and_b32 v145, 0xffff0000, v16
    v_lshlrev_b32 v146, 16, v17
    v_and_b32 v147, 0xffff0000, v17
    v_mov_b32 v148, v144
    v_mov_b32 v149, v145
    v_mov_b32 v150, v146
    v_mov_b32 v151, v147
    v_mov_b32 v152, v144
    v_mov_b32 v153, v145
    v_mov_b32 v154, v146
    v_mov_b32 v155, v147
    v_mov_b32 v156, v144
    v_mov_b32 v157, v145
    v_mov_b32 v158, v146
    v_mov_b32 v159, v147
    v_lshlrev_b32 v160, 16, v18
    v_and_b32 v161, 0xffff0000, v18
    v_lshlrev_b32 v162, 16, v19
    v_and_b32 v163, 0xffff0000, v19
    v_mov_b32 v164, v160
    v_mov_b32 v165, v161
    v_mov_b32 v166, v162
    v_mov_b32 v167, v163
    v_mov_b32 v168, v160
    v_mov_b32 v169, v161
    v_mov_b32 v170, v162
    v_mov_b32 v171, v163
    v_mov_b32 v172, v160
    v_mov_b32 v173, v161
    v_mov_b32 v174, v162
    v_mov_b32 v175, v163
    v_lshlrev_b32 v176, 16, v20
    v_and_b32 v177, 0xffff0000, v20
    v_lshlrev_b32 v178, 16, v21
    v_and_b32 v179, 0xffff0000, v21
    v_mov_b32 v180, v176
    v_mov_b32 v181, v177
    v_mov_b32 v182, v178
    v_mov_b32 v183, v179
    v_mov_b32 v184, v176
    v_mov_b32 v185, v177
    v_mov_b32 v186, v178
    v_mov_b32 v187, v179
    v_mov_b32 v188, v176
    v_mov_b32 v189, v177
    v_mov_b32 v190, v178
    v_mov_b32 v191, v179
    v_lshlrev_b32 v192, 16, v22
    v_and_b32 v193, 0xffff0000, v22
    v_lshlrev_b32 v194, 16, v23
    v_and_b32 v195, 0xffff0000, v23
    v_mov_b32 v196, v192
    v_mov_b32 v197, v193
    v_mov_b32 v198, v194
    v_mov_b32 v199, v195
    v_mov_b32 v200, v192
    v_mov_b32 v201, v193
    v_mov_b32 v202, v194
    v_mov_b32 v203, v195
    v_mov_b32 v204, v192
    v_mov_b32 v205, v193
    v_mov_b32 v206, v194
    v_mov_b32 v207, v195
    v_lshlrev_b32 v208, 16, v24
    v_and_b32 v209, 0xffff0000, v24
    v_lshlrev_b32 v210, 16, v25
    v_and_b32 v211, 0xffff0000, v25
    v_mov_b32 v212, v208
    v_mov_b32 v213, v209
    v_mov_b32 v214, v210
    v_mov_b32 v215, v211
    v_mov_b32 v216, v208
    v_mov_b32 v217, v209
    v_mov_b32 v218, v210
    v_mov_b32 v219, v211
    v_mov_b32 v220, v208
    v_mov_b32 v221, v209
    v_mov_b32 v222, v210
    v_mov_b32 v223, v211
    v_lshlrev_b32 v224, 16, v26
    v_and_b32 v225, 0xffff0000, v26
    v_lshlrev_b32 v226, 16, v27
    v_and_b32 v227, 0xffff0000, v27
    v_mov_b32 v228, v224
    v_mov_b32 v229, v225
    v_mov_b32 v230, v226
    v_mov_b32 v231, v227
    v_mov_b32 v232, v224
    v_mov_b32 v233, v225
    v_mov_b32 v234, v226
    v_mov_b32 v235, v227
    v_mov_b32 v236, v224
    v_mov_b32 v237, v225
    v_mov_b32 v238, v226
    v_mov_b32 v239, v227
    v_lshlrev_b32 v240, 16, v28
    v_and_b32 v241, 0xffff0000, v28
    v_lshlrev_b32 v242, 16, v29
    v_and_b32 v243, 0xffff0000, v29
    v_mov_b32 v244, v240
    v_mov_b32 v245, v241
    v_mov_b32 v246, v242
    v_mov_b32 v247, v243
    v_mov_b32 v248, v240
    v_mov_b32 v249, v241
    v_mov_b32 v250, v242
    v_mov_b32 v251, v243
    v_mov_b32 v252, v240
    v_mov_b32 v253, v241
    v_mov_b32 v254, v242
    v_mov_b32 v255, v243
    s_waitcnt vmcnt(4)
    s_waitcnt lgkmcnt(15)
    v_mfma_f32_16x16x32_bf16 v[48:51], a[96:99], a[0:3], v[48:51]
    s_barrier
    v_mfma_f32_16x16x32_bf16 v[52:55], a[96:99], a[4:7], v[52:55]
    s_add_u32 m0, s66, 65536
    v_mfma_f32_16x16x32_bf16 v[56:59], a[96:99], a[8:11], v[56:59]
    s_add_u32 s56, s56, 1
    v_mfma_f32_16x16x32_bf16 v[60:63], a[96:99], a[12:15], v[60:63]
    ds_read_b64_tr_b16 a[96:97], v6 offset:16384
    v_mfma_f32_16x16x32_bf16 v[64:67], a[100:103], a[0:3], v[64:67]
    ds_read_b64_tr_b16 a[98:99], v6 offset:20480
    v_mfma_f32_16x16x32_bf16 v[68:71], a[100:103], a[4:7], v[68:71]
    buffer_load_dwordx4 v12, s[36:39], s58 offen offset:0  lds
    v_mfma_f32_16x16x32_bf16 v[72:75], a[100:103], a[8:11], v[72:75]
    s_xor_b32 s59, s56, s68
    v_mfma_f32_16x16x32_bf16 v[76:79], a[100:103], a[12:15], v[76:79]
    ds_read_b64_tr_b16 a[100:101], v7 offset:16384
    v_mfma_f32_16x16x32_bf16 v[80:83], a[104:107], a[0:3], v[80:83]
    ds_read_b64_tr_b16 a[102:103], v7 offset:20480
    v_mfma_f32_16x16x32_bf16 v[84:87], a[104:107], a[4:7], v[84:87]
    buffer_load_dwordx4 v13, s[36:39], s58 offen offset:1024  lds
    v_mfma_f32_16x16x32_bf16 v[88:91], a[104:107], a[8:11], v[88:91]
    s_mul_i32 s59, s59, s64
    v_mfma_f32_16x16x32_bf16 v[92:95], a[104:107], a[12:15], v[92:95]
    ds_read_b64_tr_b16 a[104:105], v6 offset:16448
    v_mfma_f32_16x16x32_bf16 v[96:99], a[108:111], a[0:3], v[96:99]
    ds_read_b64_tr_b16 a[106:107], v6 offset:20544
    v_mfma_f32_16x16x32_bf16 v[100:103], a[108:111], a[4:7], v[100:103]
    buffer_load_dwordx4 v14, s[36:39], s58 offen offset:2048  lds
    v_mfma_f32_16x16x32_bf16 v[104:107], a[108:111], a[8:11], v[104:107]
    s_cbranch_vccz 2
    buffer_load_dwordx4 v15, s[40:43], s58 offen offset:3072  lds
    v_mfma_f32_16x16x32_bf16 v[108:111], a[108:111], a[12:15], v[108:111]
    ds_read_b64_tr_b16 a[108:109], v7 offset:16448
    v_mfma_f32_16x16x32_bf16 v[112:115], a[0:3], a[112:115], v[112:115]
    ds_read_b64_tr_b16 a[110:111], v7 offset:20544
    v_mfma_f32_16x16x32_bf16 v[116:119], a[4:7], a[112:115], v[116:119]
    s_add_u32 s58, s59, s57
    v_mfma_f32_16x16x32_bf16 v[120:123], a[8:11], a[112:115], v[120:123]
    s_waitcnt lgkmcnt(14)
    v_mfma_f32_16x16x32_bf16 v[124:127], a[12:15], a[112:115], v[124:127]
    ds_read_b64_tr_b16 a[112:113], v6 offset:16512
    v_mfma_f32_16x16x32_bf16 v[128:131], a[0:3], a[116:119], v[128:131]
    ds_read_b64_tr_b16 a[114:115], v6 offset:20608
    v_mfma_f32_16x16x32_bf16 v[132:135], a[4:7], a[116:119], v[132:135]
    buffer_load_dwordx4 a[32:35], v1, s[32:35], s54 offen offset:0 sc1
    v_mfma_f32_16x16x32_bf16 v[136:139], a[8:11], a[116:119], v[136:139]
    s_add_u32 s52, s52, 4096
    v_mfma_f32_16x16x32_bf16 v[140:143], a[12:15], a[116:119], v[140:143]
    ds_read_b64_tr_b16 a[116:117], v7 offset:16512
    v_mfma_f32_16x16x32_bf16 v[144:147], a[120:123], a[0:3], v[144:147]
    ds_read_b64_tr_b16 a[118:119], v7 offset:20608
    v_mfma_f32_16x16x32_bf16 v[148:151], a[120:123], a[4:7], v[148:151]
    v_mfma_f32_16x16x32_bf16 v[152:155], a[120:123], a[8:11], v[152:155]
    buffer_load_dwordx4 a[36:39], v1, s[32:35], s54 offen offset:1024 sc1
    v_mfma_f32_16x16x32_bf16 v[156:159], a[120:123], a[12:15], v[156:159]
    ds_read_b64_tr_b16 a[120:121], v8 offset:16384
    v_mfma_f32_16x16x32_bf16 v[160:163], a[124:127], a[0:3], v[160:163]
    ds_read_b64_tr_b16 a[122:123], v8 offset:19968
    v_mfma_f32_16x16x32_bf16 v[164:167], a[124:127], a[4:7], v[164:167]
    buffer_load_dwordx4 a[40:43], v1, s[32:35], s54 offen offset:2048 sc1
    v_mfma_f32_16x16x32_bf16 v[168:171], a[124:127], a[8:11], v[168:171]
    buffer_load_dwordx4 a[44:47], v1, s[32:35], s54 offen offset:3072 sc1
    v_mfma_f32_16x16x32_bf16 v[172:175], a[124:127], a[12:15], v[172:175]
    ds_read_b64_tr_b16 a[124:125], v8 offset:16416
    v_mfma_f32_16x16x32_bf16 v[176:179], a[128:131], a[0:3], v[176:179]
    ds_read_b64_tr_b16 a[126:127], v8 offset:20000
    v_mfma_f32_16x16x32_bf16 v[180:183], a[128:131], a[4:7], v[180:183]
    s_xor_b32 s54, s52, s53
    v_mfma_f32_16x16x32_bf16 v[184:187], a[128:131], a[8:11], v[184:187]
    buffer_load_dwordx4 a[48:51], v1, s[32:35], s54 offen offset:0 sc1
    v_mfma_f32_16x16x32_bf16 v[188:191], a[128:131], a[12:15], v[188:191]
    ds_read_b64_tr_b16 a[128:129], v8 offset:16448
    v_mfma_f32_16x16x32_bf16 v[192:195], a[132:135], a[0:3], v[192:195]
    ds_read_b64_tr_b16 a[130:131], v8 offset:20032
    v_mfma_f32_16x16x32_bf16 v[196:199], a[132:135], a[4:7], v[196:199]
    s_add_u32 s52, s52, 4096
    v_mfma_f32_16x16x32_bf16 v[200:203], a[132:135], a[8:11], v[200:203]
    s_waitcnt lgkmcnt(15)
    v_mfma_f32_16x16x32_bf16 v[204:207], a[132:135], a[12:15], v[204:207]
    ds_read_b64_tr_b16 a[132:133], v8 offset:16480
    v_mfma_f32_16x16x32_bf16 v[208:211], a[136:139], a[0:3], v[208:211]
    ds_read_b64_tr_b16 a[134:135], v8 offset:20064
    v_mfma_f32_16x16x32_bf16 v[212:215], a[136:139], a[4:7], v[212:215]
    buffer_load_dwordx4 a[52:55], v1, s[32:35], s54 offen offset:1024 sc1
    v_mfma_f32_16x16x32_bf16 v[216:219], a[136:139], a[8:11], v[216:219]
    buffer_load_dwordx4 a[56:59], v1, s[32:35], s54 offen offset:2048 sc1
    v_mfma_f32_16x16x32_bf16 v[220:223], a[136:139], a[12:15], v[220:223]
    ds_read_b64_tr_b16 a[136:137], v8 offset:16512
    v_mfma_f32_16x16x32_bf16 v[224:227], a[140:143], a[0:3], v[224:227]
    ds_read_b64_tr_b16 a[138:139], v8 offset:20096
    v_mfma_f32_16x16x32_bf16 v[228:231], a[140:143], a[4:7], v[228:231]
    buffer_load_dwordx4 a[60:63], v1, s[32:35], s54 offen offset:3072 sc1
    v_mfma_f32_16x16x32_bf16 v[232:235], a[140:143], a[8:11], v[232:235]
    s_xor_b32 s54, s52, s53
    v_mfma_f32_16x16x32_bf16 v[236:239], a[140:143], a[12:15], v[236:239]
    ds_read_b64_tr_b16 a[140:141], v8 offset:16544
    v_mfma_f32_16x16x32_bf16 v[240:243], a[144:147], a[0:3], v[240:243]
    ds_read_b64_tr_b16 a[142:143], v8 offset:20128
    s_waitcnt vmcnt(11)
    v_mfma_f32_16x16x32_bf16 v[244:247], a[144:147], a[4:7], v[244:247]
    v_mfma_f32_16x16x32_bf16 v[248:251], a[144:147], a[8:11], v[248:251]
    s_waitcnt lgkmcnt(14)
    v_mfma_f32_16x16x32_bf16 v[252:255], a[144:147], a[12:15], v[252:255]
    ds_read_b64_tr_b16 a[144:145], v8 offset:16576
    ds_read_b64_tr_b16 a[146:147], v8 offset:20160
    v_mfma_f32_16x16x32_bf16 v[48:51], a[96:99], a[16:19], v[48:51]
    s_add_u32 m0, s66, 81920
    v_mfma_f32_16x16x32_bf16 v[52:55], a[96:99], a[20:23], v[52:55]
    s_add_u32 s56, s56, 1
    v_mfma_f32_16x16x32_bf16 v[56:59], a[96:99], a[24:27], v[56:59]
    buffer_load_dwordx4 v12, s[36:39], s58 offen offset:0  lds
    v_mfma_f32_16x16x32_bf16 v[60:63], a[96:99], a[28:31], v[60:63]
    ds_read_b64_tr_b16 a[96:97], v6 offset:32768
    v_mfma_f32_16x16x32_bf16 v[64:67], a[100:103], a[16:19], v[64:67]
    ds_read_b64_tr_b16 a[98:99], v6 offset:36864
    v_mfma_f32_16x16x32_bf16 v[68:71], a[100:103], a[20:23], v[68:71]
    s_xor_b32 s59, s56, s68
    v_mfma_f32_16x16x32_bf16 v[72:75], a[100:103], a[24:27], v[72:75]
    buffer_load_dwordx4 v13, s[36:39], s58 offen offset:1024  lds
    v_mfma_f32_16x16x32_bf16 v[76:79], a[100:103], a[28:31], v[76:79]
    ds_read_b64_tr_b16 a[100:101], v7 offset:32768
    v_mfma_f32_16x16x32_bf16 v[80:83], a[104:107], a[16:19], v[80:83]
    ds_read_b64_tr_b16 a[102:103], v7 offset:36864
    v_mfma_f32_16x16x32_bf16 v[84:87], a[104:107], a[20:23], v[84:87]
    s_mul_i32 s59, s59, s64
    v_mfma_f32_16x16x32_bf16 v[88:91], a[104:107], a[24:27], v[88:91]
    buffer_load_dwordx4 v14, s[36:39], s58 offen offset:2048  lds
    v_mfma_f32_16x16x32_bf16 v[92:95], a[104:107], a[28:31], v[92:95]
    ds_read_b64_tr_b16 a[104:105], v6 offset:32832
    v_mfma_f32_16x16x32_bf16 v[96:99], a[108:111], a[16:19], v[96:99]
    ds_read_b64_tr_b16 a[106:107], v6 offset:36928
    v_mfma_f32_16x16x32_bf16 v[100:103], a[108:111], a[20:23], v[100:103]
    v_mfma_f32_16x16x32_bf16 v[104:107], a[108:111], a[24:27], v[104:107]
    s_cbranch_vccz 2
    buffer_load_dwordx4 v15, s[40:43], s58 offen offset:3072  lds
    v_mfma_f32_16x16x32_bf16 v[108:111], a[108:111], a[28:31], v[108:111]
    ds_read_b64_tr_b16 a[108:109], v7 offset:32832
    v_mfma_f32_16x16x32_bf16 v[112:115], a[16:19], a[112:115], v[112:115]
    ds_read_b64_tr_b16 a[110:111], v7 offset:36928
    v_mfma_f32_16x16x32_bf16 v[116:119], a[20:23], a[112:115], v[116:119]
    s_add_u32 s58, s59, s57
    v_mfma_f32_16x16x32_bf16 v[120:123], a[24:27], a[112:115], v[120:123]
    s_waitcnt lgkmcnt(14)
    v_mfma_f32_16x16x32_bf16 v[124:127], a[28:31], a[112:115], v[124:127]
    ds_read_b64_tr_b16 a[112:113], v6 offset:32896
    v_mfma_f32_16x16x32_bf16 v[128:131], a[16:19], a[116:119], v[128:131]
    ds_read_b64_tr_b16 a[114:115], v6 offset:36992
    v_mfma_f32_16x16x32_bf16 v[132:135], a[20:23], a[116:119], v[132:135]
    buffer_load_dwordx4 a[64:67], v1, s[32:35], s54 offen offset:0 sc1
    v_mfma_f32_16x16x32_bf16 v[136:139], a[24:27], a[116:119], v[136:139]
    s_add_u32 s52, s52, 4096
    v_mfma_f32_16x16x32_bf16 v[140:143], a[28:31], a[116:119], v[140:143]
    ds_read_b64_tr_b16 a[116:117], v7 offset:32896
    v_mfma_f32_16x16x32_bf16 v[144:147], a[120:123], a[16:19], v[144:147]
    ds_read_b64_tr_b16 a[118:119], v7 offset:36992
    v_mfma_f32_16x16x32_bf16 v[148:151], a[120:123], a[20:23], v[148:151]
    buffer_load_dwordx4 a[68:71], v1, s[32:35], s54 offen offset:1024 sc1
    v_mfma_f32_16x16x32_bf16 v[152:155], a[120:123], a[24:27], v[152:155]
    buffer_load_dwordx4 a[72:75], v1, s[32:35], s54 offen offset:2048 sc1
    v_mfma_f32_16x16x32_bf16 v[156:159], a[120:123], a[28:31], v[156:159]
    ds_read_b64_tr_b16 a[120:121], v8 offset:32768
    v_mfma_f32_16x16x32_bf16 v[160:163], a[124:127], a[16:19], v[160:163]
    ds_read_b64_tr_b16 a[122:123], v8 offset:36352
    v_mfma_f32_16x16x32_bf16 v[164:167], a[124:127], a[20:23], v[164:167]
    buffer_load_dwordx4 a[76:79], v1, s[32:35], s54 offen offset:3072 sc1
    v_mfma_f32_16x16x32_bf16 v[168:171], a[124:127], a[24:27], v[168:171]
    v_mfma_f32_16x16x32_bf16 v[172:175], a[124:127], a[28:31], v[172:175]
    ds_read_b64_tr_b16 a[124:125], v8 offset:32800
    v_mfma_f32_16x16x32_bf16 v[176:179], a[128:131], a[16:19], v[176:179]
    ds_read_b64_tr_b16 a[126:127], v8 offset:36384
    v_mfma_f32_16x16x32_bf16 v[180:183], a[128:131], a[20:23], v[180:183]
    s_xor_b32 s54, s52, s53
    v_mfma_f32_16x16x32_bf16 v[184:187], a[128:131], a[24:27], v[184:187]
    buffer_load_dwordx4 a[80:83], v1, s[32:35], s54 offen offset:0 sc1
    v_mfma_f32_16x16x32_bf16 v[188:191], a[128:131], a[28:31], v[188:191]
    ds_read_b64_tr_b16 a[128:129], v8 offset:32832
    v_mfma_f32_16x16x32_bf16 v[192:195], a[132:135], a[16:19], v[192:195]
    ds_read_b64_tr_b16 a[130:131], v8 offset:36416
    v_mfma_f32_16x16x32_bf16 v[196:199], a[132:135], a[20:23], v[196:199]
    s_add_u32 s52, s52, 4096
    v_mfma_f32_16x16x32_bf16 v[200:203], a[132:135], a[24:27], v[200:203]
    s_waitcnt lgkmcnt(15)
    v_mfma_f32_16x16x32_bf16 v[204:207], a[132:135], a[28:31], v[204:207]
    ds_read_b64_tr_b16 a[132:133], v8 offset:32864
    v_mfma_f32_16x16x32_bf16 v[208:211], a[136:139], a[16:19], v[208:211]
    ds_read_b64_tr_b16 a[134:135], v8 offset:36448
    v_mfma_f32_16x16x32_bf16 v[212:215], a[136:139], a[20:23], v[212:215]
    buffer_load_dwordx4 a[84:87], v1, s[32:35], s54 offen offset:1024 sc1
    v_mfma_f32_16x16x32_bf16 v[216:219], a[136:139], a[24:27], v[216:219]
    buffer_load_dwordx4 a[88:91], v1, s[32:35], s54 offen offset:2048 sc1
    v_mfma_f32_16x16x32_bf16 v[220:223], a[136:139], a[28:31], v[220:223]
    ds_read_b64_tr_b16 a[136:137], v8 offset:32896
    v_mfma_f32_16x16x32_bf16 v[224:227], a[140:143], a[16:19], v[224:227]
    ds_read_b64_tr_b16 a[138:139], v8 offset:36480
    v_mfma_f32_16x16x32_bf16 v[228:231], a[140:143], a[20:23], v[228:231]
    buffer_load_dwordx4 a[92:95], v1, s[32:35], s54 offen offset:3072 sc1
    v_mfma_f32_16x16x32_bf16 v[232:235], a[140:143], a[24:27], v[232:235]
    s_xor_b32 s54, s52, s53
    v_mfma_f32_16x16x32_bf16 v[236:239], a[140:143], a[28:31], v[236:239]
    ds_read_b64_tr_b16 a[140:141], v8 offset:32928
    v_mfma_f32_16x16x32_bf16 v[240:243], a[144:147], a[16:19], v[240:243]
    ds_read_b64_tr_b16 a[142:143], v8 offset:36512
    s_waitcnt vmcnt(15)
    v_mfma_f32_16x16x32_bf16 v[244:247], a[144:147], a[20:23], v[244:247]
    v_mfma_f32_16x16x32_bf16 v[248:251], a[144:147], a[24:27], v[248:251]
    s_waitcnt lgkmcnt(14)
    v_mfma_f32_16x16x32_bf16 v[252:255], a[144:147], a[28:31], v[252:255]
    ds_read_b64_tr_b16 a[144:145], v8 offset:32960
    ds_read_b64_tr_b16 a[146:147], v8 offset:36544
    v_mfma_f32_16x16x32_bf16 v[48:51], a[96:99], a[32:35], v[48:51]
    s_barrier
    v_mfma_f32_16x16x32_bf16 v[52:55], a[96:99], a[36:39], v[52:55]
    s_add_u32 m0, s66, 0
    v_mfma_f32_16x16x32_bf16 v[56:59], a[96:99], a[40:43], v[56:59]
    s_add_u32 s56, s56, 1
    v_mfma_f32_16x16x32_bf16 v[60:63], a[96:99], a[44:47], v[60:63]
    ds_read_b64_tr_b16 a[96:97], v6 offset:49152
    v_mfma_f32_16x16x32_bf16 v[64:67], a[100:103], a[32:35], v[64:67]
    ds_read_b64_tr_b16 a[98:99], v6 offset:53248
    v_mfma_f32_16x16x32_bf16 v[68:71], a[100:103], a[36:39], v[68:71]
    buffer_load_dwordx4 v12, s[36:39], s58 offen offset:0  lds
    v_mfma_f32_16x16x32_bf16 v[72:75], a[100:103], a[40:43], v[72:75]
    s_xor_b32 s59, s56, s68
    v_mfma_f32_16x16x32_bf16 v[76:79], a[100:103], a[44:47], v[76:79]
    ds_read_b64_tr_b16 a[100:101], v7 offset:49152
    v_mfma_f32_16x16x32_bf16 v[80:83], a[104:107], a[32:35], v[80:83]
    ds_read_b64_tr_b16 a[102:103], v7 offset:53248
    v_mfma_f32_16x16x32_bf16 v[84:87], a[104:107], a[36:39], v[84:87]
    buffer_load_dwordx4 v13, s[36:39], s58 offen offset:1024  lds
    v_mfma_f32_16x16x32_bf16 v[88:91], a[104:107], a[40:43], v[88:91]
    s_mul_i32 s59, s59, s64
    v_mfma_f32_16x16x32_bf16 v[92:95], a[104:107], a[44:47], v[92:95]
    ds_read_b64_tr_b16 a[104:105], v6 offset:49216
    v_mfma_f32_16x16x32_bf16 v[96:99], a[108:111], a[32:35], v[96:99]
    ds_read_b64_tr_b16 a[106:107], v6 offset:53312
    v_mfma_f32_16x16x32_bf16 v[100:103], a[108:111], a[36:39], v[100:103]
    buffer_load_dwordx4 v14, s[36:39], s58 offen offset:2048  lds
    v_mfma_f32_16x16x32_bf16 v[104:107], a[108:111], a[40:43], v[104:107]
    s_cbranch_vccz 2
    buffer_load_dwordx4 v15, s[40:43], s58 offen offset:3072  lds
    v_mfma_f32_16x16x32_bf16 v[108:111], a[108:111], a[44:47], v[108:111]
    ds_read_b64_tr_b16 a[108:109], v7 offset:49216
    v_mfma_f32_16x16x32_bf16 v[112:115], a[32:35], a[112:115], v[112:115]
    ds_read_b64_tr_b16 a[110:111], v7 offset:53312
    v_mfma_f32_16x16x32_bf16 v[116:119], a[36:39], a[112:115], v[116:119]
    s_add_u32 s58, s59, s57
    v_mfma_f32_16x16x32_bf16 v[120:123], a[40:43], a[112:115], v[120:123]
    s_waitcnt lgkmcnt(14)
    v_mfma_f32_16x16x32_bf16 v[124:127], a[44:47], a[112:115], v[124:127]
    ds_read_b64_tr_b16 a[112:113], v6 offset:49280
    v_mfma_f32_16x16x32_bf16 v[128:131], a[32:35], a[116:119], v[128:131]
    ds_read_b64_tr_b16 a[114:115], v6 offset:53376
    v_mfma_f32_16x16x32_bf16 v[132:135], a[36:39], a[116:119], v[132:135]
    buffer_load_dwordx4 a[0:3], v1, s[32:35], s54 offen offset:0 sc1
    v_mfma_f32_16x16x32_bf16 v[136:139], a[40:43], a[116:119], v[136:139]
    s_add_u32 s52, s52, 4096
    v_mfma_f32_16x16x32_bf16 v[140:143], a[44:47], a[116:119], v[140:143]
    ds_read_b64_tr_b16 a[116:117], v7 offset:49280
    v_mfma_f32_16x16x32_bf16 v[144:147], a[120:123], a[32:35], v[144:147]
    ds_read_b64_tr_b16 a[118:119], v7 offset:53376
    v_mfma_f32_16x16x32_bf16 v[148:151], a[120:123], a[36:39], v[148:151]
    v_mfma_f32_16x16x32_bf16 v[152:155], a[120:123], a[40:43], v[152:155]
    buffer_load_dwordx4 a[4:7], v1, s[32:35], s54 offen offset:1024 sc1
    v_mfma_f32_16x16x32_bf16 v[156:159], a[120:123], a[44:47], v[156:159]
    ds_read_b64_tr_b16 a[120:121], v8 offset:49152
    v_mfma_f32_16x16x32_bf16 v[160:163], a[124:127], a[32:35], v[160:163]
    ds_read_b64_tr_b16 a[122:123], v8 offset:52736
    v_mfma_f32_16x16x32_bf16 v[164:167], a[124:127], a[36:39], v[164:167]
    buffer_load_dwordx4 a[8:11], v1, s[32:35], s54 offen offset:2048 sc1
    v_mfma_f32_16x16x32_bf16 v[168:171], a[124:127], a[40:43], v[168:171]
    buffer_load_dwordx4 a[12:15], v1, s[32:35], s54 offen offset:3072 sc1
    v_mfma_f32_16x16x32_bf16 v[172:175], a[124:127], a[44:47], v[172:175]
    ds_read_b64_tr_b16 a[124:125], v8 offset:49184
    v_mfma_f32_16x16x32_bf16 v[176:179], a[128:131], a[32:35], v[176:179]
    ds_read_b64_tr_b16 a[126:127], v8 offset:52768
    v_mfma_f32_16x16x32_bf16 v[180:183], a[128:131], a[36:39], v[180:183]
    s_xor_b32 s54, s52, s53
    v_mfma_f32_16x16x32_bf16 v[184:187], a[128:131], a[40:43], v[184:187]
    buffer_load_dwordx4 a[16:19], v1, s[32:35], s54 offen offset:0 sc1
    v_mfma_f32_16x16x32_bf16 v[188:191], a[128:131], a[44:47], v[188:191]
    ds_read_b64_tr_b16 a[128:129], v8 offset:49216
    v_mfma_f32_16x16x32_bf16 v[192:195], a[132:135], a[32:35], v[192:195]
    ds_read_b64_tr_b16 a[130:131], v8 offset:52800
    v_mfma_f32_16x16x32_bf16 v[196:199], a[132:135], a[36:39], v[196:199]
    s_add_u32 s52, s52, 4096
    v_mfma_f32_16x16x32_bf16 v[200:203], a[132:135], a[40:43], v[200:203]
    s_waitcnt lgkmcnt(15)
    v_mfma_f32_16x16x32_bf16 v[204:207], a[132:135], a[44:47], v[204:207]
    ds_read_b64_tr_b16 a[132:133], v8 offset:49248
    v_mfma_f32_16x16x32_bf16 v[208:211], a[136:139], a[32:35], v[208:211]
    ds_read_b64_tr_b16 a[134:135], v8 offset:52832
    v_mfma_f32_16x16x32_bf16 v[212:215], a[136:139], a[36:39], v[212:215]
    buffer_load_dwordx4 a[20:23], v1, s[32:35], s54 offen offset:1024 sc1
    v_mfma_f32_16x16x32_bf16 v[216:219], a[136:139], a[40:43], v[216:219]
    buffer_load_dwordx4 a[24:27], v1, s[32:35], s54 offen offset:2048 sc1
    v_mfma_f32_16x16x32_bf16 v[220:223], a[136:139], a[44:47], v[220:223]
    ds_read_b64_tr_b16 a[136:137], v8 offset:49280
    v_mfma_f32_16x16x32_bf16 v[224:227], a[140:143], a[32:35], v[224:227]
    ds_read_b64_tr_b16 a[138:139], v8 offset:52864
    v_mfma_f32_16x16x32_bf16 v[228:231], a[140:143], a[36:39], v[228:231]
    buffer_load_dwordx4 a[28:31], v1, s[32:35], s54 offen offset:3072 sc1
    v_mfma_f32_16x16x32_bf16 v[232:235], a[140:143], a[40:43], v[232:235]
    s_xor_b32 s54, s52, s53
    v_mfma_f32_16x16x32_bf16 v[236:239], a[140:143], a[44:47], v[236:239]
    ds_read_b64_tr_b16 a[140:141], v8 offset:49312
    v_mfma_f32_16x16x32_bf16 v[240:243], a[144:147], a[32:35], v[240:243]
    ds_read_b64_tr_b16 a[142:143], v8 offset:52896
    s_waitcnt vmcnt(22)
    v_mfma_f32_16x16x32_bf16 v[244:247], a[144:147], a[36:39], v[244:247]
    v_mfma_f32_16x16x32_bf16 v[248:251], a[144:147], a[40:43], v[248:251]
    s_waitcnt lgkmcnt(14)
    v_mfma_f32_16x16x32_bf16 v[252:255], a[144:147], a[44:47], v[252:255]
    ds_read_b64_tr_b16 a[144:145], v8 offset:49344
    ds_read_b64_tr_b16 a[146:147], v8 offset:52928
    s_mov_b32 s67, 2
    .p2align 6
L_g1_loop:
    v_mfma_f32_16x16x32_bf16 v[48:51], a[96:99], a[48:51], v[48:51]
    s_add_u32 m0, s66, 16384
    v_mfma_f32_16x16x32_bf16 v[52:55], a[96:99], a[52:55], v[52:55]
    s_add_u32 s56, s56, 1
    v_mfma_f32_16x16x32_bf16 v[56:59], a[96:99], a[56:59], v[56:59]
    v_mfma_f32_16x16x32_bf16 v[60:63], a[96:99], a[60:63], v[60:63]
    ds_read_b64_tr_b16 a[96:97], v9 offset:0
    v_mfma_f32_16x16x32_bf16 v[64:67], a[100:103], a[48:51], v[64:67]
    ds_read_b64_tr_b16 a[98:99], v9 offset:4096
    v_mfma_f32_16x16x32_bf16 v[68:71], a[100:103], a[52:55], v[68:71]
    buffer_load_dwordx4 v12, s[36:39], s58 offen offset:0  lds
    v_mfma_f32_16x16x32_bf16 v[72:75], a[100:103], a[56:59], v[72:75]
    s_xor_b32 s59, s56, s68
    v_mfma_f32_16x16x32_bf16 v[76:79], a[100:103], a[60:63], v[76:79]
    ds_read_b64_tr_b16 a[100:101], v10 offset:0
    v_mfma_f32_16x16x32_bf16 v[80:83], a[104:107], a[48:51], v[80:83]
    ds_read_b64_tr_b16 a[102:103], v10 offset:4096
    v_mfma_f32_16x16x32_bf16 v[84:87], a[104:107], a[52:55], v[84:87]
    v_mfma_f32_16x16x32_bf16 v[88:91], a[104:107], a[56:59], v[88:91]
    buffer_load_dwordx4 v13, s[36:39], s58 offen offset:1024  lds
    v_mfma_f32_16x16x32_bf16 v[92:95], a[104:107], a[60:63], v[92:95]
    ds_read_b64_tr_b16 a[104:105], v9 offset:64
    v_mfma_f32_16x16x32_bf16 v[96:99], a[108:111], a[48:51], v[96:99]
    ds_read_b64_tr_b16 a[106:107], v9 offset:4160
    v_mfma_f32_16x16x32_bf16 v[100:103], a[108:111], a[52:55], v[100:103]
    v_mfma_f32_16x16x32_bf16 v[104:107], a[108:111], a[56:59], v[104:107]
    s_mul_i32 s59, s59, s64
    v_mfma_f32_16x16x32_bf16 v[108:111], a[108:111], a[60:63], v[108:111]
    ds_read_b64_tr_b16 a[108:109], v10 offset:64
    v_mfma_f32_16x16x32_bf16 v[112:115], a[48:51], a[112:115], v[112:115]
    ds_read_b64_tr_b16 a[110:111], v10 offset:4160
    v_mfma_f32_16x16x32_bf16 v[116:119], a[52:55], a[112:115], v[116:119]
    buffer_load_dwordx4 v14, s[36:39], s58 offen offset:2048  lds
    v_mfma_f32_16x16x32_bf16 v[120:123], a[56:59], a[112:115], v[120:123]
    s_waitcnt lgkmcnt(14)
    v_mfma_f32_16x16x32_bf16 v[124:127], a[60:63], a[112:115], v[124:127]
    ds_read_b64_tr_b16 a[112:113], v9 offset:128
    v_mfma_f32_16x16x32_bf16 v[128:131], a[48:51], a[116:119], v[128:131]
    ds_read_b64_tr_b16 a[114:115], v9 offset:4224
    v_mfma_f32_16x16x32_bf16 v[132:135], a[52:55], a[116:119], v[132:135]
    v_mfma_f32_16x16x32_bf16 v[136:139], a[56:59], a[116:119], v[136:139]
    s_cbranch_vccz 2
    buffer_load_dwordx4 v15, s[40:43], s58 offen offset:3072  lds
    v_mfma_f32_16x16x32_bf16 v[140:143], a[60:63], a[116:119], v[140:143]
    ds_read_b64_tr_b16 a[116:117], v10 offset:128
    v_mfma_f32_16x16x32_bf16 v[144:147], a[120:123], a[48:51], v[144:147]
    ds_read_b64_tr_b16 a[118:119], v10 offset:4224
    v_mfma_f32_16x16x32_bf16 v[148:151], a[120:123], a[52:55], v[148:151]
    s_add_u32 s58, s59, s57
    v_mfma_f32_16x16x32_bf16 v[152:155], a[120:123], a[56:59], v[152:155]
    v_mfma_f32_16x16x32_bf16 v[156:159], a[120:123], a[60:63], v[156:159]
    ds_read_b64_tr_b16 a[120:121], v11 offset:0
    v_mfma_f32_16x16x32_bf16 v[160:163], a[124:127], a[48:51], v[160:163]
    ds_read_b64_tr_b16 a[122:123], v11 offset:3584
    v_mfma_f32_16x16x32_bf16 v[164:167], a[124:127], a[52:55], v[164:167]
    buffer_load_dwordx4 a[32:35], v1, s[32:35], s54 offen offset:0 sc1
    v_mfma_f32_16x16x32_bf16 v[168:171], a[124:127], a[56:59], v[168:171]
    v_mfma_f32_16x16x32_bf16 v[172:175], a[124:127], a[60:63], v[172:175]
    ds_read_b64_tr_b16 a[124:125], v11 offset:32
    v_mfma_f32_16x16x32_bf16 v[176:179], a[128:131], a[48:51], v[176:179]
    ds_read_b64_tr_b16 a[126:127], v11 offset:3616
    v_mfma_f32_16x16x32_bf16 v[180:183], a[128:131], a[52:55], v[180:183]
    s_add_u32 s52, s52, 4096
    v_mfma_f32_16x16x32_bf16 v[184:187], a[128:131], a[56:59], v[184:187]
    buffer_load_dwordx4 a[36:39], v1, s[32:35], s54 offen offset:1024 sc1
    v_mfma_f32_16x16x32_bf16 v[188:191], a[128:131], a[60:63], v[188:191]
    ds_read_b64_tr_b16 a[128:129], v11 offset:64
    v_mfma_f32_16x16x32_bf16 v[192:195], a[132:135], a[48:51], v[192:195]
    ds_read_b64_tr_b16 a[130:131], v11 offset:3648
    v_mfma_f32_16x16x32_bf16 v[196:199], a[132:135], a[52:55], v[196:199]
    v_mfma_f32_16x16x32_bf16 v[200:203], a[132:135], a[56:59], v[200:203]
    s_waitcnt lgkmcnt(15)
    v_mfma_f32_16x16x32_bf16 v[204:207], a[132:135], a[60:63], v[204:207]
    ds_read_b64_tr_b16 a[132:133], v11 offset:96
    v_mfma_f32_16x16x32_bf16 v[208:211], a[136:139], a[48:51], v[208:211]
    ds_read_b64_tr_b16 a[134:135], v11 offset:3680
    v_mfma_f32_16x16x32_bf16 v[212:215], a[136:139], a[52:55], v[212:215]
    buffer_load_dwordx4 a[40:43], v1, s[32:35], s54 offen offset:2048 sc1
    v_mfma_f32_16x16x32_bf16 v[216:219], a[136:139], a[56:59], v[216:219]
    buffer_load_dwordx4 a[44:47], v1, s[32:35], s54 offen offset:3072 sc1
    v_mfma_f32_16x16x32_bf16 v[220:223], a[136:139], a[60:63], v[220:223]
    ds_read_b64_tr_b16 a[136:137], v11 offset:128
    v_mfma_f32_16x16x32_bf16 v[224:227], a[140:143], a[48:51], v[224:227]
    ds_read_b64_tr_b16 a[138:139], v11 offset:3712
    v_mfma_f32_16x16x32_bf16 v[228:231], a[140:143], a[52:55], v[228:231]
    v_mfma_f32_16x16x32_bf16 v[232:235], a[140:143], a[56:59], v[232:235]
    s_xor_b32 s54, s52, s53
    v_mfma_f32_16x16x32_bf16 v[236:239], a[140:143], a[60:63], v[236:239]
    ds_read_b64_tr_b16 a[140:141], v11 offset:160
    v_mfma_f32_16x16x32_bf16 v[240:243], a[144:147], a[48:51], v[240:243]
    ds_read_b64_tr_b16 a[142:143], v11 offset:3744
    s_waitcnt vmcnt(11)
    v_mfma_f32_16x16x32_bf16 v[244:247], a[144:147], a[52:55], v[244:247]
    v_mfma_f32_16x16x32_bf16 v[248:251], a[144:147], a[56:59], v[248:251]
    s_waitcnt lgkmcnt(14)
    v_mfma_f32_16x16x32_bf16 v[252:255], a[144:147], a[60:63], v[252:255]
    ds_read_b64_tr_b16 a[144:145], v11 offset:192
    ds_read_b64_tr_b16 a[146:147], v11 offset:3776
    v_mfma_f32_16x16x32_bf16 v[48:51], a[96:99], a[64:67], v[48:51]
    s_barrier
    v_mfma_f32_16x16x32_bf16 v[52:55], a[96:99], a[68:71], v[52:55]
    s_add_u32 m0, s66, 32768
    v_mfma_f32_16x16x32_bf16 v[56:59], a[96:99], a[72:75], v[56:59]
    s_add_u32 s56, s56, 1
    v_mfma_f32_16x16x32_bf16 v[60:63], a[96:99], a[76:79], v[60:63]
    ds_read_b64_tr_b16 a[96:97], v9 offset:16384
    v_mfma_f32_16x16x32_bf16 v[64:67], a[100:103], a[64:67], v[64:67]
    ds_read_b64_tr_b16 a[98:99], v9 offset:20480
    v_mfma_f32_16x16x32_bf16 v[68:71], a[100:103], a[68:71], v[68:71]
    v_mfma_f32_16x16x32_bf16 v[72:75], a[100:103], a[72:75], v[72:75]
    buffer_load_dwordx4 v12, s[36:39], s58 offen offset:0  lds
    v_mfma_f32_16x16x32_bf16 v[76:79], a[100:103], a[76:79], v[76:79]
    ds_read_b64_tr_b16 a[100:101], v10 offset:16384
    v_mfma_f32_16x16x32_bf16 v[80:83], a[104:107], a[64:67], v[80:83]
    ds_read_b64_tr_b16 a[102:103], v10 offset:20480
    v_mfma_f32_16x16x32_bf16 v[84:87], a[104:107], a[68:71], v[84:87]
    s_xor_b32 s59, s56, s68
    v_mfma_f32_16x16x32_bf16 v[88:91], a[104:107], a[72:75], v[88:91]
    v_mfma_f32_16x16x32_bf16 v[92:95], a[104:107], a[76:79], v[92:95]
    ds_read_b64_tr_b16 a[104:105], v9 offset:16448
    v_mfma_f32_16x16x32_bf16 v[96:99], a[108:111], a[64:67], v[96:99]
    ds_read_b64_tr_b16 a[106:107], v9 offset:20544
    v_mfma_f32_16x16x32_bf16 v[100:103], a[108:111], a[68:71], v[100:103]
    buffer_load_dwordx4 v13, s[36:39], s58 offen offset:1024  lds
    v_mfma_f32_16x16x32_bf16 v[104:107], a[108:111], a[72:75], v[104:107]
    s_mul_i32 s59, s59, s64
    v_mfma_f32_16x16x32_bf16 v[108:111], a[108:111], a[76:79], v[108:111]
    ds_read_b64_tr_b16 a[108:109], v10 offset:16448
    v_mfma_f32_16x16x32_bf16 v[112:115], a[64:67], a[112:115], v[112:115]
    ds_read_b64_tr_b16 a[110:111], v10 offset:20544
    v_mfma_f32_16x16x32_bf16 v[116:119], a[68:71], a[112:115], v[116:119]
    v_mfma_f32_16x16x32_bf16 v[120:123], a[72:75], a[112:115], v[120:123]
    s_waitcnt lgkmcnt(14)
    v_mfma_f32_16x16x32_bf16 v[124:127], a[76:79], a[112:115], v[124:127]
    ds_read_b64_tr_b16 a[112:113], v9 offset:16512
    v_mfma_f32_16x16x32_bf16 v[128:131], a[64:67], a[116:119], v[128:131]
    ds_read_b64_tr_b16 a[114:115], v9 offset:20608
    v_mfma_f32_16x16x32_bf16 v[132:135], a[68:71], a[116:119], v[132:135]
    buffer_load_dwordx4 v14, s[36:39], s58 offen offset:2048  lds
    v_mfma_f32_16x16x32_bf16 v[136:139], a[72:75], a[116:119], v[136:139]
    s_cbranch_vccz 2
    buffer_load_dwordx4 v15, s[40:43], s58 offen offset:3072  lds
    v_mfma_f32_16x16x32_bf16 v[140:143], a[76:79], a[116:119], v[140:143]
    ds_read_b64_tr_b16 a[116:117], v10 offset:16512
    v_mfma_f32_16x16x32_bf16 v[144:147], a[120:123], a[64:67], v[144:147]
    ds_read_b64_tr_b16 a[118:119], v10 offset:20608
    v_mfma_f32_16x16x32_bf16 v[148:151], a[120:123], a[68:71], v[148:151]
    v_mfma_f32_16x16x32_bf16 v[152:155], a[120:123], a[72:75], v[152:155]
    s_add_u32 s58, s59, s57
    v_mfma_f32_16x16x32_bf16 v[156:159], a[120:123], a[76:79], v[156:159]
    ds_read_b64_tr_b16 a[120:121], v11 offset:16384
    v_mfma_f32_16x16x32_bf16 v[160:163], a[124:127], a[64:67], v[160:163]
    ds_read_b64_tr_b16 a[122:123], v11 offset:19968
    v_mfma_f32_16x16x32_bf16 v[164:167], a[124:127], a[68:71], v[164:167]
    buffer_load_dwordx4 a[48:51], v1, s[32:35], s54 offen offset:0 sc1
    v_mfma_f32_16x16x32_bf16 v[168:171], a[124:127], a[72:75], v[168:171]
    v_mfma_f32_16x16x32_bf16 v[172:175], a[124:127], a[76:79], v[172:175]
    ds_read_b64_tr_b16 a[124:125], v11 offset:16416
    v_mfma_f32_16x16x32_bf16 v[176:179], a[128:131], a[64:67], v[176:179]
    ds_read_b64_tr_b16 a[126:127], v11 offset:20000
    v_mfma_f32_16x16x32_bf16 v[180:183], a[128:131], a[68:71], v[180:183]
    s_add_u32 s52, s52, 4096
    v_mfma_f32_16x16x32_bf16 v[184:187], a[128:131], a[72:75], v[184:187]
    buffer_load_dwordx4 a[52:55], v1, s[32:35], s54 offen offset:1024 sc1
    v_mfma_f32_16x16x32_bf16 v[188:191], a[128:131], a[76:79], v[188:191]
    ds_read_b64_tr_b16 a[128:129], v11 offset:16448
    v_mfma_f32_16x16x32_bf16 v[192:195], a[132:135], a[64:67], v[192:195]
    ds_read_b64_tr_b16 a[130:131], v11 offset:20032
    v_mfma_f32_16x16x32_bf16 v[196:199], a[132:135], a[68:71], v[196:199]
    v_mfma_f32_16x16x32_bf16 v[200:203], a[132:135], a[72:75], v[200:203]
    s_waitcnt lgkmcnt(15)
    v_mfma_f32_16x16x32_bf16 v[204:207], a[132:135], a[76:79], v[204:207]
    ds_read_b64_tr_b16 a[132:133], v11 offset:16480
    v_mfma_f32_16x16x32_bf16 v[208:211], a[136:139], a[64:67], v[208:211]
    ds_read_b64_tr_b16 a[134:135], v11 offset:20064
    v_mfma_f32_16x16x32_bf16 v[212:215], a[136:139], a[68:71], v[212:215]
    buffer_load_dwordx4 a[56:59], v1, s[32:35], s54 offen offset:2048 sc1
    v_mfma_f32_16x16x32_bf16 v[216:219], a[136:139], a[72:75], v[216:219]
    buffer_load_dwordx4 a[60:63], v1, s[32:35], s54 offen offset:3072 sc1
    v_mfma_f32_16x16x32_bf16 v[220:223], a[136:139], a[76:79], v[220:223]
    ds_read_b64_tr_b16 a[136:137], v11 offset:16512
    v_mfma_f32_16x16x32_bf16 v[224:227], a[140:143], a[64:67], v[224:227]
    ds_read_b64_tr_b16 a[138:139], v11 offset:20096
    v_mfma_f32_16x16x32_bf16 v[228:231], a[140:143], a[68:71], v[228:231]
    v_mfma_f32_16x16x32_bf16 v[232:235], a[140:143], a[72:75], v[232:235]
    s_xor_b32 s54, s52, s53
    v_mfma_f32_16x16x32_bf16 v[236:239], a[140:143], a[76:79], v[236:239]
    ds_read_b64_tr_b16 a[140:141], v11 offset:16544
    v_mfma_f32_16x16x32_bf16 v[240:243], a[144:147], a[64:67], v[240:243]
    ds_read_b64_tr_b16 a[142:143], v11 offset:20128
    s_waitcnt vmcnt(25)
    v_mfma_f32_16x16x32_bf16 v[244:247], a[144:147], a[68:71], v[244:247]
    v_mfma_f32_16x16x32_bf16 v[248:251], a[144:147], a[72:75], v[248:251]
    s_waitcnt lgkmcnt(14)
    v_mfma_f32_16x16x32_bf16 v[252:255], a[144:147], a[76:79], v[252:255]
    ds_read_b64_tr_b16 a[144:145], v11 offset:16576
    ds_read_b64_tr_b16 a[146:147], v11 offset:20160
    v_mfma_f32_16x16x32_bf16 v[48:51], a[96:99], a[80:83], v[48:51]
    s_add_u32 m0, s66, 49152
    v_mfma_f32_16x16x32_bf16 v[52:55], a[96:99], a[84:87], v[52:55]
    s_add_u32 s56, s56, 1
    v_mfma_f32_16x16x32_bf16 v[56:59], a[96:99], a[88:91], v[56:59]
    v_mfma_f32_16x16x32_bf16 v[60:63], a[96:99], a[92:95], v[60:63]
    ds_read_b64_tr_b16 a[96:97], v6 offset:0
    v_mfma_f32_16x16x32_bf16 v[64:67], a[100:103], a[80:83], v[64:67]
    ds_read_b64_tr_b16 a[98:99], v6 offset:4096
    v_mfma_f32_16x16x32_bf16 v[68:71], a[100:103], a[84:87], v[68:71]
    buffer_load_dwordx4 v12, s[36:39], s58 offen offset:0  lds
    v_mfma_f32_16x16x32_bf16 v[72:75], a[100:103], a[88:91], v[72:75]
    s_xor_b32 s59, s56, s68
    v_mfma_f32_16x16x32_bf16 v[76:79], a[100:103], a[92:95], v[76:79]
    ds_read_b64_tr_b16 a[100:101], v7 offset:0
    v_mfma_f32_16x16x32_bf16 v[80:83], a[104:107], a[80:83], v[80:83]
    ds_read_b64_tr_b16 a[102:103], v7 offset:4096
    v_mfma_f32_16x16x32_bf16 v[84:87], a[104:107], a[84:87], v[84:87]
    v_mfma_f32_16x16x32_bf16 v[88:91], a[104:107], a[88:91], v[88:91]
    buffer_load_dwordx4 v13, s[36:39], s58 offen offset:1024  lds
    v_mfma_f32_16x16x32_bf16 v[92:95], a[104:107], a[92:95], v[92:95]
    ds_read_b64_tr_b16 a[104:105], v6 offset:64
    v_mfma_f32_16x16x32_bf16 v[96:99], a[108:111], a[80:83], v[96:99]
    ds_read_b64_tr_b16 a[106:107], v6 offset:4160
    v_mfma_f32_16x16x32_bf16 v[100:103], a[108:111], a[84:87], v[100:103]
    v_mfma_f32_16x16x32_bf16 v[104:107], a[108:111], a[88:91], v[104:107]
    s_mul_i32 s59, s59, s64
    v_mfma_f32_16x16x32_bf16 v[108:111], a[108:111], a[92:95], v[108:111]
    ds_read_b64_tr_b16 a[108:109], v7 offset:64
    v_mfma_f32_16x16x32_bf16 v[112:115], a[80:83], a[112:115], v[112:115]
    ds_read_b64_tr_b16 a[110:111], v7 offset:4160
    v_mfma_f32_16x16x32_bf16 v[116:119], a[84:87], a[112:115], v[116:119]
    buffer_load_dwordx4 v14, s[36:39], s58 offen offset:2048  lds
    v_mfma_f32_16x16x32_bf16 v[120:123], a[88:91], a[112:115], v[120:123]
    s_waitcnt lgkmcnt(14)
    v_mfma_f32_16x16x32_bf16 v[124:127], a[92:95], a[112:115], v[124:127]
    ds_read_b64_tr_b16 a[112:113], v6 offset:128
    v_mfma_f32_16x16x32_bf16 v[128:131], a[80:83], a[116:119], v[128:131]
    ds_read_b64_tr_b16 a[114:115], v6 offset:4224
    v_mfma_f32_16x16x32_bf16 v[132:135], a[84:87], a[116:119], v[132:135]
    v_mfma_f32_16x16x32_bf16 v[136:139], a[88:91], a[116:119], v[136:139]
    s_cbranch_vccz 2
    buffer_load_dwordx4 v15, s[40:43], s58 offen offset:3072  lds
    v_mfma_f32_16x16x32_bf16 v[140:143], a[92:95], a[116:119], v[140:143]
    ds_read_b64_tr_b16 a[116:117], v7 offset:128
    v_mfma_f32_16x16x32_bf16 v[144:147], a[120:123], a[80:83], v[144:147]
    ds_read_b64_tr_b16 a[118:119], v7 offset:4224
    v_mfma_f32_16x16x32_bf16 v[148:151], a[120:123], a[84:87], v[148:151]
    s_add_u32 s58, s59, s57
    v_mfma_f32_16x16x32_bf16 v[152:155], a[120:123], a[88:91], v[152:155]
    v_mfma_f32_16x16x32_bf16 v[156:159], a[120:123], a[92:95], v[156:159]
    ds_read_b64_tr_b16 a[120:121], v8 offset:0
    v_mfma_f32_16x16x32_bf16 v[160:163], a[124:127], a[80:83], v[160:163]
    ds_read_b64_tr_b16 a[122:123], v8 offset:3584
    v_mfma_f32_16x16x32_bf16 v[164:167], a[124:127], a[84:87], v[164:167]
    buffer_load_dwordx4 a[64:67], v1, s[32:35], s54 offen offset:0 sc1
    v_mfma_f32_16x16x32_bf16 v[168:171], a[124:127], a[88:91], v[168:171]
    v_mfma_f32_16x16x32_bf16 v[172:175], a[124:127], a[92:95], v[172:175]
    ds_read_b64_tr_b16 a[124:125], v8 offset:32
    v_mfma_f32_16x16x32_bf16 v[176:179], a[128:131], a[80:83], v[176:179]
    ds_read_b64_tr_b16 a[126:127], v8 offset:3616
    v_mfma_f32_16x16x32_bf16 v[180:183], a[128:131], a[84:87], v[180:183]
    s_add_u32 s52, s52, 4096
    v_mfma_f32_16x16x32_bf16 v[184:187], a[128:131], a[88:91], v[184:187]
    buffer_load_dwordx4 a[68:71], v1, s[32:35], s54 offen offset:1024 sc1
    v_mfma_f32_16x16x32_bf16 v[188:191], a[128:131], a[92:95], v[188:191]
    ds_read_b64_tr_b16 a[128:129], v8 offset:64
    v_mfma_f32_16x16x32_bf16 v[192:195], a[132:135], a[80:83], v[192:195]
    ds_read_b64_tr_b16 a[130:131], v8 offset:3648
    v_mfma_f32_16x16x32_bf16 v[196:199], a[132:135], a[84:87], v[196:199]
    v_mfma_f32_16x16x32_bf16 v[200:203], a[132:135], a[88:91], v[200:203]
    s_waitcnt lgkmcnt(15)
    v_mfma_f32_16x16x32_bf16 v[204:207], a[132:135], a[92:95], v[204:207]
    ds_read_b64_tr_b16 a[132:133], v8 offset:96
    v_mfma_f32_16x16x32_bf16 v[208:211], a[136:139], a[80:83], v[208:211]
    ds_read_b64_tr_b16 a[134:135], v8 offset:3680
    v_mfma_f32_16x16x32_bf16 v[212:215], a[136:139], a[84:87], v[212:215]
    buffer_load_dwordx4 a[72:75], v1, s[32:35], s54 offen offset:2048 sc1
    v_mfma_f32_16x16x32_bf16 v[216:219], a[136:139], a[88:91], v[216:219]
    buffer_load_dwordx4 a[76:79], v1, s[32:35], s54 offen offset:3072 sc1
    v_mfma_f32_16x16x32_bf16 v[220:223], a[136:139], a[92:95], v[220:223]
    ds_read_b64_tr_b16 a[136:137], v8 offset:128
    v_mfma_f32_16x16x32_bf16 v[224:227], a[140:143], a[80:83], v[224:227]
    ds_read_b64_tr_b16 a[138:139], v8 offset:3712
    v_mfma_f32_16x16x32_bf16 v[228:231], a[140:143], a[84:87], v[228:231]
    v_mfma_f32_16x16x32_bf16 v[232:235], a[140:143], a[88:91], v[232:235]
    s_xor_b32 s54, s52, s53
    v_mfma_f32_16x16x32_bf16 v[236:239], a[140:143], a[92:95], v[236:239]
    ds_read_b64_tr_b16 a[140:141], v8 offset:160
    v_mfma_f32_16x16x32_bf16 v[240:243], a[144:147], a[80:83], v[240:243]
    ds_read_b64_tr_b16 a[142:143], v8 offset:3744
    s_waitcnt vmcnt(11)
    v_mfma_f32_16x16x32_bf16 v[244:247], a[144:147], a[84:87], v[244:247]
    v_mfma_f32_16x16x32_bf16 v[248:251], a[144:147], a[88:91], v[248:251]
    s_waitcnt lgkmcnt(14)
    v_mfma_f32_16x16x32_bf16 v[252:255], a[144:147], a[92:95], v[252:255]
    ds_read_b64_tr_b16 a[144:145], v8 offset:192
    ds_read_b64_tr_b16 a[146:147], v8 offset:3776
    v_mfma_f32_16x16x32_bf16 v[48:51], a[96:99], a[0:3], v[48:51]
    s_barrier
    v_mfma_f32_16x16x32_bf16 v[52:55], a[96:99], a[4:7], v[52:55]
    s_add_u32 m0, s66, 65536
    v_mfma_f32_16x16x32_bf16 v[56:59], a[96:99], a[8:11], v[56:59]
    s_add_u32 s56, s56, 1
    v_mfma_f32_16x16x32_bf16 v[60:63], a[96:99], a[12:15], v[60:63]
    ds_read_b64_tr_b16 a[96:97], v6 offset:16384
    v_mfma_f32_16x16x32_bf16 v[64:67], a[100:103], a[0:3], v[64:67]
    ds_read_b64_tr_b16 a[98:99], v6 offset:20480
    v_mfma_f32_16x16x32_bf16 v[68:71], a[100:103], a[4:7], v[68:71]
    v_mfma_f32_16x16x32_bf16 v[72:75], a[100:103], a[8:11], v[72:75]
    buffer_load_dwordx4 v12, s[36:39], s58 offen offset:0  lds
    v_mfma_f32_16x16x32_bf16 v[76:79], a[100:103], a[12:15], v[76:79]
    ds_read_b64_tr_b16 a[100:101], v7 offset:16384
    v_mfma_f32_16x16x32_bf16 v[80:83], a[104:107], a[0:3], v[80:83]
    ds_read_b64_tr_b16 a[102:103], v7 offset:20480
    v_mfma_f32_16x16x32_bf16 v[84:87], a[104:107], a[4:7], v[84:87]
    s_xor_b32 s59, s56, s68
    v_mfma_f32_16x16x32_bf16 v[88:91], a[104:107], a[8:11], v[88:91]
    v_mfma_f32_16x16x32_bf16 v[92:95], a[104:107], a[12:15], v[92:95]
    ds_read_b64_tr_b16 a[104:105], v6 offset:16448
    v_mfma_f32_16x16x32_bf16 v[96:99], a[108:111], a[0:3], v[96:99]
    ds_read_b64_tr_b16 a[106:107], v6 offset:20544
    v_mfma_f32_16x16x32_bf16 v[100:103], a[108:111], a[4:7], v[100:103]
    buffer_load_dwordx4 v13, s[36:39], s58 offen offset:1024  lds
    v_mfma_f32_16x16x32_bf16 v[104:107], a[108:111], a[8:11], v[104:107]
    s_mul_i32 s59, s59, s64
    v_mfma_f32_16x16x32_bf16 v[108:111], a[108:111], a[12:15], v[108:111]
    ds_read_b64_tr_b16 a[108:109], v7 offset:16448
    v_mfma_f32_16x16x32_bf16 v[112:115], a[0:3], a[112:115], v[112:115]
    ds_read_b64_tr_b16 a[110:111], v7 offset:20544
    v_mfma_f32_16x16x32_bf16 v[116:119], a[4:7], a[112:115], v[116:119]
    v_mfma_f32_16x16x32_bf16 v[120:123], a[8:11], a[112:115], v[120:123]
    s_waitcnt lgkmcnt(14)
    v_mfma_f32_16x16x32_bf16 v[124:127], a[12:15], a[112:115], v[124:127]
    ds_read_b64_tr_b16 a[112:113], v6 offset:16512
    v_mfma_f32_16x16x32_bf16 v[128:131], a[0:3], a[116:119], v[128:131]
    ds_read_b64_tr_b16 a[114:115], v6 offset:20608
    v_mfma_f32_16x16x32_bf16 v[132:135], a[4:7], a[116:119], v[132:135]
    buffer_load_dwordx4 v14, s[36:39], s58 offen offset:2048  lds
    v_mfma_f32_16x16x32_bf16 v[136:139], a[8:11], a[116:119], v[136:139]
    s_cbranch_vccz 2
    buffer_load_dwordx4 v15, s[40:43], s58 offen offset:3072  lds
    v_mfma_f32_16x16x32_bf16 v[140:143], a[12:15], a[116:119], v[140:143]
    ds_read_b64_tr_b16 a[116:117], v7 offset:16512
    v_mfma_f32_16x16x32_bf16 v[144:147], a[120:123], a[0:3], v[144:147]
    ds_read_b64_tr_b16 a[118:119], v7 offset:20608
    v_mfma_f32_16x16x32_bf16 v[148:151], a[120:123], a[4:7], v[148:151]
    v_mfma_f32_16x16x32_bf16 v[152:155], a[120:123], a[8:11], v[152:155]
    s_add_u32 s58, s59, s57
    v_mfma_f32_16x16x32_bf16 v[156:159], a[120:123], a[12:15], v[156:159]
    ds_read_b64_tr_b16 a[120:121], v8 offset:16384
    v_mfma_f32_16x16x32_bf16 v[160:163], a[124:127], a[0:3], v[160:163]
    ds_read_b64_tr_b16 a[122:123], v8 offset:19968
    v_mfma_f32_16x16x32_bf16 v[164:167], a[124:127], a[4:7], v[164:167]
    buffer_load_dwordx4 a[80:83], v1, s[32:35], s54 offen offset:0 sc1
    v_mfma_f32_16x16x32_bf16 v[168:171], a[124:127], a[8:11], v[168:171]
    v_mfma_f32_16x16x32_bf16 v[172:175], a[124:127], a[12:15], v[172:175]
    ds_read_b64_tr_b16 a[124:125], v8 offset:16416
    v_mfma_f32_16x16x32_bf16 v[176:179], a[128:131], a[0:3], v[176:179]
    ds_read_b64_tr_b16 a[126:127], v8 offset:20000
    v_mfma_f32_16x16x32_bf16 v[180:183], a[128:131], a[4:7], v[180:183]
    s_add_u32 s52, s52, 4096
    v_mfma_f32_16x16x32_bf16 v[184:187], a[128:131], a[8:11], v[184:187]
    buffer_load_dwordx4 a[84:87], v1, s[32:35], s54 offen offset:1024 sc1
    v_mfma_f32_16x16x32_bf16 v[188:191], a[128:131], a[12:15], v[188:191]
    ds_read_b64_tr_b16 a[128:129], v8 offset:16448
    v_mfma_f32_16x16x32_bf16 v[192:195], a[132:135], a[0:3], v[192:195]
    ds_read_b64_tr_b16 a[130:131], v8 offset:20032
    v_mfma_f32_16x16x32_bf16 v[196:199], a[132:135], a[4:7], v[196:199]
    v_mfma_f32_16x16x32_bf16 v[200:203], a[132:135], a[8:11], v[200:203]
    s_waitcnt lgkmcnt(15)
    v_mfma_f32_16x16x32_bf16 v[204:207], a[132:135], a[12:15], v[204:207]
    ds_read_b64_tr_b16 a[132:133], v8 offset:16480
    v_mfma_f32_16x16x32_bf16 v[208:211], a[136:139], a[0:3], v[208:211]
    ds_read_b64_tr_b16 a[134:135], v8 offset:20064
    v_mfma_f32_16x16x32_bf16 v[212:215], a[136:139], a[4:7], v[212:215]
    buffer_load_dwordx4 a[88:91], v1, s[32:35], s54 offen offset:2048 sc1
    v_mfma_f32_16x16x32_bf16 v[216:219], a[136:139], a[8:11], v[216:219]
    buffer_load_dwordx4 a[92:95], v1, s[32:35], s54 offen offset:3072 sc1
    v_mfma_f32_16x16x32_bf16 v[220:223], a[136:139], a[12:15], v[220:223]
    ds_read_b64_tr_b16 a[136:137], v8 offset:16512
    v_mfma_f32_16x16x32_bf16 v[224:227], a[140:143], a[0:3], v[224:227]
    ds_read_b64_tr_b16 a[138:139], v8 offset:20096
    v_mfma_f32_16x16x32_bf16 v[228:231], a[140:143], a[4:7], v[228:231]
    v_mfma_f32_16x16x32_bf16 v[232:235], a[140:143], a[8:11], v[232:235]
    s_xor_b32 s54, s52, s53
    v_mfma_f32_16x16x32_bf16 v[236:239], a[140:143], a[12:15], v[236:239]
    ds_read_b64_tr_b16 a[140:141], v8 offset:16544
    v_mfma_f32_16x16x32_bf16 v[240:243], a[144:147], a[0:3], v[240:243]
    ds_read_b64_tr_b16 a[142:143], v8 offset:20128
    s_waitcnt vmcnt(28)
    v_mfma_f32_16x16x32_bf16 v[244:247], a[144:147], a[4:7], v[244:247]
    v_mfma_f32_16x16x32_bf16 v[248:251], a[144:147], a[8:11], v[248:251]
    s_waitcnt lgkmcnt(14)
    v_mfma_f32_16x16x32_bf16 v[252:255], a[144:147], a[12:15], v[252:255]
    ds_read_b64_tr_b16 a[144:145], v8 offset:16576
    ds_read_b64_tr_b16 a[146:147], v8 offset:20160
    v_mfma_f32_16x16x32_bf16 v[48:51], a[96:99], a[16:19], v[48:51]
    s_add_u32 m0, s66, 81920
    v_mfma_f32_16x16x32_bf16 v[52:55], a[96:99], a[20:23], v[52:55]
    s_add_u32 s56, s56, 1
    v_mfma_f32_16x16x32_bf16 v[56:59], a[96:99], a[24:27], v[56:59]
    v_mfma_f32_16x16x32_bf16 v[60:63], a[96:99], a[28:31], v[60:63]
    ds_read_b64_tr_b16 a[96:97], v6 offset:32768
    v_mfma_f32_16x16x32_bf16 v[64:67], a[100:103], a[16:19], v[64:67]
    ds_read_b64_tr_b16 a[98:99], v6 offset:36864
    v_mfma_f32_16x16x32_bf16 v[68:71], a[100:103], a[20:23], v[68:71]
    buffer_load_dwordx4 v12, s[36:39], s58 offen offset:0  lds
    v_mfma_f32_16x16x32_bf16 v[72:75], a[100:103], a[24:27], v[72:75]
    s_xor_b32 s59, s56, s68
    v_mfma_f32_16x16x32_bf16 v[76:79], a[100:103], a[28:31], v[76:79]
    ds_read_b64_tr_b16 a[100:101], v7 offset:32768
    v_mfma_f32_16x16x32_bf16 v[80:83], a[104:107], a[16:19], v[80:83]
    ds_read_b64_tr_b16 a[102:103], v7 offset:36864
    v_mfma_f32_16x16x32_bf16 v[84:87], a[104:107], a[20:23], v[84:87]
    v_mfma_f32_16x16x32_bf16 v[88:91], a[104:107], a[24:27], v[88:91]
    buffer_load_dwordx4 v13, s[36:39], s58 offen offset:1024  lds
    v_mfma_f32_16x16x32_bf16 v[92:95], a[104:107], a[28:31], v[92:95]
    ds_read_b64_tr_b16 a[104:105], v6 offset:32832
    v_mfma_f32_16x16x32_bf16 v[96:99], a[108:111], a[16:19], v[96:99]
    ds_read_b64_tr_b16 a[106:107], v6 offset:36928
    v_mfma_f32_16x16x32_bf16 v[100:103], a[108:111], a[20:23], v[100:103]
    v_mfma_f32_16x16x32_bf16 v[104:107], a[108:111], a[24:27], v[104:107]
    s_mul_i32 s59, s59, s64
    v_mfma_f32_16x16x32_bf16 v[108:111], a[108:111], a[28:31], v[108:111]
    ds_read_b64_tr_b16 a[108:109], v7 offset:32832
    v_mfma_f32_16x16x32_bf16 v[112:115], a[16:19], a[112:115], v[112:115]
    ds_read_b64_tr_b16 a[110:111], v7 offset:36928
    v_mfma_f32_16x16x32_bf16 v[116:119], a[20:23], a[112:115], v[116:119]
    buffer_load_dwordx4 v14, s[36:39], s58 offen offset:2048  lds
    v_mfma_f32_16x16x32_bf16 v[120:123], a[24:27], a[112:115], v[120:123]
    s_waitcnt lgkmcnt(14)
    v_mfma_f32_16x16x32_bf16 v[124:127], a[28:31], a[112:115], v[124:127]
    ds_read_b64_tr_b16 a[112:113], v6 offset:32896
    v_mfma_f32_16x16x32_bf16 v[128:131], a[16:19], a[116:119], v[128:131]
    ds_read_b64_tr_b16 a[114:115], v6 offset:36992
    v_mfma_f32_16x16x32_bf16 v[132:135], a[20:23], a[116:119], v[132:135]
    v_mfma_f32_16x16x32_bf16 v[136:139], a[24:27], a[116:119], v[136:139]
    s_cbranch_vccz 2
    buffer_load_dwordx4 v15, s[40:43], s58 offen offset:3072  lds
    v_mfma_f32_16x16x32_bf16 v[140:143], a[28:31], a[116:119], v[140:143]
    ds_read_b64_tr_b16 a[116:117], v7 offset:32896
    v_mfma_f32_16x16x32_bf16 v[144:147], a[120:123], a[16:19], v[144:147]
    ds_read_b64_tr_b16 a[118:119], v7 offset:36992
    v_mfma_f32_16x16x32_bf16 v[148:151], a[120:123], a[20:23], v[148:151]
    s_add_u32 s58, s59, s57
    v_mfma_f32_16x16x32_bf16 v[152:155], a[120:123], a[24:27], v[152:155]
    v_mfma_f32_16x16x32_bf16 v[156:159], a[120:123], a[28:31], v[156:159]
    ds_read_b64_tr_b16 a[120:121], v8 offset:32768
    v_mfma_f32_16x16x32_bf16 v[160:163], a[124:127], a[16:19], v[160:163]
    ds_read_b64_tr_b16 a[122:123], v8 offset:36352
    v_mfma_f32_16x16x32_bf16 v[164:167], a[124:127], a[20:23], v[164:167]
    buffer_load_dwordx4 a[0:3], v1, s[32:35], s54 offen offset:0 sc1
    v_mfma_f32_16x16x32_bf16 v[168:171], a[124:127], a[24:27], v[168:171]
    v_mfma_f32_16x16x32_bf16 v[172:175], a[124:127], a[28:31], v[172:175]
    ds_read_b64_tr_b16 a[124:125], v8 offset:32800
    v_mfma_f32_16x16x32_bf16 v[176:179], a[128:131], a[16:19], v[176:179]
    ds_read_b64_tr_b16 a[126:127], v8 offset:36384
    v_mfma_f32_16x16x32_bf16 v[180:183], a[128:131], a[20:23], v[180:183]
    s_add_u32 s52, s52, 4096
    v_mfma_f32_16x16x32_bf16 v[184:187], a[128:131], a[24:27], v[184:187]
    buffer_load_dwordx4 a[4:7], v1, s[32:35], s54 offen offset:1024 sc1
    v_mfma_f32_16x16x32_bf16 v[188:191], a[128:131], a[28:31], v[188:191]
    ds_read_b64_tr_b16 a[128:129], v8 offset:32832
    v_mfma_f32_16x16x32_bf16 v[192:195], a[132:135], a[16:19], v[192:195]
    ds_read_b64_tr_b16 a[130:131], v8 offset:36416
    v_mfma_f32_16x16x32_bf16 v[196:199], a[132:135], a[20:23], v[196:199]
    v_mfma_f32_16x16x32_bf16 v[200:203], a[132:135], a[24:27], v[200:203]
    s_waitcnt lgkmcnt(15)
    v_mfma_f32_16x16x32_bf16 v[204:207], a[132:135], a[28:31], v[204:207]
    ds_read_b64_tr_b16 a[132:133], v8 offset:32864
    v_mfma_f32_16x16x32_bf16 v[208:211], a[136:139], a[16:19], v[208:211]
    ds_read_b64_tr_b16 a[134:135], v8 offset:36448
    v_mfma_f32_16x16x32_bf16 v[212:215], a[136:139], a[20:23], v[212:215]
    buffer_load_dwordx4 a[8:11], v1, s[32:35], s54 offen offset:2048 sc1
    v_mfma_f32_16x16x32_bf16 v[216:219], a[136:139], a[24:27], v[216:219]
    buffer_load_dwordx4 a[12:15], v1, s[32:35], s54 offen offset:3072 sc1
    v_mfma_f32_16x16x32_bf16 v[220:223], a[136:139], a[28:31], v[220:223]
    ds_read_b64_tr_b16 a[136:137], v8 offset:32896
    v_mfma_f32_16x16x32_bf16 v[224:227], a[140:143], a[16:19], v[224:227]
    ds_read_b64_tr_b16 a[138:139], v8 offset:36480
    v_mfma_f32_16x16x32_bf16 v[228:231], a[140:143], a[20:23], v[228:231]
    v_mfma_f32_16x16x32_bf16 v[232:235], a[140:143], a[24:27], v[232:235]
    s_xor_b32 s54, s52, s53
    v_mfma_f32_16x16x32_bf16 v[236:239], a[140:143], a[28:31], v[236:239]
    ds_read_b64_tr_b16 a[140:141], v8 offset:32928
    v_mfma_f32_16x16x32_bf16 v[240:243], a[144:147], a[16:19], v[240:243]
    ds_read_b64_tr_b16 a[142:143], v8 offset:36512
    s_waitcnt vmcnt(11)
    v_mfma_f32_16x16x32_bf16 v[244:247], a[144:147], a[20:23], v[244:247]
    v_mfma_f32_16x16x32_bf16 v[248:251], a[144:147], a[24:27], v[248:251]
    s_waitcnt lgkmcnt(14)
    v_mfma_f32_16x16x32_bf16 v[252:255], a[144:147], a[28:31], v[252:255]
    ds_read_b64_tr_b16 a[144:145], v8 offset:32960
    ds_read_b64_tr_b16 a[146:147], v8 offset:36544
    v_mfma_f32_16x16x32_bf16 v[48:51], a[96:99], a[32:35], v[48:51]
    s_barrier
    v_mfma_f32_16x16x32_bf16 v[52:55], a[96:99], a[36:39], v[52:55]
    s_add_u32 m0, s66, 0
    v_mfma_f32_16x16x32_bf16 v[56:59], a[96:99], a[40:43], v[56:59]
    s_add_u32 s56, s56, 1
    v_mfma_f32_16x16x32_bf16 v[60:63], a[96:99], a[44:47], v[60:63]
    ds_read_b64_tr_b16 a[96:97], v6 offset:49152
    v_mfma_f32_16x16x32_bf16 v[64:67], a[100:103], a[32:35], v[64:67]
    ds_read_b64_tr_b16 a[98:99], v6 offset:53248
    v_mfma_f32_16x16x32_bf16 v[68:71], a[100:103], a[36:39], v[68:71]
    v_mfma_f32_16x16x32_bf16 v[72:75], a[100:103], a[40:43], v[72:75]
    buffer_load_dwordx4 v12, s[36:39], s58 offen offset:0  lds
    v_mfma_f32_16x16x32_bf16 v[76:79], a[100:103], a[44:47], v[76:79]
    ds_read_b64_tr_b16 a[100:101], v7 offset:49152
    v_mfma_f32_16x16x32_bf16 v[80:83], a[104:107], a[32:35], v[80:83]
    ds_read_b64_tr_b16 a[102:103], v7 offset:53248
    v_mfma_f32_16x16x32_bf16 v[84:87], a[104:107], a[36:39], v[84:87]
    s_xor_b32 s59, s56, s68
    v_mfma_f32_16x16x32_bf16 v[88:91], a[104:107], a[40:43], v[88:91]
    v_mfma_f32_16x16x32_bf16 v[92:95], a[104:107], a[44:47], v[92:95]
    ds_read_b64_tr_b16 a[104:105], v6 offset:49216
    v_mfma_f32_16x16x32_bf16 v[96:99], a[108:111], a[32:35], v[96:99]
    ds_read_b64_tr_b16 a[106:107], v6 offset:53312
    v_mfma_f32_16x16x32_bf16 v[100:103], a[108:111], a[36:39], v[100:103]
    buffer_load_dwordx4 v13, s[36:39], s58 offen offset:1024  lds
    v_mfma_f32_16x16x32_bf16 v[104:107], a[108:111], a[40:43], v[104:107]
    s_mul_i32 s59, s59, s64
    v_mfma_f32_16x16x32_bf16 v[108:111], a[108:111], a[44:47], v[108:111]
    ds_read_b64_tr_b16 a[108:109], v7 offset:49216
    v_mfma_f32_16x16x32_bf16 v[112:115], a[32:35], a[112:115], v[112:115]
    ds_read_b64_tr_b16 a[110:111], v7 offset:53312
    v_mfma_f32_16x16x32_bf16 v[116:119], a[36:39], a[112:115], v[116:119]
    v_mfma_f32_16x16x32_bf16 v[120:123], a[40:43], a[112:115], v[120:123]
    s_waitcnt lgkmcnt(14)
    v_mfma_f32_16x16x32_bf16 v[124:127], a[44:47], a[112:115], v[124:127]
    ds_read_b64_tr_b16 a[112:113], v6 offset:49280
    v_mfma_f32_16x16x32_bf16 v[128:131], a[32:35], a[116:119], v[128:131]
    ds_read_b64_tr_b16 a[114:115], v6 offset:53376
    v_mfma_f32_16x16x32_bf16 v[132:135], a[36:39], a[116:119], v[132:135]
    buffer_load_dwordx4 v14, s[36:39], s58 offen offset:2048  lds
    v_mfma_f32_16x16x32_bf16 v[136:139], a[40:43], a[116:119], v[136:139]
    s_cbranch_vccz 2
    buffer_load_dwordx4 v15, s[40:43], s58 offen offset:3072  lds
    v_mfma_f32_16x16x32_bf16 v[140:143], a[44:47], a[116:119], v[140:143]
    ds_read_b64_tr_b16 a[116:117], v7 offset:49280
    v_mfma_f32_16x16x32_bf16 v[144:147], a[120:123], a[32:35], v[144:147]
    ds_read_b64_tr_b16 a[118:119], v7 offset:53376
    v_mfma_f32_16x16x32_bf16 v[148:151], a[120:123], a[36:39], v[148:151]
    v_mfma_f32_16x16x32_bf16 v[152:155], a[120:123], a[40:43], v[152:155]
    s_add_u32 s58, s59, s57
    v_mfma_f32_16x16x32_bf16 v[156:159], a[120:123], a[44:47], v[156:159]
    ds_read_b64_tr_b16 a[120:121], v8 offset:49152
    v_mfma_f32_16x16x32_bf16 v[160:163], a[124:127], a[32:35], v[160:163]
    ds_read_b64_tr_b16 a[122:123], v8 offset:52736
    v_mfma_f32_16x16x32_bf16 v[164:167], a[124:127], a[36:39], v[164:167]
    buffer_load_dwordx4 a[16:19], v1, s[32:35], s54 offen offset:0 sc1
    v_mfma_f32_16x16x32_bf16 v[168:171], a[124:127], a[40:43], v[168:171]
    v_mfma_f32_16x16x32_bf16 v[172:175], a[124:127], a[44:47], v[172:175]
    ds_read_b64_tr_b16 a[124:125], v8 offset:49184
    v_mfma_f32_16x16x32_bf16 v[176:179], a[128:131], a[32:35], v[176:179]
    ds_read_b64_tr_b16 a[126:127], v8 offset:52768
    v_mfma_f32_16x16x32_bf16 v[180:183], a[128:131], a[36:39], v[180:183]
    s_add_u32 s52, s52, 4096
    v_mfma_f32_16x16x32_bf16 v[184:187], a[128:131], a[40:43], v[184:187]
    buffer_load_dwordx4 a[20:23], v1, s[32:35], s54 offen offset:1024 sc1
    v_mfma_f32_16x16x32_bf16 v[188:191], a[128:131], a[44:47], v[188:191]
    ds_read_b64_tr_b16 a[128:129], v8 offset:49216
    v_mfma_f32_16x16x32_bf16 v[192:195], a[132:135], a[32:35], v[192:195]
    ds_read_b64_tr_b16 a[130:131], v8 offset:52800
    v_mfma_f32_16x16x32_bf16 v[196:199], a[132:135], a[36:39], v[196:199]
    v_mfma_f32_16x16x32_bf16 v[200:203], a[132:135], a[40:43], v[200:203]
    s_waitcnt lgkmcnt(15)
    v_mfma_f32_16x16x32_bf16 v[204:207], a[132:135], a[44:47], v[204:207]
    ds_read_b64_tr_b16 a[132:133], v8 offset:49248
    v_mfma_f32_16x16x32_bf16 v[208:211], a[136:139], a[32:35], v[208:211]
    ds_read_b64_tr_b16 a[134:135], v8 offset:52832
    v_mfma_f32_16x16x32_bf16 v[212:215], a[136:139], a[36:39], v[212:215]
    buffer_load_dwordx4 a[24:27], v1, s[32:35], s54 offen offset:2048 sc1
    v_mfma_f32_16x16x32_bf16 v[216:219], a[136:139], a[40:43], v[216:219]
    buffer_load_dwordx4 a[28:31], v1, s[32:35], s54 offen offset:3072 sc1
    v_mfma_f32_16x16x32_bf16 v[220:223], a[136:139], a[44:47], v[220:223]
    ds_read_b64_tr_b16 a[136:137], v8 offset:49280
    v_mfma_f32_16x16x32_bf16 v[224:227], a[140:143], a[32:35], v[224:227]
    ds_read_b64_tr_b16 a[138:139], v8 offset:52864
    v_mfma_f32_16x16x32_bf16 v[228:231], a[140:143], a[36:39], v[228:231]
    v_mfma_f32_16x16x32_bf16 v[232:235], a[140:143], a[40:43], v[232:235]
    s_xor_b32 s54, s52, s53
    v_mfma_f32_16x16x32_bf16 v[236:239], a[140:143], a[44:47], v[236:239]
    ds_read_b64_tr_b16 a[140:141], v8 offset:49312
    v_mfma_f32_16x16x32_bf16 v[240:243], a[144:147], a[32:35], v[240:243]
    ds_read_b64_tr_b16 a[142:143], v8 offset:52896
    s_waitcnt vmcnt(28)
    v_mfma_f32_16x16x32_bf16 v[244:247], a[144:147], a[36:39], v[244:247]
    v_mfma_f32_16x16x32_bf16 v[248:251], a[144:147], a[40:43], v[248:251]
    s_waitcnt lgkmcnt(14)
    v_mfma_f32_16x16x32_bf16 v[252:255], a[144:147], a[44:47], v[252:255]
    ds_read_b64_tr_b16 a[144:145], v8 offset:49344
    ds_read_b64_tr_b16 a[146:147], v8 offset:52928
    v_mfma_f32_16x16x32_bf16 v[48:51], a[96:99], a[48:51], v[48:51]
    s_add_u32 m0, s66, 16384
    v_mfma_f32_16x16x32_bf16 v[52:55], a[96:99], a[52:55], v[52:55]
    s_add_u32 s56, s56, 1
    v_mfma_f32_16x16x32_bf16 v[56:59], a[96:99], a[56:59], v[56:59]
    v_mfma_f32_16x16x32_bf16 v[60:63], a[96:99], a[60:63], v[60:63]
    ds_read_b64_tr_b16 a[96:97], v9 offset:0
    v_mfma_f32_16x16x32_bf16 v[64:67], a[100:103], a[48:51], v[64:67]
    ds_read_b64_tr_b16 a[98:99], v9 offset:4096
    v_mfma_f32_16x16x32_bf16 v[68:71], a[100:103], a[52:55], v[68:71]
    buffer_load_dwordx4 v12, s[36:39], s58 offen offset:0  lds
    v_mfma_f32_16x16x32_bf16 v[72:75], a[100:103], a[56:59], v[72:75]
    s_xor_b32 s59, s56, s68
    v_mfma_f32_16x16x32_bf16 v[76:79], a[100:103], a[60:63], v[76:79]
    ds_read_b64_tr_b16 a[100:101], v10 offset:0
    v_mfma_f32_16x16x32_bf16 v[80:83], a[104:107], a[48:51], v[80:83]
    ds_read_b64_tr_b16 a[102:103], v10 offset:4096
    v_mfma_f32_16x16x32_bf16 v[84:87], a[104:107], a[52:55], v[84:87]
    v_mfma_f32_16x16x32_bf16 v[88:91], a[104:107], a[56:59], v[88:91]
    buffer_load_dwordx4 v13, s[36:39], s58 offen offset:1024  lds
    v_mfma_f32_16x16x32_bf16 v[92:95], a[104:107], a[60:63], v[92:95]
    ds_read_b64_tr_b16 a[104:105], v9 offset:64
    v_mfma_f32_16x16x32_bf16 v[96:99], a[108:111], a[48:51], v[96:99]
    ds_read_b64_tr_b16 a[106:107], v9 offset:4160
    v_mfma_f32_16x16x32_bf16 v[100:103], a[108:111], a[52:55], v[100:103]
    v_mfma_f32_16x16x32_bf16 v[104:107], a[108:111], a[56:59], v[104:107]
    s_mul_i32 s59, s59, s64
    v_mfma_f32_16x16x32_bf16 v[108:111], a[108:111], a[60:63], v[108:111]
    ds_read_b64_tr_b16 a[108:109], v10 offset:64
    v_mfma_f32_16x16x32_bf16 v[112:115], a[48:51], a[112:115], v[112:115]
    ds_read_b64_tr_b16 a[110:111], v10 offset:4160
    v_mfma_f32_16x16x32_bf16 v[116:119], a[52:55], a[112:115], v[116:119]
    buffer_load_dwordx4 v14, s[36:39], s58 offen offset:2048  lds
    v_mfma_f32_16x16x32_bf16 v[120:123], a[56:59], a[112:115], v[120:123]
    s_waitcnt lgkmcnt(14)
    v_mfma_f32_16x16x32_bf16 v[124:127], a[60:63], a[112:115], v[124:127]
    ds_read_b64_tr_b16 a[112:113], v9 offset:128
    v_mfma_f32_16x16x32_bf16 v[128:131], a[48:51], a[116:119], v[128:131]
    ds_read_b64_tr_b16 a[114:115], v9 offset:4224
    v_mfma_f32_16x16x32_bf16 v[132:135], a[52:55], a[116:119], v[132:135]
    v_mfma_f32_16x16x32_bf16 v[136:139], a[56:59], a[116:119], v[136:139]
    s_cbranch_vccz 2
    buffer_load_dwordx4 v15, s[40:43], s58 offen offset:3072  lds
    v_mfma_f32_16x16x32_bf16 v[140:143], a[60:63], a[116:119], v[140:143]
    ds_read_b64_tr_b16 a[116:117], v10 offset:128
    v_mfma_f32_16x16x32_bf16 v[144:147], a[120:123], a[48:51], v[144:147]
    ds_read_b64_tr_b16 a[118:119], v10 offset:4224
    v_mfma_f32_16x16x32_bf16 v[148:151], a[120:123], a[52:55], v[148:151]
    s_add_u32 s58, s59, s57
    v_mfma_f32_16x16x32_bf16 v[152:155], a[120:123], a[56:59], v[152:155]
    v_mfma_f32_16x16x32_bf16 v[156:159], a[120:123], a[60:63], v[156:159]
    ds_read_b64_tr_b16 a[120:121], v11 offset:0
    v_mfma_f32_16x16x32_bf16 v[160:163], a[124:127], a[48:51], v[160:163]
    ds_read_b64_tr_b16 a[122:123], v11 offset:3584
    v_mfma_f32_16x16x32_bf16 v[164:167], a[124:127], a[52:55], v[164:167]
    buffer_load_dwordx4 a[32:35], v1, s[32:35], s54 offen offset:0 sc1
    v_mfma_f32_16x16x32_bf16 v[168:171], a[124:127], a[56:59], v[168:171]
    v_mfma_f32_16x16x32_bf16 v[172:175], a[124:127], a[60:63], v[172:175]
    ds_read_b64_tr_b16 a[124:125], v11 offset:32
    v_mfma_f32_16x16x32_bf16 v[176:179], a[128:131], a[48:51], v[176:179]
    ds_read_b64_tr_b16 a[126:127], v11 offset:3616
    v_mfma_f32_16x16x32_bf16 v[180:183], a[128:131], a[52:55], v[180:183]
    s_add_u32 s52, s52, 4096
    v_mfma_f32_16x16x32_bf16 v[184:187], a[128:131], a[56:59], v[184:187]
    buffer_load_dwordx4 a[36:39], v1, s[32:35], s54 offen offset:1024 sc1
    v_mfma_f32_16x16x32_bf16 v[188:191], a[128:131], a[60:63], v[188:191]
    ds_read_b64_tr_b16 a[128:129], v11 offset:64
    v_mfma_f32_16x16x32_bf16 v[192:195], a[132:135], a[48:51], v[192:195]
    ds_read_b64_tr_b16 a[130:131], v11 offset:3648
    v_mfma_f32_16x16x32_bf16 v[196:199], a[132:135], a[52:55], v[196:199]
    v_mfma_f32_16x16x32_bf16 v[200:203], a[132:135], a[56:59], v[200:203]
    s_waitcnt lgkmcnt(15)
    v_mfma_f32_16x16x32_bf16 v[204:207], a[132:135], a[60:63], v[204:207]
    ds_read_b64_tr_b16 a[132:133], v11 offset:96
    v_mfma_f32_16x16x32_bf16 v[208:211], a[136:139], a[48:51], v[208:211]
    ds_read_b64_tr_b16 a[134:135], v11 offset:3680
    v_mfma_f32_16x16x32_bf16 v[212:215], a[136:139], a[52:55], v[212:215]
    buffer_load_dwordx4 a[40:43], v1, s[32:35], s54 offen offset:2048 sc1
    v_mfma_f32_16x16x32_bf16 v[216:219], a[136:139], a[56:59], v[216:219]
    buffer_load_dwordx4 a[44:47], v1, s[32:35], s54 offen offset:3072 sc1
    v_mfma_f32_16x16x32_bf16 v[220:223], a[136:139], a[60:63], v[220:223]
    ds_read_b64_tr_b16 a[136:137], v11 offset:128
    v_mfma_f32_16x16x32_bf16 v[224:227], a[140:143], a[48:51], v[224:227]
    ds_read_b64_tr_b16 a[138:139], v11 offset:3712
    v_mfma_f32_16x16x32_bf16 v[228:231], a[140:143], a[52:55], v[228:231]
    v_mfma_f32_16x16x32_bf16 v[232:235], a[140:143], a[56:59], v[232:235]
    s_xor_b32 s54, s52, s53
    v_mfma_f32_16x16x32_bf16 v[236:239], a[140:143], a[60:63], v[236:239]
    ds_read_b64_tr_b16 a[140:141], v11 offset:160
    v_mfma_f32_16x16x32_bf16 v[240:243], a[144:147], a[48:51], v[240:243]
    ds_read_b64_tr_b16 a[142:143], v11 offset:3744
    s_waitcnt vmcnt(11)
    v_mfma_f32_16x16x32_bf16 v[244:247], a[144:147], a[52:55], v[244:247]
    v_mfma_f32_16x16x32_bf16 v[248:251], a[144:147], a[56:59], v[248:251]
    s_waitcnt lgkmcnt(14)
    v_mfma_f32_16x16x32_bf16 v[252:255], a[144:147], a[60:63], v[252:255]
    ds_read_b64_tr_b16 a[144:145], v11 offset:192
    ds_read_b64_tr_b16 a[146:147], v11 offset:3776
    v_mfma_f32_16x16x32_bf16 v[48:51], a[96:99], a[64:67], v[48:51]
    s_barrier
    v_mfma_f32_16x16x32_bf16 v[52:55], a[96:99], a[68:71], v[52:55]
    s_add_u32 m0, s66, 32768
    v_mfma_f32_16x16x32_bf16 v[56:59], a[96:99], a[72:75], v[56:59]
    s_add_u32 s56, s56, 1
    v_mfma_f32_16x16x32_bf16 v[60:63], a[96:99], a[76:79], v[60:63]
    ds_read_b64_tr_b16 a[96:97], v9 offset:16384
    v_mfma_f32_16x16x32_bf16 v[64:67], a[100:103], a[64:67], v[64:67]
    ds_read_b64_tr_b16 a[98:99], v9 offset:20480
    v_mfma_f32_16x16x32_bf16 v[68:71], a[100:103], a[68:71], v[68:71]
    v_mfma_f32_16x16x32_bf16 v[72:75], a[100:103], a[72:75], v[72:75]
    buffer_load_dwordx4 v12, s[36:39], s58 offen offset:0  lds
    v_mfma_f32_16x16x32_bf16 v[76:79], a[100:103], a[76:79], v[76:79]
    ds_read_b64_tr_b16 a[100:101], v10 offset:16384
    v_mfma_f32_16x16x32_bf16 v[80:83], a[104:107], a[64:67], v[80:83]
    ds_read_b64_tr_b16 a[102:103], v10 offset:20480
    v_mfma_f32_16x16x32_bf16 v[84:87], a[104:107], a[68:71], v[84:87]
    s_xor_b32 s59, s56, s68
    v_mfma_f32_16x16x32_bf16 v[88:91], a[104:107], a[72:75], v[88:91]
    v_mfma_f32_16x16x32_bf16 v[92:95], a[104:107], a[76:79], v[92:95]
    ds_read_b64_tr_b16 a[104:105], v9 offset:16448
    v_mfma_f32_16x16x32_bf16 v[96:99], a[108:111], a[64:67], v[96:99]
    ds_read_b64_tr_b16 a[106:107], v9 offset:20544
    v_mfma_f32_16x16x32_bf16 v[100:103], a[108:111], a[68:71], v[100:103]
    buffer_load_dwordx4 v13, s[36:39], s58 offen offset:1024  lds
    v_mfma_f32_16x16x32_bf16 v[104:107], a[108:111], a[72:75], v[104:107]
    s_mul_i32 s59, s59, s64
    v_mfma_f32_16x16x32_bf16 v[108:111], a[108:111], a[76:79], v[108:111]
    ds_read_b64_tr_b16 a[108:109], v10 offset:16448
    v_mfma_f32_16x16x32_bf16 v[112:115], a[64:67], a[112:115], v[112:115]
    ds_read_b64_tr_b16 a[110:111], v10 offset:20544
    v_mfma_f32_16x16x32_bf16 v[116:119], a[68:71], a[112:115], v[116:119]
    v_mfma_f32_16x16x32_bf16 v[120:123], a[72:75], a[112:115], v[120:123]
    s_waitcnt lgkmcnt(14)
    v_mfma_f32_16x16x32_bf16 v[124:127], a[76:79], a[112:115], v[124:127]
    ds_read_b64_tr_b16 a[112:113], v9 offset:16512
    v_mfma_f32_16x16x32_bf16 v[128:131], a[64:67], a[116:119], v[128:131]
    ds_read_b64_tr_b16 a[114:115], v9 offset:20608
    v_mfma_f32_16x16x32_bf16 v[132:135], a[68:71], a[116:119], v[132:135]
    buffer_load_dwordx4 v14, s[36:39], s58 offen offset:2048  lds
    v_mfma_f32_16x16x32_bf16 v[136:139], a[72:75], a[116:119], v[136:139]
    s_cbranch_vccz 2
    buffer_load_dwordx4 v15, s[40:43], s58 offen offset:3072  lds
    v_mfma_f32_16x16x32_bf16 v[140:143], a[76:79], a[116:119], v[140:143]
    ds_read_b64_tr_b16 a[116:117], v10 offset:16512
    v_mfma_f32_16x16x32_bf16 v[144:147], a[120:123], a[64:67], v[144:147]
    ds_read_b64_tr_b16 a[118:119], v10 offset:20608
    v_mfma_f32_16x16x32_bf16 v[148:151], a[120:123], a[68:71], v[148:151]
    v_mfma_f32_16x16x32_bf16 v[152:155], a[120:123], a[72:75], v[152:155]
    s_add_u32 s58, s59, s57
    v_mfma_f32_16x16x32_bf16 v[156:159], a[120:123], a[76:79], v[156:159]
    ds_read_b64_tr_b16 a[120:121], v11 offset:16384
    v_mfma_f32_16x16x32_bf16 v[160:163], a[124:127], a[64:67], v[160:163]
    ds_read_b64_tr_b16 a[122:123], v11 offset:19968
    v_mfma_f32_16x16x32_bf16 v[164:167], a[124:127], a[68:71], v[164:167]
    buffer_load_dwordx4 a[48:51], v1, s[32:35], s54 offen offset:0 sc1
    v_mfma_f32_16x16x32_bf16 v[168:171], a[124:127], a[72:75], v[168:171]
    v_mfma_f32_16x16x32_bf16 v[172:175], a[124:127], a[76:79], v[172:175]
    ds_read_b64_tr_b16 a[124:125], v11 offset:16416
    v_mfma_f32_16x16x32_bf16 v[176:179], a[128:131], a[64:67], v[176:179]
    ds_read_b64_tr_b16 a[126:127], v11 offset:20000
    v_mfma_f32_16x16x32_bf16 v[180:183], a[128:131], a[68:71], v[180:183]
    s_add_u32 s52, s52, 4096
    v_mfma_f32_16x16x32_bf16 v[184:187], a[128:131], a[72:75], v[184:187]
    buffer_load_dwordx4 a[52:55], v1, s[32:35], s54 offen offset:1024 sc1
    v_mfma_f32_16x16x32_bf16 v[188:191], a[128:131], a[76:79], v[188:191]
    ds_read_b64_tr_b16 a[128:129], v11 offset:16448
    v_mfma_f32_16x16x32_bf16 v[192:195], a[132:135], a[64:67], v[192:195]
    ds_read_b64_tr_b16 a[130:131], v11 offset:20032
    v_mfma_f32_16x16x32_bf16 v[196:199], a[132:135], a[68:71], v[196:199]
    v_mfma_f32_16x16x32_bf16 v[200:203], a[132:135], a[72:75], v[200:203]
    s_waitcnt lgkmcnt(15)
    v_mfma_f32_16x16x32_bf16 v[204:207], a[132:135], a[76:79], v[204:207]
    ds_read_b64_tr_b16 a[132:133], v11 offset:16480
    v_mfma_f32_16x16x32_bf16 v[208:211], a[136:139], a[64:67], v[208:211]
    ds_read_b64_tr_b16 a[134:135], v11 offset:20064
    v_mfma_f32_16x16x32_bf16 v[212:215], a[136:139], a[68:71], v[212:215]
    buffer_load_dwordx4 a[56:59], v1, s[32:35], s54 offen offset:2048 sc1
    v_mfma_f32_16x16x32_bf16 v[216:219], a[136:139], a[72:75], v[216:219]
    buffer_load_dwordx4 a[60:63], v1, s[32:35], s54 offen offset:3072 sc1
    v_mfma_f32_16x16x32_bf16 v[220:223], a[136:139], a[76:79], v[220:223]
    ds_read_b64_tr_b16 a[136:137], v11 offset:16512
    v_mfma_f32_16x16x32_bf16 v[224:227], a[140:143], a[64:67], v[224:227]
    ds_read_b64_tr_b16 a[138:139], v11 offset:20096
    v_mfma_f32_16x16x32_bf16 v[228:231], a[140:143], a[68:71], v[228:231]
    v_mfma_f32_16x16x32_bf16 v[232:235], a[140:143], a[72:75], v[232:235]
    s_xor_b32 s54, s52, s53
    v_mfma_f32_16x16x32_bf16 v[236:239], a[140:143], a[76:79], v[236:239]
    ds_read_b64_tr_b16 a[140:141], v11 offset:16544
    v_mfma_f32_16x16x32_bf16 v[240:243], a[144:147], a[64:67], v[240:243]
    ds_read_b64_tr_b16 a[142:143], v11 offset:20128
    s_waitcnt vmcnt(28)
    v_mfma_f32_16x16x32_bf16 v[244:247], a[144:147], a[68:71], v[244:247]
    v_mfma_f32_16x16x32_bf16 v[248:251], a[144:147], a[72:75], v[248:251]
    s_waitcnt lgkmcnt(14)
    v_mfma_f32_16x16x32_bf16 v[252:255], a[144:147], a[76:79], v[252:255]
    ds_read_b64_tr_b16 a[144:145], v11 offset:16576
    ds_read_b64_tr_b16 a[146:147], v11 offset:20160
    v_mfma_f32_16x16x32_bf16 v[48:51], a[96:99], a[80:83], v[48:51]
    s_add_u32 m0, s66, 49152
    v_mfma_f32_16x16x32_bf16 v[52:55], a[96:99], a[84:87], v[52:55]
    s_add_u32 s56, s56, 1
    v_mfma_f32_16x16x32_bf16 v[56:59], a[96:99], a[88:91], v[56:59]
    v_mfma_f32_16x16x32_bf16 v[60:63], a[96:99], a[92:95], v[60:63]
    ds_read_b64_tr_b16 a[96:97], v6 offset:0
    v_mfma_f32_16x16x32_bf16 v[64:67], a[100:103], a[80:83], v[64:67]
    ds_read_b64_tr_b16 a[98:99], v6 offset:4096
    v_mfma_f32_16x16x32_bf16 v[68:71], a[100:103], a[84:87], v[68:71]
    buffer_load_dwordx4 v12, s[36:39], s58 offen offset:0  lds
    v_mfma_f32_16x16x32_bf16 v[72:75], a[100:103], a[88:91], v[72:75]
    s_xor_b32 s59, s56, s68
    v_mfma_f32_16x16x32_bf16 v[76:79], a[100:103], a[92:95], v[76:79]
    ds_read_b64_tr_b16 a[100:101], v7 offset:0
    v_mfma_f32_16x16x32_bf16 v[80:83], a[104:107], a[80:83], v[80:83]
    ds_read_b64_tr_b16 a[102:103], v7 offset:4096
    v_mfma_f32_16x16x32_bf16 v[84:87], a[104:107], a[84:87], v[84:87]
    v_mfma_f32_16x16x32_bf16 v[88:91], a[104:107], a[88:91], v[88:91]
    buffer_load_dwordx4 v13, s[36:39], s58 offen offset:1024  lds
    v_mfma_f32_16x16x32_bf16 v[92:95], a[104:107], a[92:95], v[92:95]
    ds_read_b64_tr_b16 a[104:105], v6 offset:64
    v_mfma_f32_16x16x32_bf16 v[96:99], a[108:111], a[80:83], v[96:99]
    ds_read_b64_tr_b16 a[106:107], v6 offset:4160
    v_mfma_f32_16x16x32_bf16 v[100:103], a[108:111], a[84:87], v[100:103]
    v_mfma_f32_16x16x32_bf16 v[104:107], a[108:111], a[88:91], v[104:107]
    s_mul_i32 s59, s59, s64
    v_mfma_f32_16x16x32_bf16 v[108:111], a[108:111], a[92:95], v[108:111]
    ds_read_b64_tr_b16 a[108:109], v7 offset:64
    v_mfma_f32_16x16x32_bf16 v[112:115], a[80:83], a[112:115], v[112:115]
    ds_read_b64_tr_b16 a[110:111], v7 offset:4160
    v_mfma_f32_16x16x32_bf16 v[116:119], a[84:87], a[112:115], v[116:119]
    buffer_load_dwordx4 v14, s[36:39], s58 offen offset:2048  lds
    v_mfma_f32_16x16x32_bf16 v[120:123], a[88:91], a[112:115], v[120:123]
    s_waitcnt lgkmcnt(14)
    v_mfma_f32_16x16x32_bf16 v[124:127], a[92:95], a[112:115], v[124:127]
    ds_read_b64_tr_b16 a[112:113], v6 offset:128
    v_mfma_f32_16x16x32_bf16 v[128:131], a[80:83], a[116:119], v[128:131]
    ds_read_b64_tr_b16 a[114:115], v6 offset:4224
    v_mfma_f32_16x16x32_bf16 v[132:135], a[84:87], a[116:119], v[132:135]
    v_mfma_f32_16x16x32_bf16 v[136:139], a[88:91], a[116:119], v[136:139]
    s_cbranch_vccz 2
    buffer_load_dwordx4 v15, s[40:43], s58 offen offset:3072  lds
    v_mfma_f32_16x16x32_bf16 v[140:143], a[92:95], a[116:119], v[140:143]
    ds_read_b64_tr_b16 a[116:117], v7 offset:128
    v_mfma_f32_16x16x32_bf16 v[144:147], a[120:123], a[80:83], v[144:147]
    ds_read_b64_tr_b16 a[118:119], v7 offset:4224
    v_mfma_f32_16x16x32_bf16 v[148:151], a[120:123], a[84:87], v[148:151]
    s_add_u32 s58, s59, s57
    v_mfma_f32_16x16x32_bf16 v[152:155], a[120:123], a[88:91], v[152:155]
    v_mfma_f32_16x16x32_bf16 v[156:159], a[120:123], a[92:95], v[156:159]
    ds_read_b64_tr_b16 a[120:121], v8 offset:0
    v_mfma_f32_16x16x32_bf16 v[160:163], a[124:127], a[80:83], v[160:163]
    ds_read_b64_tr_b16 a[122:123], v8 offset:3584
    v_mfma_f32_16x16x32_bf16 v[164:167], a[124:127], a[84:87], v[164:167]
    buffer_load_dwordx4 a[64:67], v1, s[32:35], s54 offen offset:0 sc1
    v_mfma_f32_16x16x32_bf16 v[168:171], a[124:127], a[88:91], v[168:171]
    v_mfma_f32_16x16x32_bf16 v[172:175], a[124:127], a[92:95], v[172:175]
    ds_read_b64_tr_b16 a[124:125], v8 offset:32
    v_mfma_f32_16x16x32_bf16 v[176:179], a[128:131], a[80:83], v[176:179]
    ds_read_b64_tr_b16 a[126:127], v8 offset:3616
    v_mfma_f32_16x16x32_bf16 v[180:183], a[128:131], a[84:87], v[180:183]
    s_add_u32 s52, s52, 4096
    v_mfma_f32_16x16x32_bf16 v[184:187], a[128:131], a[88:91], v[184:187]
    buffer_load_dwordx4 a[68:71], v1, s[32:35], s54 offen offset:1024 sc1
    v_mfma_f32_16x16x32_bf16 v[188:191], a[128:131], a[92:95], v[188:191]
    ds_read_b64_tr_b16 a[128:129], v8 offset:64
    v_mfma_f32_16x16x32_bf16 v[192:195], a[132:135], a[80:83], v[192:195]
    ds_read_b64_tr_b16 a[130:131], v8 offset:3648
    v_mfma_f32_16x16x32_bf16 v[196:199], a[132:135], a[84:87], v[196:199]
    v_mfma_f32_16x16x32_bf16 v[200:203], a[132:135], a[88:91], v[200:203]
    s_waitcnt lgkmcnt(15)
    v_mfma_f32_16x16x32_bf16 v[204:207], a[132:135], a[92:95], v[204:207]
    ds_read_b64_tr_b16 a[132:133], v8 offset:96
    v_mfma_f32_16x16x32_bf16 v[208:211], a[136:139], a[80:83], v[208:211]
    ds_read_b64_tr_b16 a[134:135], v8 offset:3680
    v_mfma_f32_16x16x32_bf16 v[212:215], a[136:139], a[84:87], v[212:215]
    buffer_load_dwordx4 a[72:75], v1, s[32:35], s54 offen offset:2048 sc1
    v_mfma_f32_16x16x32_bf16 v[216:219], a[136:139], a[88:91], v[216:219]
    buffer_load_dwordx4 a[76:79], v1, s[32:35], s54 offen offset:3072 sc1
    v_mfma_f32_16x16x32_bf16 v[220:223], a[136:139], a[92:95], v[220:223]
    ds_read_b64_tr_b16 a[136:137], v8 offset:128
    v_mfma_f32_16x16x32_bf16 v[224:227], a[140:143], a[80:83], v[224:227]
    ds_read_b64_tr_b16 a[138:139], v8 offset:3712
    v_mfma_f32_16x16x32_bf16 v[228:231], a[140:143], a[84:87], v[228:231]
    v_mfma_f32_16x16x32_bf16 v[232:235], a[140:143], a[88:91], v[232:235]
    s_xor_b32 s54, s52, s53
    v_mfma_f32_16x16x32_bf16 v[236:239], a[140:143], a[92:95], v[236:239]
    ds_read_b64_tr_b16 a[140:141], v8 offset:160
    v_mfma_f32_16x16x32_bf16 v[240:243], a[144:147], a[80:83], v[240:243]
    ds_read_b64_tr_b16 a[142:143], v8 offset:3744
    s_waitcnt vmcnt(11)
    v_mfma_f32_16x16x32_bf16 v[244:247], a[144:147], a[84:87], v[244:247]
    v_mfma_f32_16x16x32_bf16 v[248:251], a[144:147], a[88:91], v[248:251]
    s_waitcnt lgkmcnt(14)
    v_mfma_f32_16x16x32_bf16 v[252:255], a[144:147], a[92:95], v[252:255]
    ds_read_b64_tr_b16 a[144:145], v8 offset:192
    ds_read_b64_tr_b16 a[146:147], v8 offset:3776
    v_mfma_f32_16x16x32_bf16 v[48:51], a[96:99], a[0:3], v[48:51]
    s_barrier
    v_mfma_f32_16x16x32_bf16 v[52:55], a[96:99], a[4:7], v[52:55]
    s_add_u32 m0, s66, 65536
    v_mfma_f32_16x16x32_bf16 v[56:59], a[96:99], a[8:11], v[56:59]
    s_add_u32 s56, s56, 1
    v_mfma_f32_16x16x32_bf16 v[60:63], a[96:99], a[12:15], v[60:63]
    ds_read_b64_tr_b16 a[96:97], v6 offset:16384
    v_mfma_f32_16x16x32_bf16 v[64:67], a[100:103], a[0:3], v[64:67]
    ds_read_b64_tr_b16 a[98:99], v6 offset:20480
    v_mfma_f32_16x16x32_bf16 v[68:71], a[100:103], a[4:7], v[68:71]
    v_mfma_f32_16x16x32_bf16 v[72:75], a[100:103], a[8:11], v[72:75]
    buffer_load_dwordx4 v12, s[36:39], s58 offen offset:0  lds
    v_mfma_f32_16x16x32_bf16 v[76:79], a[100:103], a[12:15], v[76:79]
    ds_read_b64_tr_b16 a[100:101], v7 offset:16384
    v_mfma_f32_16x16x32_bf16 v[80:83], a[104:107], a[0:3], v[80:83]
    ds_read_b64_tr_b16 a[102:103], v7 offset:20480
    v_mfma_f32_16x16x32_bf16 v[84:87], a[104:107], a[4:7], v[84:87]
    s_xor_b32 s59, s56, s68
    v_mfma_f32_16x16x32_bf16 v[88:91], a[104:107], a[8:11], v[88:91]
    v_mfma_f32_16x16x32_bf16 v[92:95], a[104:107], a[12:15], v[92:95]
    ds_read_b64_tr_b16 a[104:105], v6 offset:16448
    v_mfma_f32_16x16x32_bf16 v[96:99], a[108:111], a[0:3], v[96:99]
    ds_read_b64_tr_b16 a[106:107], v6 offset:20544
    v_mfma_f32_16x16x32_bf16 v[100:103], a[108:111], a[4:7], v[100:103]
    buffer_load_dwordx4 v13, s[36:39], s58 offen offset:1024  lds
    v_mfma_f32_16x16x32_bf16 v[104:107], a[108:111], a[8:11], v[104:107]
    s_mul_i32 s59, s59, s64
    v_mfma_f32_16x16x32_bf16 v[108:111], a[108:111], a[12:15], v[108:111]
    ds_read_b64_tr_b16 a[108:109], v7 offset:16448
    v_mfma_f32_16x16x32_bf16 v[112:115], a[0:3], a[112:115], v[112:115]
    ds_read_b64_tr_b16 a[110:111], v7 offset:20544
    v_mfma_f32_16x16x32_bf16 v[116:119], a[4:7], a[112:115], v[116:119]
    v_mfma_f32_16x16x32_bf16 v[120:123], a[8:11], a[112:115], v[120:123]
    s_waitcnt lgkmcnt(14)
    v_mfma_f32_16x16x32_bf16 v[124:127], a[12:15], a[112:115], v[124:127]
    ds_read_b64_tr_b16 a[112:113], v6 offset:16512
    v_mfma_f32_16x16x32_bf16 v[128:131], a[0:3], a[116:119], v[128:131]
    ds_read_b64_tr_b16 a[114:115], v6 offset:20608
    v_mfma_f32_16x16x32_bf16 v[132:135], a[4:7], a[116:119], v[132:135]
    buffer_load_dwordx4 v14, s[36:39], s58 offen offset:2048  lds
    v_mfma_f32_16x16x32_bf16 v[136:139], a[8:11], a[116:119], v[136:139]
    s_cbranch_vccz 2
    buffer_load_dwordx4 v15, s[40:43], s58 offen offset:3072  lds
    v_mfma_f32_16x16x32_bf16 v[140:143], a[12:15], a[116:119], v[140:143]
    ds_read_b64_tr_b16 a[116:117], v7 offset:16512
    v_mfma_f32_16x16x32_bf16 v[144:147], a[120:123], a[0:3], v[144:147]
    ds_read_b64_tr_b16 a[118:119], v7 offset:20608
    v_mfma_f32_16x16x32_bf16 v[148:151], a[120:123], a[4:7], v[148:151]
    v_mfma_f32_16x16x32_bf16 v[152:155], a[120:123], a[8:11], v[152:155]
    s_add_u32 s58, s59, s57
    v_mfma_f32_16x16x32_bf16 v[156:159], a[120:123], a[12:15], v[156:159]
    ds_read_b64_tr_b16 a[120:121], v8 offset:16384
    v_mfma_f32_16x16x32_bf16 v[160:163], a[124:127], a[0:3], v[160:163]
    ds_read_b64_tr_b16 a[122:123], v8 offset:19968
    v_mfma_f32_16x16x32_bf16 v[164:167], a[124:127], a[4:7], v[164:167]
    buffer_load_dwordx4 a[80:83], v1, s[32:35], s54 offen offset:0 sc1
    v_mfma_f32_16x16x32_bf16 v[168:171], a[124:127], a[8:11], v[168:171]
    v_mfma_f32_16x16x32_bf16 v[172:175], a[124:127], a[12:15], v[172:175]
    ds_read_b64_tr_b16 a[124:125], v8 offset:16416
    v_mfma_f32_16x16x32_bf16 v[176:179], a[128:131], a[0:3], v[176:179]
    ds_read_b64_tr_b16 a[126:127], v8 offset:20000
    v_mfma_f32_16x16x32_bf16 v[180:183], a[128:131], a[4:7], v[180:183]
    s_add_u32 s52, s52, 4096
    v_mfma_f32_16x16x32_bf16 v[184:187], a[128:131], a[8:11], v[184:187]
    buffer_load_dwordx4 a[84:87], v1, s[32:35], s54 offen offset:1024 sc1
    v_mfma_f32_16x16x32_bf16 v[188:191], a[128:131], a[12:15], v[188:191]
    ds_read_b64_tr_b16 a[128:129], v8 offset:16448
    v_mfma_f32_16x16x32_bf16 v[192:195], a[132:135], a[0:3], v[192:195]
    ds_read_b64_tr_b16 a[130:131], v8 offset:20032
    v_mfma_f32_16x16x32_bf16 v[196:199], a[132:135], a[4:7], v[196:199]
    v_mfma_f32_16x16x32_bf16 v[200:203], a[132:135], a[8:11], v[200:203]
    s_waitcnt lgkmcnt(15)
    v_mfma_f32_16x16x32_bf16 v[204:207], a[132:135], a[12:15], v[204:207]
    ds_read_b64_tr_b16 a[132:133], v8 offset:16480
    v_mfma_f32_16x16x32_bf16 v[208:211], a[136:139], a[0:3], v[208:211]
    ds_read_b64_tr_b16 a[134:135], v8 offset:20064
    v_mfma_f32_16x16x32_bf16 v[212:215], a[136:139], a[4:7], v[212:215]
    buffer_load_dwordx4 a[88:91], v1, s[32:35], s54 offen offset:2048 sc1
    v_mfma_f32_16x16x32_bf16 v[216:219], a[136:139], a[8:11], v[216:219]
    buffer_load_dwordx4 a[92:95], v1, s[32:35], s54 offen offset:3072 sc1
    v_mfma_f32_16x16x32_bf16 v[220:223], a[136:139], a[12:15], v[220:223]
    ds_read_b64_tr_b16 a[136:137], v8 offset:16512
    v_mfma_f32_16x16x32_bf16 v[224:227], a[140:143], a[0:3], v[224:227]
    ds_read_b64_tr_b16 a[138:139], v8 offset:20096
    v_mfma_f32_16x16x32_bf16 v[228:231], a[140:143], a[4:7], v[228:231]
    v_mfma_f32_16x16x32_bf16 v[232:235], a[140:143], a[8:11], v[232:235]
    s_xor_b32 s54, s52, s53
    v_mfma_f32_16x16x32_bf16 v[236:239], a[140:143], a[12:15], v[236:239]
    ds_read_b64_tr_b16 a[140:141], v8 offset:16544
    v_mfma_f32_16x16x32_bf16 v[240:243], a[144:147], a[0:3], v[240:243]
    ds_read_b64_tr_b16 a[142:143], v8 offset:20128
    s_waitcnt vmcnt(28)
    v_mfma_f32_16x16x32_bf16 v[244:247], a[144:147], a[4:7], v[244:247]
    v_mfma_f32_16x16x32_bf16 v[248:251], a[144:147], a[8:11], v[248:251]
    s_waitcnt lgkmcnt(14)
    v_mfma_f32_16x16x32_bf16 v[252:255], a[144:147], a[12:15], v[252:255]
    ds_read_b64_tr_b16 a[144:145], v8 offset:16576
    ds_read_b64_tr_b16 a[146:147], v8 offset:20160
    v_mfma_f32_16x16x32_bf16 v[48:51], a[96:99], a[16:19], v[48:51]
    s_add_u32 m0, s66, 81920
    v_mfma_f32_16x16x32_bf16 v[52:55], a[96:99], a[20:23], v[52:55]
    s_add_u32 s56, s56, 1
    v_mfma_f32_16x16x32_bf16 v[56:59], a[96:99], a[24:27], v[56:59]
    v_mfma_f32_16x16x32_bf16 v[60:63], a[96:99], a[28:31], v[60:63]
    ds_read_b64_tr_b16 a[96:97], v6 offset:32768
    v_mfma_f32_16x16x32_bf16 v[64:67], a[100:103], a[16:19], v[64:67]
    ds_read_b64_tr_b16 a[98:99], v6 offset:36864
    v_mfma_f32_16x16x32_bf16 v[68:71], a[100:103], a[20:23], v[68:71]
    buffer_load_dwordx4 v12, s[36:39], s58 offen offset:0  lds
    v_mfma_f32_16x16x32_bf16 v[72:75], a[100:103], a[24:27], v[72:75]
    s_xor_b32 s59, s56, s68
    v_mfma_f32_16x16x32_bf16 v[76:79], a[100:103], a[28:31], v[76:79]
    ds_read_b64_tr_b16 a[100:101], v7 offset:32768
    v_mfma_f32_16x16x32_bf16 v[80:83], a[104:107], a[16:19], v[80:83]
    ds_read_b64_tr_b16 a[102:103], v7 offset:36864
    v_mfma_f32_16x16x32_bf16 v[84:87], a[104:107], a[20:23], v[84:87]
    v_mfma_f32_16x16x32_bf16 v[88:91], a[104:107], a[24:27], v[88:91]
    buffer_load_dwordx4 v13, s[36:39], s58 offen offset:1024  lds
    v_mfma_f32_16x16x32_bf16 v[92:95], a[104:107], a[28:31], v[92:95]
    ds_read_b64_tr_b16 a[104:105], v6 offset:32832
    v_mfma_f32_16x16x32_bf16 v[96:99], a[108:111], a[16:19], v[96:99]
    ds_read_b64_tr_b16 a[106:107], v6 offset:36928
    v_mfma_f32_16x16x32_bf16 v[100:103], a[108:111], a[20:23], v[100:103]
    v_mfma_f32_16x16x32_bf16 v[104:107], a[108:111], a[24:27], v[104:107]
    s_mul_i32 s59, s59, s64
    v_mfma_f32_16x16x32_bf16 v[108:111], a[108:111], a[28:31], v[108:111]
    ds_read_b64_tr_b16 a[108:109], v7 offset:32832
    v_mfma_f32_16x16x32_bf16 v[112:115], a[16:19], a[112:115], v[112:115]
    ds_read_b64_tr_b16 a[110:111], v7 offset:36928
    v_mfma_f32_16x16x32_bf16 v[116:119], a[20:23], a[112:115], v[116:119]
    buffer_load_dwordx4 v14, s[36:39], s58 offen offset:2048  lds
    v_mfma_f32_16x16x32_bf16 v[120:123], a[24:27], a[112:115], v[120:123]
    s_waitcnt lgkmcnt(14)
    v_mfma_f32_16x16x32_bf16 v[124:127], a[28:31], a[112:115], v[124:127]
    ds_read_b64_tr_b16 a[112:113], v6 offset:32896
    v_mfma_f32_16x16x32_bf16 v[128:131], a[16:19], a[116:119], v[128:131]
    ds_read_b64_tr_b16 a[114:115], v6 offset:36992
    v_mfma_f32_16x16x32_bf16 v[132:135], a[20:23], a[116:119], v[132:135]
    v_mfma_f32_16x16x32_bf16 v[136:139], a[24:27], a[116:119], v[136:139]
    s_cbranch_vccz 2
    buffer_load_dwordx4 v15, s[40:43], s58 offen offset:3072  lds
    v_mfma_f32_16x16x32_bf16 v[140:143], a[28:31], a[116:119], v[140:143]
    ds_read_b64_tr_b16 a[116:117], v7 offset:32896
    v_mfma_f32_16x16x32_bf16 v[144:147], a[120:123], a[16:19], v[144:147]
    ds_read_b64_tr_b16 a[118:119], v7 offset:36992
    v_mfma_f32_16x16x32_bf16 v[148:151], a[120:123], a[20:23], v[148:151]
    s_add_u32 s58, s59, s57
    v_mfma_f32_16x16x32_bf16 v[152:155], a[120:123], a[24:27], v[152:155]
    v_mfma_f32_16x16x32_bf16 v[156:159], a[120:123], a[28:31], v[156:159]
    ds_read_b64_tr_b16 a[120:121], v8 offset:32768
    v_mfma_f32_16x16x32_bf16 v[160:163], a[124:127], a[16:19], v[160:163]
    ds_read_b64_tr_b16 a[122:123], v8 offset:36352
    v_mfma_f32_16x16x32_bf16 v[164:167], a[124:127], a[20:23], v[164:167]
    buffer_load_dwordx4 a[0:3], v1, s[32:35], s54 offen offset:0 sc1
    v_mfma_f32_16x16x32_bf16 v[168:171], a[124:127], a[24:27], v[168:171]
    v_mfma_f32_16x16x32_bf16 v[172:175], a[124:127], a[28:31], v[172:175]
    ds_read_b64_tr_b16 a[124:125], v8 offset:32800
    v_mfma_f32_16x16x32_bf16 v[176:179], a[128:131], a[16:19], v[176:179]
    ds_read_b64_tr_b16 a[126:127], v8 offset:36384
    v_mfma_f32_16x16x32_bf16 v[180:183], a[128:131], a[20:23], v[180:183]
    s_add_u32 s52, s52, 4096
    v_mfma_f32_16x16x32_bf16 v[184:187], a[128:131], a[24:27], v[184:187]
    buffer_load_dwordx4 a[4:7], v1, s[32:35], s54 offen offset:1024 sc1
    v_mfma_f32_16x16x32_bf16 v[188:191], a[128:131], a[28:31], v[188:191]
    ds_read_b64_tr_b16 a[128:129], v8 offset:32832
    v_mfma_f32_16x16x32_bf16 v[192:195], a[132:135], a[16:19], v[192:195]
    ds_read_b64_tr_b16 a[130:131], v8 offset:36416
    v_mfma_f32_16x16x32_bf16 v[196:199], a[132:135], a[20:23], v[196:199]
    v_mfma_f32_16x16x32_bf16 v[200:203], a[132:135], a[24:27], v[200:203]
    s_waitcnt lgkmcnt(15)
    v_mfma_f32_16x16x32_bf16 v[204:207], a[132:135], a[28:31], v[204:207]
    ds_read_b64_tr_b16 a[132:133], v8 offset:32864
    v_mfma_f32_16x16x32_bf16 v[208:211], a[136:139], a[16:19], v[208:211]
    ds_read_b64_tr_b16 a[134:135], v8 offset:36448
    v_mfma_f32_16x16x32_bf16 v[212:215], a[136:139], a[20:23], v[212:215]
    buffer_load_dwordx4 a[8:11], v1, s[32:35], s54 offen offset:2048 sc1
    v_mfma_f32_16x16x32_bf16 v[216:219], a[136:139], a[24:27], v[216:219]
    buffer_load_dwordx4 a[12:15], v1, s[32:35], s54 offen offset:3072 sc1
    v_mfma_f32_16x16x32_bf16 v[220:223], a[136:139], a[28:31], v[220:223]
    ds_read_b64_tr_b16 a[136:137], v8 offset:32896
    v_mfma_f32_16x16x32_bf16 v[224:227], a[140:143], a[16:19], v[224:227]
    ds_read_b64_tr_b16 a[138:139], v8 offset:36480
    v_mfma_f32_16x16x32_bf16 v[228:231], a[140:143], a[20:23], v[228:231]
    v_mfma_f32_16x16x32_bf16 v[232:235], a[140:143], a[24:27], v[232:235]
    s_xor_b32 s54, s52, s53
    v_mfma_f32_16x16x32_bf16 v[236:239], a[140:143], a[28:31], v[236:239]
    ds_read_b64_tr_b16 a[140:141], v8 offset:32928
    v_mfma_f32_16x16x32_bf16 v[240:243], a[144:147], a[16:19], v[240:243]
    ds_read_b64_tr_b16 a[142:143], v8 offset:36512
    s_waitcnt vmcnt(11)
    v_mfma_f32_16x16x32_bf16 v[244:247], a[144:147], a[20:23], v[244:247]
    v_mfma_f32_16x16x32_bf16 v[248:251], a[144:147], a[24:27], v[248:251]
    s_waitcnt lgkmcnt(14)
    v_mfma_f32_16x16x32_bf16 v[252:255], a[144:147], a[28:31], v[252:255]
    ds_read_b64_tr_b16 a[144:145], v8 offset:32960
    ds_read_b64_tr_b16 a[146:147], v8 offset:36544
    v_mfma_f32_16x16x32_bf16 v[48:51], a[96:99], a[32:35], v[48:51]
    s_barrier
    v_mfma_f32_16x16x32_bf16 v[52:55], a[96:99], a[36:39], v[52:55]
    s_add_u32 m0, s66, 0
    v_mfma_f32_16x16x32_bf16 v[56:59], a[96:99], a[40:43], v[56:59]
    s_add_u32 s56, s56, 1
    v_mfma_f32_16x16x32_bf16 v[60:63], a[96:99], a[44:47], v[60:63]
    ds_read_b64_tr_b16 a[96:97], v6 offset:49152
    v_mfma_f32_16x16x32_bf16 v[64:67], a[100:103], a[32:35], v[64:67]
    ds_read_b64_tr_b16 a[98:99], v6 offset:53248
    v_mfma_f32_16x16x32_bf16 v[68:71], a[100:103], a[36:39], v[68:71]
    v_mfma_f32_16x16x32_bf16 v[72:75], a[100:103], a[40:43], v[72:75]
    buffer_load_dwordx4 v12, s[36:39], s58 offen offset:0  lds
    v_mfma_f32_16x16x32_bf16 v[76:79], a[100:103], a[44:47], v[76:79]
    ds_read_b64_tr_b16 a[100:101], v7 offset:49152
    v_mfma_f32_16x16x32_bf16 v[80:83], a[104:107], a[32:35], v[80:83]
    ds_read_b64_tr_b16 a[102:103], v7 offset:53248
    v_mfma_f32_16x16x32_bf16 v[84:87], a[104:107], a[36:39], v[84:87]
    s_xor_b32 s59, s56, s68
    v_mfma_f32_16x16x32_bf16 v[88:91], a[104:107], a[40:43], v[88:91]
    v_mfma_f32_16x16x32_bf16 v[92:95], a[104:107], a[44:47], v[92:95]
    ds_read_b64_tr_b16 a[104:105], v6 offset:49216
    v_mfma_f32_16x16x32_bf16 v[96:99], a[108:111], a[32:35], v[96:99]
    ds_read_b64_tr_b16 a[106:107], v6 offset:53312
    v_mfma_f32_16x16x32_bf16 v[100:103], a[108:111], a[36:39], v[100:103]
    buffer_load_dwordx4 v13, s[36:39], s58 offen offset:1024  lds
    v_mfma_f32_16x16x32_bf16 v[104:107], a[108:111], a[40:43], v[104:107]
    s_mul_i32 s59, s59, s64
    v_mfma_f32_16x16x32_bf16 v[108:111], a[108:111], a[44:47], v[108:111]
    ds_read_b64_tr_b16 a[108:109], v7 offset:49216
    v_mfma_f32_16x16x32_bf16 v[112:115], a[32:35], a[112:115], v[112:115]
    ds_read_b64_tr_b16 a[110:111], v7 offset:53312
    v_mfma_f32_16x16x32_bf16 v[116:119], a[36:39], a[112:115], v[116:119]
    v_mfma_f32_16x16x32_bf16 v[120:123], a[40:43], a[112:115], v[120:123]
    s_waitcnt lgkmcnt(14)
    v_mfma_f32_16x16x32_bf16 v[124:127], a[44:47], a[112:115], v[124:127]
    ds_read_b64_tr_b16 a[112:113], v6 offset:49280
    v_mfma_f32_16x16x32_bf16 v[128:131], a[32:35], a[116:119], v[128:131]
    ds_read_b64_tr_b16 a[114:115], v6 offset:53376
    v_mfma_f32_16x16x32_bf16 v[132:135], a[36:39], a[116:119], v[132:135]
    buffer_load_dwordx4 v14, s[36:39], s58 offen offset:2048  lds
    v_mfma_f32_16x16x32_bf16 v[136:139], a[40:43], a[116:119], v[136:139]
    s_cbranch_vccz 2
    buffer_load_dwordx4 v15, s[40:43], s58 offen offset:3072  lds
    v_mfma_f32_16x16x32_bf16 v[140:143], a[44:47], a[116:119], v[140:143]
    ds_read_b64_tr_b16 a[116:117], v7 offset:49280
    v_mfma_f32_16x16x32_bf16 v[144:147], a[120:123], a[32:35], v[144:147]
    ds_read_b64_tr_b16 a[118:119], v7 offset:53376
    v_mfma_f32_16x16x32_bf16 v[148:151], a[120:123], a[36:39], v[148:151]
    v_mfma_f32_16x16x32_bf16 v[152:155], a[120:123], a[40:43], v[152:155]
    s_add_u32 s58, s59, s57
    v_mfma_f32_16x16x32_bf16 v[156:159], a[120:123], a[44:47], v[156:159]
    ds_read_b64_tr_b16 a[120:121], v8 offset:49152
    v_mfma_f32_16x16x32_bf16 v[160:163], a[124:127], a[32:35], v[160:163]
    ds_read_b64_tr_b16 a[122:123], v8 offset:52736
    v_mfma_f32_16x16x32_bf16 v[164:167], a[124:127], a[36:39], v[164:167]
    buffer_load_dwordx4 a[16:19], v1, s[32:35], s54 offen offset:0 sc1
    v_mfma_f32_16x16x32_bf16 v[168:171], a[124:127], a[40:43], v[168:171]
    v_mfma_f32_16x16x32_bf16 v[172:175], a[124:127], a[44:47], v[172:175]
    ds_read_b64_tr_b16 a[124:125], v8 offset:49184
    v_mfma_f32_16x16x32_bf16 v[176:179], a[128:131], a[32:35], v[176:179]
    ds_read_b64_tr_b16 a[126:127], v8 offset:52768
    v_mfma_f32_16x16x32_bf16 v[180:183], a[128:131], a[36:39], v[180:183]
    s_add_u32 s52, s52, 4096
    v_mfma_f32_16x16x32_bf16 v[184:187], a[128:131], a[40:43], v[184:187]
    buffer_load_dwordx4 a[20:23], v1, s[32:35], s54 offen offset:1024 sc1
    v_mfma_f32_16x16x32_bf16 v[188:191], a[128:131], a[44:47], v[188:191]
    ds_read_b64_tr_b16 a[128:129], v8 offset:49216
    v_mfma_f32_16x16x32_bf16 v[192:195], a[132:135], a[32:35], v[192:195]
    ds_read_b64_tr_b16 a[130:131], v8 offset:52800
    v_mfma_f32_16x16x32_bf16 v[196:199], a[132:135], a[36:39], v[196:199]
    v_mfma_f32_16x16x32_bf16 v[200:203], a[132:135], a[40:43], v[200:203]
    s_waitcnt lgkmcnt(15)
    v_mfma_f32_16x16x32_bf16 v[204:207], a[132:135], a[44:47], v[204:207]
    ds_read_b64_tr_b16 a[132:133], v8 offset:49248
    v_mfma_f32_16x16x32_bf16 v[208:211], a[136:139], a[32:35], v[208:211]
    ds_read_b64_tr_b16 a[134:135], v8 offset:52832
    v_mfma_f32_16x16x32_bf16 v[212:215], a[136:139], a[36:39], v[212:215]
    buffer_load_dwordx4 a[24:27], v1, s[32:35], s54 offen offset:2048 sc1
    v_mfma_f32_16x16x32_bf16 v[216:219], a[136:139], a[40:43], v[216:219]
    buffer_load_dwordx4 a[28:31], v1, s[32:35], s54 offen offset:3072 sc1
    v_mfma_f32_16x16x32_bf16 v[220:223], a[136:139], a[44:47], v[220:223]
    ds_read_b64_tr_b16 a[136:137], v8 offset:49280
    v_mfma_f32_16x16x32_bf16 v[224:227], a[140:143], a[32:35], v[224:227]
    ds_read_b64_tr_b16 a[138:139], v8 offset:52864
    v_mfma_f32_16x16x32_bf16 v[228:231], a[140:143], a[36:39], v[228:231]
    v_mfma_f32_16x16x32_bf16 v[232:235], a[140:143], a[40:43], v[232:235]
    s_xor_b32 s54, s52, s53
    v_mfma_f32_16x16x32_bf16 v[236:239], a[140:143], a[44:47], v[236:239]
    ds_read_b64_tr_b16 a[140:141], v8 offset:49312
    v_mfma_f32_16x16x32_bf16 v[240:243], a[144:147], a[32:35], v[240:243]
    ds_read_b64_tr_b16 a[142:143], v8 offset:52896
    s_waitcnt vmcnt(28)
    v_mfma_f32_16x16x32_bf16 v[244:247], a[144:147], a[36:39], v[244:247]
    v_mfma_f32_16x16x32_bf16 v[248:251], a[144:147], a[40:43], v[248:251]
    s_waitcnt lgkmcnt(14)
    v_mfma_f32_16x16x32_bf16 v[252:255], a[144:147], a[44:47], v[252:255]
    ds_read_b64_tr_b16 a[144:145], v8 offset:49344
    ds_read_b64_tr_b16 a[146:147], v8 offset:52928
    s_sub_u32 s67, s67, 1
    s_cmp_lg_u32 s67, 0
    s_cbranch_scc1 L_g1_loop
    v_mfma_f32_16x16x32_bf16 v[80:83], a[104:107], a[48:51], v[80:83]
    s_add_u32 m0, s66, 16384
    s_add_u32 s56, s56, 1
    buffer_load_dwordx4 v12, s[36:39], s58 offen offset:0  lds
    s_xor_b32 s59, s56, s68
    v_mfma_f32_16x16x32_bf16 v[84:87], a[104:107], a[52:55], v[84:87]
    buffer_load_dwordx4 v13, s[36:39], s58 offen offset:1024  lds
    s_mul_i32 s59, s59, s64
    buffer_load_dwordx4 v14, s[36:39], s58 offen offset:2048  lds
    v_mfma_f32_16x16x32_bf16 v[88:91], a[104:107], a[56:59], v[88:91]
    s_cbranch_vccz 2
    buffer_load_dwordx4 v15, s[40:43], s58 offen offset:3072  lds
    s_add_u32 s58, s59, s57
    buffer_load_dwordx4 a[244:247], v1, s[72:75], s76 offen
    s_add_u32 s76, s76, 1048576
    v_mfma_f32_16x16x32_bf16 v[92:95], a[104:107], a[60:63], v[92:95]
    ds_read_b64_tr_b16 a[104:105], v9 offset:64
    buffer_load_dwordx4 a[244:247], v1, s[72:75], s76 offen
    s_add_u32 s76, s76, 1048576
    v_mfma_f32_16x16x32_bf16 v[96:99], a[108:111], a[48:51], v[96:99]
    ds_read_b64_tr_b16 a[106:107], v9 offset:4160
    buffer_load_dwordx4 a[244:247], v1, s[72:75], s76 offen
    s_add_u32 s76, s76, 1048576
    v_mfma_f32_16x16x32_bf16 v[100:103], a[108:111], a[52:55], v[100:103]
    buffer_load_dwordx4 a[244:247], v1, s[72:75], s76 offen
    s_add_u32 s76, s76, 1048576
    s_lshl_b32 s78, s28, 3
    s_add_u32 s78, s78, s27
    v_mfma_f32_16x16x32_bf16 v[104:107], a[108:111], a[56:59], v[104:107]
    s_waitcnt lgkmcnt(15)
    s_lshl_b32 s82, s78, 2
    s_add_u32 s82, s82, s26
    v_mfma_f32_16x16x32_bf16 v[108:111], a[108:111], a[60:63], v[108:111]
    ds_read_b64_tr_b16 a[108:109], v10 offset:64
    s_lshl_b32 s82, s82, 6
    s_add_u32 s82, s82, 40960000
    v_mfma_f32_16x16x32_bf16 v[112:115], a[48:51], a[112:115], v[112:115]
    ds_read_b64_tr_b16 a[110:111], v10 offset:4160
    s_sub_u32 s83, s82, 256
    s_lshl_b32 s78, s78, 15
    s_add_u32 s78, s78, s66
    v_mfma_f32_16x16x32_bf16 v[116:119], a[52:55], a[112:115], v[116:119]
    s_add_u32 s78, s78, 4194304
    s_add_u32 s79, s78, 16384
    s_sub_u32 s80, s78, 32768
    v_mfma_f32_16x16x32_bf16 v[120:123], a[56:59], a[112:115], v[120:123]
    v_add_u32 v37, s66, v1
    v_add_u32 v37, 98304, v37
    v_mov_b32 v2, 0x3e8293ee
    s_cmp_eq_u32 s27, 0
    v_mfma_f32_16x16x32_bf16 v[124:127], a[60:63], a[112:115], v[124:127]
    ds_read_b64_tr_b16 a[112:113], v9 offset:128
    s_cselect_b32 s80, 0x40000000, s80
    s_cselect_b32 s92, s26, 3
    v_mfma_f32_16x16x32_bf16 v[128:131], a[48:51], a[116:119], v[128:131]
    ds_read_b64_tr_b16 a[114:115], v9 offset:4224
    s_waitcnt vmcnt(11)
    s_add_u32 s81, s80, 16384
    v_mfma_f32_16x16x32_bf16 v[132:135], a[52:55], a[116:119], v[132:135]
    s_cmp_eq_u32 s27, 7
    s_cselect_b32 s78, 0x40000000, s78
    s_cselect_b32 s79, 0x40000000, s79
    buffer_load_dwordx4 a[240:243], v1, s[48:51], s77 offen
    v_mfma_f32_16x16x32_bf16 v[136:139], a[56:59], a[116:119], v[136:139]
    s_waitcnt lgkmcnt(2)
    s_add_u32 s77, s77, 1048576
    buffer_load_dwordx4 a[240:243], v1, s[48:51], s77 offen
    v_mfma_f32_16x16x32_bf16 v[140:143], a[60:63], a[116:119], v[140:143]
    ds_read_b64_tr_b16 a[116:117], v10 offset:128
    ds_read_b64_tr_b16 a[118:119], v10 offset:4224
    s_add_u32 s77, s77, 1048576
    v_mfma_f32_16x16x32_bf16 v[80:83], a[104:107], a[64:67], v[80:83]
    s_barrier
    s_lshl_b32 s84, s27, 2
    v_mfma_f32_16x16x32_bf16 v[84:87], a[104:107], a[68:71], v[84:87]
    s_add_u32 s84, s84, s26
    s_lshl_b32 s90, s84, 9
    v_mfma_f32_16x16x32_bf16 v[88:91], a[104:107], a[72:75], v[88:91]
    s_lshl_b32 s87, s3, 4
    s_add_u32 s90, s90, s87
    v_mfma_f32_16x16x32_bf16 v[92:95], a[104:107], a[76:79], v[92:95]
    ds_read_b64_tr_b16 a[104:105], v9 offset:16448
    s_add_u32 s91, s90, 40927232
    v_mfma_f32_16x16x32_bf16 v[96:99], a[108:111], a[64:67], v[96:99]
    ds_read_b64_tr_b16 a[106:107], v9 offset:20544
    s_add_u32 s90, s90, 40910848
    v_mfma_f32_16x16x32_bf16 v[100:103], a[108:111], a[68:71], v[100:103]
    s_mul_i32 s84, s84, 589824
    s_add_u32 s84, s84, 16777216
    v_mfma_f32_16x16x32_bf16 v[104:107], a[108:111], a[72:75], v[104:107]
    s_waitcnt lgkmcnt(2)
    s_lshl_b32 s87, s28, 11
    v_mfma_f32_16x16x32_bf16 v[108:111], a[108:111], a[76:79], v[108:111]
    ds_read_b64_tr_b16 a[108:109], v10 offset:16448
    s_add_u32 s86, s84, s87
    v_mfma_f32_16x16x32_bf16 v[112:115], a[64:67], a[112:115], v[112:115]
    ds_read_b64_tr_b16 a[110:111], v10 offset:20544
    s_add_u32 s86, s86, 229376
    v_mfma_f32_16x16x32_bf16 v[116:119], a[68:71], a[112:115], v[116:119]
    s_mul_i32 s87, s3, 7
    s_add_u32 s87, s87, s29
    v_mfma_f32_16x16x32_bf16 v[120:123], a[72:75], a[112:115], v[120:123]
    s_lshr_b32 s87, s87, 1
    s_lshl_b32 s87, s87, 11
    v_mfma_f32_16x16x32_bf16 v[124:127], a[76:79], a[112:115], v[124:127]
    ds_read_b64_tr_b16 a[112:113], v9 offset:16512
    s_add_u32 s84, s84, s87
    v_mfma_f32_16x16x32_bf16 v[128:131], a[64:67], a[116:119], v[128:131]
    ds_read_b64_tr_b16 a[114:115], v9 offset:20608
    s_waitcnt vmcnt(23)
    v_mfma_f32_16x16x32_bf16 v[132:135], a[68:71], a[116:119], v[132:135]
    s_mul_i32 s87, s29, 7680
    s_sub_u32 s85, s84, s87
    v_mfma_f32_16x16x32_bf16 v[136:139], a[72:75], a[116:119], v[136:139]
    s_waitcnt lgkmcnt(2)
    s_add_u32 s85, s85, 6144
    v_mfma_f32_16x16x32_bf16 v[140:143], a[76:79], a[116:119], v[140:143]
    ds_read_b64_tr_b16 a[116:117], v10 offset:16512
    ds_read_b64_tr_b16 a[118:119], v10 offset:20608
    v_mfma_f32_16x16x32_bf16 v[80:83], a[104:107], a[80:83], v[80:83]
    s_and_b32 s60, s2, 3
    s_lshl_b32 s60, s60, 2
    s_bfe_u32 s61, s2, 0x20003
    v_mfma_f32_16x16x32_bf16 v[84:87], a[104:107], a[84:87], v[84:87]
    s_add_u32 s60, s60, s61
    s_lshr_b32 s61, s2, 5
    v_mfma_f32_16x16x32_bf16 v[88:91], a[104:107], a[88:91], v[88:91]
    s_bfe_u32 s62, s2, 0x10002
    s_xor_b32 s68, s60, s61
    s_and_b32 s68, s68, 3
    v_mfma_f32_16x16x32_bf16 v[92:95], a[104:107], a[92:95], v[92:95]
    ds_read_b64_tr_b16 a[104:105], v6 offset:64
    s_lshl_b32 s101, s68, 17
    v_mfma_f32_16x16x32_bf16 v[96:99], a[108:111], a[80:83], v[96:99]
    ds_read_b64_tr_b16 a[106:107], v6 offset:4160
    s_mul_i32 s63, s62, 28
    s_lshl_b32 s100, s26, 15
    v_mfma_f32_16x16x32_bf16 v[100:103], a[108:111], a[84:87], v[100:103]
    s_lshl_b32 s72, s61, 8
    s_add_u32 s100, s100, s72
    v_mfma_f32_16x16x32_bf16 v[104:107], a[108:111], a[88:91], v[104:107]
    s_waitcnt lgkmcnt(2)
    s_lshl_b32 s73, s62, 7
    s_add_u32 s73, s73, s72
    v_mfma_f32_16x16x32_bf16 v[108:111], a[108:111], a[92:95], v[108:111]
    ds_read_b64_tr_b16 a[108:109], v7 offset:64
    s_and_b32 s30, s26, 1
    v_mfma_f32_16x16x32_bf16 v[112:115], a[80:83], a[112:115], v[112:115]
    ds_read_b64_tr_b16 a[110:111], v7 offset:4160
    s_mul_i32 s30, s30, 24576
    v_mfma_f32_16x16x32_bf16 v[116:119], a[84:87], a[112:115], v[116:119]
    s_sub_u32 s30, s100, s30
    s_xor_b32 s72, s68, 0
    s_add_u32 s72, s72, s63
    v_mfma_f32_16x16x32_bf16 v[120:123], a[88:91], a[112:115], v[120:123]
    s_lshl_b32 s52, s72, 12
    s_lshl_b32 s72, s72, 17
    v_mfma_f32_16x16x32_bf16 v[124:127], a[92:95], a[112:115], v[124:127]
    ds_read_b64_tr_b16 a[112:113], v6 offset:128
    s_add_u32 s56, s72, s30
    s_xor_b32 s72, s68, 1
    v_mfma_f32_16x16x32_bf16 v[128:131], a[80:83], a[116:119], v[128:131]
    ds_read_b64_tr_b16 a[114:115], v6 offset:4224
    s_waitcnt vmcnt(6)
    v_mfma_f32_16x16x32_bf16 v[132:135], a[84:87], a[116:119], v[132:135]
    s_add_u32 s72, s72, s63
    s_lshl_b32 s53, s72, 12
    s_lshl_b32 s72, s72, 17
    v_mfma_f32_16x16x32_bf16 v[136:139], a[88:91], a[116:119], v[136:139]
    s_waitcnt lgkmcnt(2)
    s_add_u32 s57, s72, s30
    v_mfma_f32_16x16x32_bf16 v[140:143], a[92:95], a[116:119], v[140:143]
    ds_read_b64_tr_b16 a[116:117], v7 offset:128
    ds_read_b64_tr_b16 a[118:119], v7 offset:4224
    v_mfma_f32_16x16x32_bf16 v[80:83], a[104:107], a[0:3], v[80:83]
    s_barrier
    s_xor_b32 s72, s68, 2
    s_add_u32 s72, s72, s63
    v_mfma_f32_16x16x32_bf16 v[84:87], a[104:107], a[4:7], v[84:87]
    s_lshl_b32 s54, s72, 12
    s_lshl_b32 s72, s72, 17
    s_add_u32 s58, s72, s30
    v_mfma_f32_16x16x32_bf16 v[88:91], a[104:107], a[8:11], v[88:91]
    s_xor_b32 s72, s68, 3
    s_add_u32 s72, s72, s63
    v_mfma_f32_16x16x32_bf16 v[92:95], a[104:107], a[12:15], v[92:95]
    ds_read_b64_tr_b16 a[104:105], v6 offset:16448
    s_lshl_b32 s55, s72, 12
    s_lshl_b32 s72, s72, 17
    v_mfma_f32_16x16x32_bf16 v[96:99], a[108:111], a[0:3], v[96:99]
    ds_read_b64_tr_b16 a[106:107], v6 offset:20544
    s_add_u32 s59, s72, s30
    v_mfma_f32_16x16x32_bf16 v[100:103], a[108:111], a[4:7], v[100:103]
    s_sub_u32 s63, 28, s63
    s_mul_i32 s72, s62, 4
    s_add_u32 s63, s63, s72
    v_mfma_f32_16x16x32_bf16 v[104:107], a[108:111], a[8:11], v[104:107]
    s_waitcnt lgkmcnt(2)
    s_lshl_b32 s64, s63, 12
    v_mfma_f32_16x16x32_bf16 v[108:111], a[108:111], a[12:15], v[108:111]
    ds_read_b64_tr_b16 a[108:109], v7 offset:16448
    s_lshl_b32 s29, s72, 17
    s_add_u32 s29, s29, s100
    v_mfma_f32_16x16x32_bf16 v[112:115], a[0:3], a[112:115], v[112:115]
    ds_read_b64_tr_b16 a[110:111], v7 offset:20544
    s_sub_u32 s72, 4, s72
    s_lshl_b32 s3, s72, 12
    v_mfma_f32_16x16x32_bf16 v[116:119], a[4:7], a[112:115], v[116:119]
    s_lshl_b32 s74, s60, 2
    s_add_u32 s74, s74, s26
    v_mfma_f32_16x16x32_bf16 v[120:123], a[8:11], a[112:115], v[120:123]
    s_mul_i32 s63, s74, 294912
    s_add_u32 s63, s63, 16777216
    s_add_u32 s32, s24, s63
    v_mfma_f32_16x16x32_bf16 v[124:127], a[12:15], a[112:115], v[124:127]
    ds_read_b64_tr_b16 a[112:113], v6 offset:16512
    s_addc_u32 s33, s25, 0
    v_mfma_f32_16x16x32_bf16 v[128:131], a[0:3], a[116:119], v[128:131]
    ds_read_b64_tr_b16 a[114:115], v6 offset:20608
    s_waitcnt vmcnt(9)
    s_and_b32 s33, s33, 0xffff
    v_mfma_f32_16x16x32_bf16 v[132:135], a[4:7], a[116:119], v[132:135]
    s_mov_b32 s34, 294912
    s_mov_b32 s35, 0x20000
    v_mfma_f32_16x16x32_bf16 v[136:139], a[8:11], a[116:119], v[136:139]
    s_waitcnt lgkmcnt(2)
    s_sub_u32 s36, s16, 4096
    s_subb_u32 s37, s17, 0
    v_mfma_f32_16x16x32_bf16 v[140:143], a[12:15], a[116:119], v[140:143]
    ds_read_b64_tr_b16 a[116:117], v7 offset:16512
    ds_read_b64_tr_b16 a[118:119], v7 offset:20608
    v_mfma_f32_16x16x32_bf16 v[80:83], a[104:107], a[16:19], v[80:83]
    s_and_b32 s37, s37, 0xffff
    s_mov_b32 s38, 7344128
    v_mfma_f32_16x16x32_bf16 v[84:87], a[104:107], a[20:23], v[84:87]
    s_mov_b32 s39, 0x20000
    s_sub_u32 s40, s8, 4096
    v_mfma_f32_16x16x32_bf16 v[88:91], a[104:107], a[24:27], v[88:91]
    s_subb_u32 s41, s9, 0
    s_and_b32 s41, s41, 0xffff
    v_mfma_f32_16x16x32_bf16 v[92:95], a[104:107], a[28:31], v[92:95]
    s_mov_b32 s42, 2101248
    s_mov_b32 s43, 0x20000
    v_mfma_f32_16x16x32_bf16 v[96:99], a[108:111], a[16:19], v[96:99]
    s_lshr_b32 s93, s74, 1
    s_lshl_b32 s93, s93, 9
    v_mfma_f32_16x16x32_bf16 v[100:103], a[108:111], a[20:23], v[100:103]
    s_add_u32 s94, s93, 40927232
    s_lshl_b32 s63, s62, 8
    v_mfma_f32_16x16x32_bf16 v[104:107], a[108:111], a[24:27], v[104:107]
    s_waitcnt lgkmcnt(0)
    s_add_u32 s93, s93, s63
    v_mfma_f32_16x16x32_bf16 v[108:111], a[108:111], a[28:31], v[108:111]
    s_add_u32 s93, s93, 40910848
    v_mfma_f32_16x16x32_bf16 v[112:115], a[16:19], a[112:115], v[112:115]
    s_lshl_b32 s63, s2, 2
    s_add_u32 s63, s63, s26
    v_mfma_f32_16x16x32_bf16 v[116:119], a[20:23], a[112:115], v[116:119]
    s_lshl_b32 s75, s63, 13
    s_add_u32 s75, s75, 41943040
    v_mfma_f32_16x16x32_bf16 v[120:123], a[24:27], a[112:115], v[120:123]
    s_xor_b32 s76, s75, 0x20000
    s_lshl_b32 s77, s63, 6
    v_mfma_f32_16x16x32_bf16 v[124:127], a[28:31], a[112:115], v[124:127]
    s_add_u32 s77, s77, 41025536
    s_xor_b32 s60, s77, 0x400
    v_mfma_f32_16x16x32_bf16 v[128:131], a[16:19], a[116:119], v[128:131]
    s_add_u32 s61, s75, 4096
    s_lshl_b32 s30, s74, 16
    v_mfma_f32_16x16x32_bf16 v[132:135], a[20:23], a[116:119], v[132:135]
    s_add_u32 s30, s30, s73
    s_lshl_b32 s63, s62, 7
    v_mfma_f32_16x16x32_bf16 v[136:139], a[24:27], a[116:119], v[136:139]
    s_waitcnt lgkmcnt(15)
    s_xor_b32 s72, s63, 128
    v_mfma_f32_16x16x32_bf16 v[140:143], a[28:31], a[116:119], v[140:143]
    s_lshl_b32 s31, s26, 13
    v_mfma_f32_16x16x32_bf16 v[48:51], a[96:99], a[48:51], v[48:51]
    v_cvt_pk_bf16_f32 v16, v80, v81
    v_cvt_pk_bf16_f32 v17, v82, v83
    v_mfma_f32_16x16x32_bf16 v[52:55], a[96:99], a[52:55], v[52:55]
    v_cvt_pk_bf16_f32 v18, v96, v97
    v_cvt_pk_bf16_f32 v19, v98, v99
    v_mfma_f32_16x16x32_bf16 v[56:59], a[96:99], a[56:59], v[56:59]
    buffer_store_dwordx4 v[16:19], v1, s[44:47], s78 offen offset:0 sc1
    ds_write_b128 v37, v[16:19] offset:16384
    v_mfma_f32_16x16x32_bf16 v[60:63], a[96:99], a[60:63], v[60:63]
    ds_read_b64_tr_b16 a[96:97], v9 offset:0
    v_cvt_pk_bf16_f32 v20, v84, v85
    v_mfma_f32_16x16x32_bf16 v[64:67], a[100:103], a[48:51], v[64:67]
    ds_read_b64_tr_b16 a[98:99], v9 offset:4096
    v_cvt_pk_bf16_f32 v21, v86, v87
    v_mfma_f32_16x16x32_bf16 v[68:71], a[100:103], a[52:55], v[68:71]
    v_cvt_pk_bf16_f32 v22, v100, v101
    v_cvt_pk_bf16_f32 v23, v102, v103
    v_mfma_f32_16x16x32_bf16 v[72:75], a[100:103], a[56:59], v[72:75]
    buffer_store_dwordx4 v[20:23], v1, s[44:47], s78 offen offset:1024 sc1
    ds_write_b128 v37, v[20:23] offset:17408
    v_mfma_f32_16x16x32_bf16 v[76:79], a[100:103], a[60:63], v[76:79]
    ds_read_b64_tr_b16 a[100:101], v10 offset:0
    v_cvt_pk_bf16_f32 v24, v88, v89
    v_mfma_f32_16x16x32_bf16 v[144:147], a[120:123], a[48:51], v[144:147]
    ds_read_b64_tr_b16 a[102:103], v10 offset:4096
    v_mfma_f32_16x16x32_bf16 v[148:151], a[120:123], a[52:55], v[148:151]
    v_cvt_pk_bf16_f32 v25, v90, v91
    v_cvt_pk_bf16_f32 v26, v104, v105
    v_mfma_f32_16x16x32_bf16 v[152:155], a[120:123], a[56:59], v[152:155]
    v_cvt_pk_bf16_f32 v27, v106, v107
    buffer_store_dwordx4 v[24:27], v1, s[44:47], s78 offen offset:2048 sc1
    v_mfma_f32_16x16x32_bf16 v[156:159], a[120:123], a[60:63], v[156:159]
    ds_read_b64_tr_b16 a[120:121], v11 offset:0
    ds_write_b128 v37, v[24:27] offset:18432
    v_mfma_f32_16x16x32_bf16 v[160:163], a[124:127], a[48:51], v[160:163]
    ds_read_b64_tr_b16 a[122:123], v11 offset:3584
    v_cvt_pk_bf16_f32 v28, v92, v93
    v_mfma_f32_16x16x32_bf16 v[164:167], a[124:127], a[52:55], v[164:167]
    v_cvt_pk_bf16_f32 v29, v94, v95
    v_cvt_pk_bf16_f32 v30, v108, v109
    v_mfma_f32_16x16x32_bf16 v[168:171], a[124:127], a[56:59], v[168:171]
    v_cvt_pk_bf16_f32 v31, v110, v111
    buffer_store_dwordx4 v[28:31], v1, s[44:47], s78 offen offset:3072 sc1
    v_mfma_f32_16x16x32_bf16 v[172:175], a[124:127], a[60:63], v[172:175]
    ds_read_b64_tr_b16 a[124:125], v11 offset:32
    ds_write_b128 v37, v[28:31] offset:19456
    v_mfma_f32_16x16x32_bf16 v[176:179], a[128:131], a[48:51], v[176:179]
    ds_read_b64_tr_b16 a[126:127], v11 offset:3616
    v_cvt_pk_bf16_f32 v16, v112, v113
    v_mfma_f32_16x16x32_bf16 v[180:183], a[128:131], a[52:55], v[180:183]
    v_cvt_pk_bf16_f32 v17, v114, v115
    v_mfma_f32_16x16x32_bf16 v[184:187], a[128:131], a[56:59], v[184:187]
    s_waitcnt lgkmcnt(15)
    v_cvt_pk_bf16_f32 v18, v116, v117
    v_mfma_f32_16x16x32_bf16 v[188:191], a[128:131], a[60:63], v[188:191]
    ds_read_b64_tr_b16 a[128:129], v11 offset:64
    v_cvt_pk_bf16_f32 v19, v118, v119
    v_mfma_f32_16x16x32_bf16 v[192:195], a[132:135], a[48:51], v[192:195]
    ds_read_b64_tr_b16 a[130:131], v11 offset:3648
    buffer_store_dwordx4 v[16:19], v1, s[44:47], s79 offen offset:0 sc1
    v_mfma_f32_16x16x32_bf16 v[196:199], a[132:135], a[52:55], v[196:199]
    ds_write_b128 v37, v[16:19] offset:49152
    v_cvt_pk_bf16_f32 v20, v128, v129
    v_mfma_f32_16x16x32_bf16 v[200:203], a[132:135], a[56:59], v[200:203]
    v_cvt_pk_bf16_f32 v21, v130, v131
    v_cvt_pk_bf16_f32 v22, v132, v133
    v_mfma_f32_16x16x32_bf16 v[204:207], a[132:135], a[60:63], v[204:207]
    ds_read_b64_tr_b16 a[132:133], v11 offset:96
    v_cvt_pk_bf16_f32 v23, v134, v135
    v_mfma_f32_16x16x32_bf16 v[208:211], a[136:139], a[48:51], v[208:211]
    ds_read_b64_tr_b16 a[134:135], v11 offset:3680
    buffer_store_dwordx4 v[20:23], v1, s[44:47], s79 offen offset:1024 sc1
    v_mfma_f32_16x16x32_bf16 v[212:215], a[136:139], a[52:55], v[212:215]
    ds_write_b128 v37, v[20:23] offset:50176
    v_cvt_pk_bf16_f32 v24, v120, v121
    v_mfma_f32_16x16x32_bf16 v[216:219], a[136:139], a[56:59], v[216:219]
    v_cvt_pk_bf16_f32 v25, v122, v123
    v_mfma_f32_16x16x32_bf16 v[220:223], a[136:139], a[60:63], v[220:223]
    ds_read_b64_tr_b16 a[136:137], v11 offset:128
    v_cvt_pk_bf16_f32 v26, v124, v125
    v_mfma_f32_16x16x32_bf16 v[224:227], a[140:143], a[48:51], v[224:227]
    ds_read_b64_tr_b16 a[138:139], v11 offset:3712
    v_cvt_pk_bf16_f32 v27, v126, v127
    v_mfma_f32_16x16x32_bf16 v[228:231], a[140:143], a[52:55], v[228:231]
    buffer_store_dwordx4 v[24:27], v1, s[44:47], s79 offen offset:2048 sc1
    ds_write_b128 v37, v[24:27] offset:51200
    v_mfma_f32_16x16x32_bf16 v[232:235], a[140:143], a[56:59], v[232:235]
    v_cvt_pk_bf16_f32 v28, v136, v137
    v_cvt_pk_bf16_f32 v29, v138, v139
    v_mfma_f32_16x16x32_bf16 v[236:239], a[140:143], a[60:63], v[236:239]
    ds_read_b64_tr_b16 a[140:141], v11 offset:160
    v_cvt_pk_bf16_f32 v30, v140, v141
    v_mfma_f32_16x16x32_bf16 v[240:243], a[144:147], a[48:51], v[240:243]
    ds_read_b64_tr_b16 a[142:143], v11 offset:3744
    v_cvt_pk_bf16_f32 v31, v142, v143
    v_mfma_f32_16x16x32_bf16 v[244:247], a[144:147], a[52:55], v[244:247]
    buffer_store_dwordx4 v[28:31], v1, s[44:47], s79 offen offset:3072 sc1
    ds_write_b128 v37, v[28:31] offset:52224
    v_mfma_f32_16x16x32_bf16 v[248:251], a[144:147], a[56:59], v[248:251]
    s_waitcnt lgkmcnt(10)
    v_mfma_f32_16x16x32_bf16 v[252:255], a[144:147], a[60:63], v[252:255]
    ds_read_b64_tr_b16 a[144:145], v11 offset:192
    ds_read_b64_tr_b16 a[146:147], v11 offset:3776
    v_mfma_f32_16x16x32_bf16 v[48:51], a[96:99], a[64:67], v[48:51]
    v_lshrrev_b32 v112, 3, v0
    v_bfe_u32 v113, v0, 1, 2
    v_bfe_u32 v114, v0, 4, 2
    v_mfma_f32_16x16x32_bf16 v[52:55], a[96:99], a[68:71], v[52:55]
    v_xor_b32 v113, v113, v114
    v_lshlrev_b32 v112, 11, v112
    v_mfma_f32_16x16x32_bf16 v[56:59], a[96:99], a[72:75], v[56:59]
    v_lshl_add_u32 v112, v113, 5, v112
    v_and_b32 v113, 1, v0
    v_lshl_add_u32 v112, v113, 4, v112
    v_mfma_f32_16x16x32_bf16 v[60:63], a[96:99], a[76:79], v[60:63]
    ds_read_b64_tr_b16 a[96:97], v9 offset:16384
    v_add_u32 v113, s63, v112
    v_mfma_f32_16x16x32_bf16 v[64:67], a[100:103], a[64:67], v[64:67]
    ds_read_b64_tr_b16 a[98:99], v9 offset:20480
    v_add_u32 v12, 4096, v113
    v_add_u32 v13, 19456, v113
    v_mfma_f32_16x16x32_bf16 v[68:71], a[100:103], a[68:71], v[68:71]
    v_add_u32 v113, s72, v112
    v_add_u32 v14, 2048, v113
    v_mfma_f32_16x16x32_bf16 v[72:75], a[100:103], a[72:75], v[72:75]
    v_add_u32 v15, 17408, v113
    v_lshrrev_b32 v113, 5, v0
    v_lshlrev_b32 v113, 13, v113
    v_mfma_f32_16x16x32_bf16 v[76:79], a[100:103], a[76:79], v[76:79]
    ds_read_b64_tr_b16 a[100:101], v10 offset:16384
    v_add_u32 v114, 16384, v113
    v_mfma_f32_16x16x32_bf16 v[144:147], a[120:123], a[64:67], v[144:147]
    ds_read_b64_tr_b16 a[102:103], v10 offset:20480
    v_add_u32 v40, v12, v113
    v_mfma_f32_16x16x32_bf16 v[148:151], a[120:123], a[68:71], v[148:151]
    v_add_u32 v41, v13, v114
    v_add_u32 v42, v14, v113
    v_add_u32 v43, v15, v114
    v_mfma_f32_16x16x32_bf16 v[152:155], a[120:123], a[72:75], v[152:155]
    v_and_b32 v112, 15, v0
    v_lshlrev_b32 v33, 4, v112
    v_mfma_f32_16x16x32_bf16 v[156:159], a[120:123], a[76:79], v[156:159]
    ds_read_b64_tr_b16 a[120:121], v11 offset:16384
    v_bfe_u32 v112, v0, 4, 1
    v_lshl_add_u32 v33, v112, 10, v33
    v_mfma_f32_16x16x32_bf16 v[160:163], a[124:127], a[64:67], v[160:163]
    ds_read_b64_tr_b16 a[122:123], v11 offset:19968
    v_lshrrev_b32 v112, 5, v0
    v_mfma_f32_16x16x32_bf16 v[164:167], a[124:127], a[68:71], v[164:167]
    v_lshl_add_u32 v33, v112, 8, v33
    v_and_b32 v38, 15, v0
    v_lshlrev_b32 v38, 4, v38
    v_mfma_f32_16x16x32_bf16 v[168:171], a[124:127], a[72:75], v[168:171]
    v_and_b32 v39, 31, v0
    v_lshlrev_b32 v39, 4, v39
    v_mfma_f32_16x16x32_bf16 v[172:175], a[124:127], a[76:79], v[172:175]
    ds_read_b64_tr_b16 a[124:125], v11 offset:16416
    v_lshrrev_b32 v112, 2, v0
    v_and_b32 v113, 3, v0
    v_mfma_f32_16x16x32_bf16 v[176:179], a[128:131], a[64:67], v[176:179]
    ds_read_b64_tr_b16 a[126:127], v11 offset:20000
    v_lshlrev_b32 v113, 3, v113
    v_mfma_f32_16x16x32_bf16 v[180:183], a[128:131], a[68:71], v[180:183]
    v_lshl_add_u32 v113, v112, 7, v113
    v_bfe_u32 v112, v0, 3, 2
    v_mfma_f32_16x16x32_bf16 v[184:187], a[128:131], a[72:75], v[184:187]
    s_waitcnt lgkmcnt(8)
    v_xor_b32 v114, 0, v112
    v_lshl_add_u32 v128, v114, 5, v113
    v_mfma_f32_16x16x32_bf16 v[188:191], a[128:131], a[76:79], v[188:191]
    ds_read_b64_tr_b16 a[128:129], v11 offset:16448
    v_add_u32 v132, 0x10000, v128
    v_mfma_f32_16x16x32_bf16 v[192:195], a[132:135], a[64:67], v[192:195]
    ds_read_b64_tr_b16 a[130:131], v11 offset:20032
    v_xor_b32 v114, 1, v112
    v_lshl_add_u32 v129, v114, 5, v113
    v_mfma_f32_16x16x32_bf16 v[196:199], a[132:135], a[68:71], v[196:199]
    v_add_u32 v133, 0x10000, v129
    v_xor_b32 v114, 2, v112
    v_mfma_f32_16x16x32_bf16 v[200:203], a[132:135], a[72:75], v[200:203]
    v_lshl_add_u32 v130, v114, 5, v113
    v_add_u32 v134, 0x10000, v130
    v_xor_b32 v114, 3, v112
    v_mfma_f32_16x16x32_bf16 v[204:207], a[132:135], a[76:79], v[204:207]
    ds_read_b64_tr_b16 a[132:133], v11 offset:16480
    v_lshl_add_u32 v131, v114, 5, v113
    v_mfma_f32_16x16x32_bf16 v[208:211], a[136:139], a[64:67], v[208:211]
    ds_read_b64_tr_b16 a[134:135], v11 offset:20064
    v_add_u32 v135, 0x10000, v131
    v_and_b32 v112, 15, v0
    v_mfma_f32_16x16x32_bf16 v[212:215], a[136:139], a[68:71], v[212:215]
    v_lshrrev_b32 v113, 4, v0
    v_lshlrev_b32 v141, 3, v113
    v_mfma_f32_16x16x32_bf16 v[216:219], a[136:139], a[72:75], v[216:219]
    v_and_b32 v114, 7, v0
    v_xor_b32 v113, v113, v114
    v_mfma_f32_16x16x32_bf16 v[220:223], a[136:139], a[76:79], v[220:223]
    ds_read_b64_tr_b16 a[136:137], v11 offset:16512
    v_lshlrev_b32 v112, 8, v112
    v_add_u32 v112, s31, v112
    v_mfma_f32_16x16x32_bf16 v[224:227], a[140:143], a[64:67], v[224:227]
    ds_read_b64_tr_b16 a[138:139], v11 offset:20096
    v_lshl_add_u32 v136, v113, 4, v112
    v_mfma_f32_16x16x32_bf16 v[228:231], a[140:143], a[68:71], v[228:231]
    v_xor_b32 v113, 4, v113
    v_lshl_add_u32 v137, v113, 4, v112
    v_lshrrev_b32 v112, 3, v0
    v_mfma_f32_16x16x32_bf16 v[232:235], a[140:143], a[72:75], v[232:235]
    v_lshlrev_b32 v113, 1, v114
    v_xor_b32 v113, v113, v112
    v_mfma_f32_16x16x32_bf16 v[236:239], a[140:143], a[76:79], v[236:239]
    ds_read_b64_tr_b16 a[140:141], v11 offset:16544
    v_lshlrev_b32 v140, 11, v112
    v_lshl_add_u32 v140, v114, 4, v140
    v_mfma_f32_16x16x32_bf16 v[240:243], a[144:147], a[64:67], v[240:243]
    ds_read_b64_tr_b16 a[142:143], v11 offset:20128
    v_lshlrev_b32 v112, 8, v112
    v_mfma_f32_16x16x32_bf16 v[244:247], a[144:147], a[68:71], v[244:247]
    v_add_u32 v112, s31, v112
    v_lshl_add_u32 v138, v113, 4, v112
    v_xor_b32 v113, 1, v113
    v_mfma_f32_16x16x32_bf16 v[248:251], a[144:147], a[72:75], v[248:251]
    s_waitcnt lgkmcnt(6)
    v_lshl_add_u32 v139, v113, 4, v112
    v_mfma_f32_16x16x32_bf16 v[252:255], a[144:147], a[76:79], v[252:255]
    ds_read_b64_tr_b16 a[144:145], v11 offset:16576
    ds_read_b64_tr_b16 a[146:147], v11 offset:20160
    v_mfma_f32_16x16x32_bf16 v[48:51], a[96:99], a[80:83], v[48:51]
    v_and_b32 v112, 15, v0
    v_lshrrev_b32 v113, 4, v0
    v_mfma_f32_16x16x32_bf16 v[52:55], a[96:99], a[84:87], v[52:55]
    v_lshlrev_b32 v113, 2, v113
    v_mfma_f32_16x16x32_bf16 v[56:59], a[96:99], a[88:91], v[56:59]
    v_mov_b32 v114, 0xf149f2ca
    v_add_u32 v115, 0, v113
    v_mfma_f32_16x16x32_bf16 v[60:63], a[96:99], a[92:95], v[60:63]
    ds_read_b64_tr_b16 a[96:97], v6 offset:0
    v_mfma_f32_16x16x32_bf16 v[64:67], a[100:103], a[80:83], v[64:67]
    ds_read_b64_tr_b16 a[98:99], v6 offset:4096
    v_mfma_f32_16x16x32_bf16 v[68:71], a[100:103], a[84:87], v[68:71]
    v_cmp_lt_u32 vcc, v112, v115
    v_mov_b32 v104, v114
    v_mfma_f32_16x16x32_bf16 v[72:75], a[100:103], a[88:91], v[72:75]
    v_cndmask_b32_e64 v96, v114, 0, vcc
    v_mfma_f32_16x16x32_bf16 v[76:79], a[100:103], a[92:95], v[76:79]
    ds_read_b64_tr_b16 a[100:101], v7 offset:0
    v_mfma_f32_16x16x32_bf16 v[144:147], a[120:123], a[80:83], v[144:147]
    ds_read_b64_tr_b16 a[102:103], v7 offset:4096
    v_cndmask_b32_e64 v100, 0, v114, vcc
    v_mfma_f32_16x16x32_bf16 v[148:151], a[120:123], a[84:87], v[148:151]
    v_add_u32 v115, 1, v113
    v_mfma_f32_16x16x32_bf16 v[152:155], a[120:123], a[88:91], v[152:155]
    v_cmp_lt_u32 vcc, v112, v115
    v_mov_b32 v105, v114
    v_mfma_f32_16x16x32_bf16 v[156:159], a[120:123], a[92:95], v[156:159]
    ds_read_b64_tr_b16 a[120:121], v8 offset:0
    v_mfma_f32_16x16x32_bf16 v[160:163], a[124:127], a[80:83], v[160:163]
    ds_read_b64_tr_b16 a[122:123], v8 offset:3584
    v_mfma_f32_16x16x32_bf16 v[164:167], a[124:127], a[84:87], v[164:167]
    v_cndmask_b32_e64 v97, v114, 0, vcc
    v_cndmask_b32_e64 v101, 0, v114, vcc
    v_mfma_f32_16x16x32_bf16 v[168:171], a[124:127], a[88:91], v[168:171]
    v_add_u32 v115, 2, v113
    v_mfma_f32_16x16x32_bf16 v[172:175], a[124:127], a[92:95], v[172:175]
    ds_read_b64_tr_b16 a[124:125], v8 offset:32
    v_mfma_f32_16x16x32_bf16 v[176:179], a[128:131], a[80:83], v[176:179]
    ds_read_b64_tr_b16 a[126:127], v8 offset:3616
    v_cmp_lt_u32 vcc, v112, v115
    v_mfma_f32_16x16x32_bf16 v[180:183], a[128:131], a[84:87], v[180:183]
    v_mov_b32 v106, v114
    v_mfma_f32_16x16x32_bf16 v[184:187], a[128:131], a[88:91], v[184:187]
    s_waitcnt lgkmcnt(8)
    v_cndmask_b32_e64 v98, v114, 0, vcc
    v_mfma_f32_16x16x32_bf16 v[188:191], a[128:131], a[92:95], v[188:191]
    ds_read_b64_tr_b16 a[128:129], v8 offset:64
    v_mfma_f32_16x16x32_bf16 v[192:195], a[132:135], a[80:83], v[192:195]
    ds_read_b64_tr_b16 a[130:131], v8 offset:3648
    v_mfma_f32_16x16x32_bf16 v[196:199], a[132:135], a[84:87], v[196:199]
    v_cndmask_b32_e64 v102, 0, v114, vcc
    v_add_u32 v115, 3, v113
    v_mfma_f32_16x16x32_bf16 v[200:203], a[132:135], a[88:91], v[200:203]
    v_cmp_lt_u32 vcc, v112, v115
    v_mfma_f32_16x16x32_bf16 v[204:207], a[132:135], a[92:95], v[204:207]
    ds_read_b64_tr_b16 a[132:133], v8 offset:96
    v_mfma_f32_16x16x32_bf16 v[208:211], a[136:139], a[80:83], v[208:211]
    ds_read_b64_tr_b16 a[134:135], v8 offset:3680
    v_mov_b32 v107, v114
    v_mfma_f32_16x16x32_bf16 v[212:215], a[136:139], a[84:87], v[212:215]
    v_cndmask_b32_e64 v99, v114, 0, vcc
    v_mfma_f32_16x16x32_bf16 v[216:219], a[136:139], a[88:91], v[216:219]
    v_cndmask_b32_e64 v103, 0, v114, vcc
    v_mov_b32 v115, 0x3f803f80
    v_mfma_f32_16x16x32_bf16 v[220:223], a[136:139], a[92:95], v[220:223]
    ds_read_b64_tr_b16 a[136:137], v8 offset:128
    v_mfma_f32_16x16x32_bf16 v[224:227], a[140:143], a[80:83], v[224:227]
    ds_read_b64_tr_b16 a[138:139], v8 offset:3712
    v_mfma_f32_16x16x32_bf16 v[228:231], a[140:143], a[84:87], v[228:231]
    v_add_u32 v36, 12288, v37
    v_accvgpr_write_b32 a232, v115
    v_mfma_f32_16x16x32_bf16 v[232:235], a[140:143], a[88:91], v[232:235]
    v_accvgpr_write_b32 a233, v115
    v_mfma_f32_16x16x32_bf16 v[236:239], a[140:143], a[92:95], v[236:239]
    ds_read_b64_tr_b16 a[140:141], v8 offset:160
    v_mfma_f32_16x16x32_bf16 v[240:243], a[144:147], a[80:83], v[240:243]
    ds_read_b64_tr_b16 a[142:143], v8 offset:3744
    v_accvgpr_write_b32 a234, v115
    v_mfma_f32_16x16x32_bf16 v[244:247], a[144:147], a[84:87], v[244:247]
    v_accvgpr_write_b32 a235, v115
    v_mfma_f32_16x16x32_bf16 v[248:251], a[144:147], a[88:91], v[248:251]
    s_waitcnt lgkmcnt(6)
    v_mfma_f32_16x16x32_bf16 v[252:255], a[144:147], a[92:95], v[252:255]
    ds_read_b64_tr_b16 a[144:145], v8 offset:192
    ds_read_b64_tr_b16 a[146:147], v8 offset:3776
    s_waitcnt vmcnt(0)
    s_mov_b64 exec, 1
    buffer_store_dwordx2 v[44:45], v46, s[44:47], s82 offen sc1
    s_mov_b64 exec, -1
    v_mfma_f32_16x16x32_bf16 v[48:51], a[96:99], a[0:3], v[48:51]
    v_mfma_f32_16x16x32_bf16 v[52:55], a[96:99], a[4:7], v[52:55]
    v_mfma_f32_16x16x32_bf16 v[56:59], a[96:99], a[8:11], v[56:59]
    v_mfma_f32_16x16x32_bf16 v[60:63], a[96:99], a[12:15], v[60:63]
    ds_read_b64_tr_b16 a[96:97], v6 offset:16384
    v_mfma_f32_16x16x32_bf16 v[64:67], a[100:103], a[0:3], v[64:67]
    ds_read_b64_tr_b16 a[98:99], v6 offset:20480
    v_mfma_f32_16x16x32_bf16 v[68:71], a[100:103], a[4:7], v[68:71]
    v_mfma_f32_16x16x32_bf16 v[72:75], a[100:103], a[8:11], v[72:75]
    v_mfma_f32_16x16x32_bf16 v[76:79], a[100:103], a[12:15], v[76:79]
    ds_read_b64_tr_b16 a[100:101], v7 offset:16384
    v_mfma_f32_16x16x32_bf16 v[144:147], a[120:123], a[0:3], v[144:147]
    ds_read_b64_tr_b16 a[102:103], v7 offset:20480
    v_mfma_f32_16x16x32_bf16 v[148:151], a[120:123], a[4:7], v[148:151]
    v_mfma_f32_16x16x32_bf16 v[152:155], a[120:123], a[8:11], v[152:155]
    v_mfma_f32_16x16x32_bf16 v[156:159], a[120:123], a[12:15], v[156:159]
    ds_read_b64_tr_b16 a[120:121], v8 offset:16384
    v_mfma_f32_16x16x32_bf16 v[160:163], a[124:127], a[0:3], v[160:163]
    ds_read_b64_tr_b16 a[122:123], v8 offset:19968
    v_mfma_f32_16x16x32_bf16 v[164:167], a[124:127], a[4:7], v[164:167]
    v_mfma_f32_16x16x32_bf16 v[168:171], a[124:127], a[8:11], v[168:171]
    v_mfma_f32_16x16x32_bf16 v[172:175], a[124:127], a[12:15], v[172:175]
    ds_read_b64_tr_b16 a[124:125], v8 offset:16416
    v_mfma_f32_16x16x32_bf16 v[176:179], a[128:131], a[0:3], v[176:179]
    ds_read_b64_tr_b16 a[126:127], v8 offset:20000
    v_mfma_f32_16x16x32_bf16 v[180:183], a[128:131], a[4:7], v[180:183]
    v_mfma_f32_16x16x32_bf16 v[184:187], a[128:131], a[8:11], v[184:187]
    s_waitcnt lgkmcnt(8)
    v_mfma_f32_16x16x32_bf16 v[188:191], a[128:131], a[12:15], v[188:191]
    ds_read_b64_tr_b16 a[128:129], v8 offset:16448
    v_mfma_f32_16x16x32_bf16 v[192:195], a[132:135], a[0:3], v[192:195]
    ds_read_b64_tr_b16 a[130:131], v8 offset:20032
    v_mfma_f32_16x16x32_bf16 v[196:199], a[132:135], a[4:7], v[196:199]
    v_mfma_f32_16x16x32_bf16 v[200:203], a[132:135], a[8:11], v[200:203]
    v_mfma_f32_16x16x32_bf16 v[204:207], a[132:135], a[12:15], v[204:207]
    ds_read_b64_tr_b16 a[132:133], v8 offset:16480
    v_mfma_f32_16x16x32_bf16 v[208:211], a[136:139], a[0:3], v[208:211]
    ds_read_b64_tr_b16 a[134:135], v8 offset:20064
    v_mfma_f32_16x16x32_bf16 v[212:215], a[136:139], a[4:7], v[212:215]
    v_mfma_f32_16x16x32_bf16 v[216:219], a[136:139], a[8:11], v[216:219]
    v_mfma_f32_16x16x32_bf16 v[220:223], a[136:139], a[12:15], v[220:223]
    ds_read_b64_tr_b16 a[136:137], v8 offset:16512
    v_mfma_f32_16x16x32_bf16 v[224:227], a[140:143], a[0:3], v[224:227]
    ds_read_b64_tr_b16 a[138:139], v8 offset:20096
    v_mfma_f32_16x16x32_bf16 v[228:231], a[140:143], a[4:7], v[228:231]
    v_mfma_f32_16x16x32_bf16 v[232:235], a[140:143], a[8:11], v[232:235]
    v_mfma_f32_16x16x32_bf16 v[236:239], a[140:143], a[12:15], v[236:239]
    ds_read_b64_tr_b16 a[140:141], v8 offset:16544
    v_mfma_f32_16x16x32_bf16 v[240:243], a[144:147], a[0:3], v[240:243]
    ds_read_b64_tr_b16 a[142:143], v8 offset:20128
    v_mfma_f32_16x16x32_bf16 v[244:247], a[144:147], a[4:7], v[244:247]
    v_mfma_f32_16x16x32_bf16 v[248:251], a[144:147], a[8:11], v[248:251]
    s_waitcnt lgkmcnt(6)
    v_mfma_f32_16x16x32_bf16 v[252:255], a[144:147], a[12:15], v[252:255]
    ds_read_b64_tr_b16 a[144:145], v8 offset:16576
    ds_read_b64_tr_b16 a[146:147], v8 offset:20160
    v_mfma_f32_16x16x32_bf16 v[48:51], a[96:99], a[16:19], v[48:51]
    v_mfma_f32_16x16x32_bf16 v[52:55], a[96:99], a[20:23], v[52:55]
    v_mfma_f32_16x16x32_bf16 v[56:59], a[96:99], a[24:27], v[56:59]
    v_mfma_f32_16x16x32_bf16 v[60:63], a[96:99], a[28:31], v[60:63]
    v_mfma_f32_16x16x32_bf16 v[64:67], a[100:103], a[16:19], v[64:67]
    v_mfma_f32_16x16x32_bf16 v[68:71], a[100:103], a[20:23], v[68:71]
    v_mfma_f32_16x16x32_bf16 v[72:75], a[100:103], a[24:27], v[72:75]
    v_mfma_f32_16x16x32_bf16 v[76:79], a[100:103], a[28:31], v[76:79]
    v_mfma_f32_16x16x32_bf16 v[144:147], a[120:123], a[16:19], v[144:147]
    v_mfma_f32_16x16x32_bf16 v[148:151], a[120:123], a[20:23], v[148:151]
    v_mfma_f32_16x16x32_bf16 v[152:155], a[120:123], a[24:27], v[152:155]
    v_mfma_f32_16x16x32_bf16 v[156:159], a[120:123], a[28:31], v[156:159]
    v_mfma_f32_16x16x32_bf16 v[160:163], a[124:127], a[16:19], v[160:163]
    v_mul_f32 v48, v2, v48
    v_mul_f32 v49, v2, v49
    v_mul_f32 v50, v2, v50
    v_mfma_f32_16x16x32_bf16 v[164:167], a[124:127], a[20:23], v[164:167]
    v_mul_f32 v51, v2, v51
    v_cvt_pk_bf16_f32 v48, v48, v49
    v_mfma_f32_16x16x32_bf16 v[168:171], a[124:127], a[24:27], v[168:171]
    v_cvt_pk_bf16_f32 v49, v50, v51
    v_mul_f32 v64, v2, v64
    v_mfma_f32_16x16x32_bf16 v[172:175], a[124:127], a[28:31], v[172:175]
    v_mul_f32 v65, v2, v65
    v_mul_f32 v66, v2, v66
    v_mfma_f32_16x16x32_bf16 v[176:179], a[128:131], a[16:19], v[176:179]
    v_mul_f32 v67, v2, v67
    v_cvt_pk_bf16_f32 v50, v64, v65
    v_mfma_f32_16x16x32_bf16 v[180:183], a[128:131], a[20:23], v[180:183]
    v_cvt_pk_bf16_f32 v51, v66, v67
    v_mul_f32 v52, v2, v52
    v_mfma_f32_16x16x32_bf16 v[184:187], a[128:131], a[24:27], v[184:187]
    s_waitcnt lgkmcnt(0)
    v_mul_f32 v53, v2, v53
    v_mfma_f32_16x16x32_bf16 v[188:191], a[128:131], a[28:31], v[188:191]
    v_mul_f32 v54, v2, v54
    v_mul_f32 v55, v2, v55
    v_mfma_f32_16x16x32_bf16 v[192:195], a[132:135], a[16:19], v[192:195]
    v_cvt_pk_bf16_f32 v52, v52, v53
    v_cvt_pk_bf16_f32 v53, v54, v55
    v_mfma_f32_16x16x32_bf16 v[196:199], a[132:135], a[20:23], v[196:199]
    v_mul_f32 v68, v2, v68
    v_mul_f32 v69, v2, v69
    v_mfma_f32_16x16x32_bf16 v[200:203], a[132:135], a[24:27], v[200:203]
    v_mul_f32 v70, v2, v70
    v_mul_f32 v71, v2, v71
    v_mfma_f32_16x16x32_bf16 v[204:207], a[132:135], a[28:31], v[204:207]
    v_cvt_pk_bf16_f32 v54, v68, v69
    v_cvt_pk_bf16_f32 v55, v70, v71
    v_mfma_f32_16x16x32_bf16 v[208:211], a[136:139], a[16:19], v[208:211]
    v_mul_f32 v56, v2, v56
    v_mul_f32 v57, v2, v57
    v_mfma_f32_16x16x32_bf16 v[212:215], a[136:139], a[20:23], v[212:215]
    v_mul_f32 v58, v2, v58
    v_mul_f32 v59, v2, v59
    v_mfma_f32_16x16x32_bf16 v[216:219], a[136:139], a[24:27], v[216:219]
    v_cvt_pk_bf16_f32 v56, v56, v57
    v_cvt_pk_bf16_f32 v57, v58, v59
    v_mfma_f32_16x16x32_bf16 v[220:223], a[136:139], a[28:31], v[220:223]
    v_mul_f32 v72, v2, v72
    v_mul_f32 v73, v2, v73
    v_mfma_f32_16x16x32_bf16 v[224:227], a[140:143], a[16:19], v[224:227]
    v_mul_f32 v74, v2, v74
    v_mul_f32 v75, v2, v75
    v_mfma_f32_16x16x32_bf16 v[228:231], a[140:143], a[20:23], v[228:231]
    v_cvt_pk_bf16_f32 v58, v72, v73
    v_cvt_pk_bf16_f32 v59, v74, v75
    v_mfma_f32_16x16x32_bf16 v[232:235], a[140:143], a[24:27], v[232:235]
    v_mul_f32 v60, v2, v60
    v_mul_f32 v61, v2, v61
    v_mfma_f32_16x16x32_bf16 v[236:239], a[140:143], a[28:31], v[236:239]
    v_mul_f32 v62, v2, v62
    v_mul_f32 v63, v2, v63
    v_mfma_f32_16x16x32_bf16 v[240:243], a[144:147], a[16:19], v[240:243]
    v_cvt_pk_bf16_f32 v60, v60, v61
    v_cvt_pk_bf16_f32 v61, v62, v63
    v_mfma_f32_16x16x32_bf16 v[244:247], a[144:147], a[20:23], v[244:247]
    v_mul_f32 v76, v2, v76
    v_mul_f32 v77, v2, v77
    v_mfma_f32_16x16x32_bf16 v[248:251], a[144:147], a[24:27], v[248:251]
    v_mul_f32 v78, v2, v78
    v_mul_f32 v79, v2, v79
    v_mfma_f32_16x16x32_bf16 v[252:255], a[144:147], a[28:31], v[252:255]
    v_cvt_pk_bf16_f32 v62, v76, v77
    v_cvt_pk_bf16_f32 v63, v78, v79
    v_mov_b32 v2, 0xc0135761
    v_mov_b32 v4, 0xbdd2d3e8
    buffer_load_dwordx2 v[34:35], v46, s[44:47], s83 offen sc1
    v_pk_mul_f32 v[64:65], v[144:145], v[144:145]
    v_pk_mul_f32 v[66:67], v[146:147], v[146:147]
    v_pk_fma_f32 v[64:65], v[64:65], v[4:5], v[2:3] op_sel_hi:[1,0,0]
    v_pk_fma_f32 v[66:67], v[66:67], v[4:5], v[2:3] op_sel_hi:[1,0,0]
    v_pk_mul_f32 v[64:65], v[64:65], v[144:145]
    v_pk_mul_f32 v[66:67], v[66:67], v[146:147]
    v_exp_f32 v64, v64
    v_exp_f32 v65, v65
    v_exp_f32 v66, v66
    v_exp_f32 v67, v67
    v_pk_add_f32 v[64:65], v[64:65], 1.0 op_sel_hi:[1,0]
    v_pk_add_f32 v[66:67], v[66:67], 1.0 op_sel_hi:[1,0]
    v_rcp_f32 v64, v64
    v_rcp_f32 v65, v65
    v_rcp_f32 v66, v66
    v_rcp_f32 v67, v67
    v_pk_mul_f32 v[144:145], v[144:145], v[64:65]
    v_pk_mul_f32 v[146:147], v[146:147], v[66:67]
    v_cvt_pk_bf16_f32 v144, v144, v145
    v_cvt_pk_bf16_f32 v145, v146, v147
    v_pk_mul_f32 v[68:69], v[148:149], v[148:149]
    v_pk_mul_f32 v[70:71], v[150:151], v[150:151]
    v_pk_fma_f32 v[68:69], v[68:69], v[4:5], v[2:3] op_sel_hi:[1,0,0]
    v_pk_fma_f32 v[70:71], v[70:71], v[4:5], v[2:3] op_sel_hi:[1,0,0]
    v_pk_mul_f32 v[68:69], v[68:69], v[148:149]
    v_pk_mul_f32 v[70:71], v[70:71], v[150:151]
    v_exp_f32 v68, v68
    v_exp_f32 v69, v69
    v_exp_f32 v70, v70
    v_exp_f32 v71, v71
    v_pk_add_f32 v[68:69], v[68:69], 1.0 op_sel_hi:[1,0]
    v_pk_add_f32 v[70:71], v[70:71], 1.0 op_sel_hi:[1,0]
    v_rcp_f32 v68, v68
    v_rcp_f32 v69, v69
    v_rcp_f32 v70, v70
    v_rcp_f32 v71, v71
    v_pk_mul_f32 v[148:149], v[148:149], v[68:69]
    v_pk_mul_f32 v[150:151], v[150:151], v[70:71]
    v_cvt_pk_bf16_f32 v146, v148, v149
    v_cvt_pk_bf16_f32 v147, v150, v151
    v_pk_mul_f32 v[64:65], v[152:153], v[152:153]
    v_pk_mul_f32 v[66:67], v[154:155], v[154:155]
    v_pk_fma_f32 v[64:65], v[64:65], v[4:5], v[2:3] op_sel_hi:[1,0,0]
    v_pk_fma_f32 v[66:67], v[66:67], v[4:5], v[2:3] op_sel_hi:[1,0,0]
    v_pk_mul_f32 v[64:65], v[64:65], v[152:153]
    v_pk_mul_f32 v[66:67], v[66:67], v[154:155]
    v_exp_f32 v64, v64
    v_exp_f32 v65, v65
    v_exp_f32 v66, v66
    v_exp_f32 v67, v67
    v_pk_add_f32 v[64:65], v[64:65], 1.0 op_sel_hi:[1,0]
    v_pk_add_f32 v[66:67], v[66:67], 1.0 op_sel_hi:[1,0]
    v_rcp_f32 v64, v64
    v_rcp_f32 v65, v65
    v_rcp_f32 v66, v66
    v_rcp_f32 v67, v67
    v_pk_mul_f32 v[152:153], v[152:153], v[64:65]
    v_pk_mul_f32 v[154:155], v[154:155], v[66:67]
    v_permlane16_swap_b32 v144, v146
    v_permlane16_swap_b32 v145, v147
    v_cvt_pk_bf16_f32 v152, v152, v153
    v_cvt_pk_bf16_f32 v153, v154, v155
    v_pk_mul_f32 v[68:69], v[156:157], v[156:157]
    v_pk_mul_f32 v[70:71], v[158:159], v[158:159]
    v_pk_fma_f32 v[68:69], v[68:69], v[4:5], v[2:3] op_sel_hi:[1,0,0]
    v_pk_fma_f32 v[70:71], v[70:71], v[4:5], v[2:3] op_sel_hi:[1,0,0]
    v_pk_mul_f32 v[68:69], v[68:69], v[156:157]
    v_pk_mul_f32 v[70:71], v[70:71], v[158:159]
    v_exp_f32 v68, v68
    v_exp_f32 v69, v69
    v_exp_f32 v70, v70
    v_exp_f32 v71, v71
    v_pk_add_f32 v[68:69], v[68:69], 1.0 op_sel_hi:[1,0]
    v_pk_add_f32 v[70:71], v[70:71], 1.0 op_sel_hi:[1,0]
    v_rcp_f32 v68, v68
    v_rcp_f32 v69, v69
    v_rcp_f32 v70, v70
    v_rcp_f32 v71, v71
    v_pk_mul_f32 v[156:157], v[156:157], v[68:69]
    v_pk_mul_f32 v[158:159], v[158:159], v[70:71]
    v_cvt_pk_bf16_f32 v154, v156, v157
    v_cvt_pk_bf16_f32 v155, v158, v159
    v_pk_mul_f32 v[64:65], v[160:161], v[160:161]
    v_pk_mul_f32 v[66:67], v[162:163], v[162:163]
    v_pk_fma_f32 v[64:65], v[64:65], v[4:5], v[2:3] op_sel_hi:[1,0,0]
    v_pk_fma_f32 v[66:67], v[66:67], v[4:5], v[2:3] op_sel_hi:[1,0,0]
    v_pk_mul_f32 v[64:65], v[64:65], v[160:161]
    v_pk_mul_f32 v[66:67], v[66:67], v[162:163]
    v_exp_f32 v64, v64
    v_exp_f32 v65, v65
    v_exp_f32 v66, v66
    v_exp_f32 v67, v67
    v_pk_add_f32 v[64:65], v[64:65], 1.0 op_sel_hi:[1,0]
    v_pk_add_f32 v[66:67], v[66:67], 1.0 op_sel_hi:[1,0]
    v_rcp_f32 v64, v64
    v_rcp_f32 v65, v65
    v_rcp_f32 v66, v66
    v_rcp_f32 v67, v67
    v_pk_mul_f32 v[160:161], v[160:161], v[64:65]
    v_pk_mul_f32 v[162:163], v[162:163], v[66:67]
    v_permlane16_swap_b32 v152, v154
    v_permlane16_swap_b32 v153, v155
    v_cvt_pk_bf16_f32 v160, v160, v161
    v_cvt_pk_bf16_f32 v161, v162, v163
    v_pk_mul_f32 v[68:69], v[164:165], v[164:165]
    v_pk_mul_f32 v[70:71], v[166:167], v[166:167]
    v_pk_fma_f32 v[68:69], v[68:69], v[4:5], v[2:3] op_sel_hi:[1,0,0]
    v_pk_fma_f32 v[70:71], v[70:71], v[4:5], v[2:3] op_sel_hi:[1,0,0]
    v_pk_mul_f32 v[68:69], v[68:69], v[164:165]
    v_pk_mul_f32 v[70:71], v[70:71], v[166:167]
    v_exp_f32 v68, v68
    v_exp_f32 v69, v69
    v_exp_f32 v70, v70
    v_exp_f32 v71, v71
    v_pk_add_f32 v[68:69], v[68:69], 1.0 op_sel_hi:[1,0]
    v_pk_add_f32 v[70:71], v[70:71], 1.0 op_sel_hi:[1,0]
    v_rcp_f32 v68, v68
    v_rcp_f32 v69, v69
    v_rcp_f32 v70, v70
    v_rcp_f32 v71, v71
    v_pk_mul_f32 v[164:165], v[164:165], v[68:69]
    v_pk_mul_f32 v[166:167], v[166:167], v[70:71]
    v_cvt_pk_bf16_f32 v162, v164, v165
    v_cvt_pk_bf16_f32 v163, v166, v167
    s_mov_b32 s88, 1
    s_cmp_eq_u32 s27, 0
    s_cbranch_scc1 L_pkv_ok
    s_waitcnt vmcnt(0)
    v_cmp_ne_u64 vcc, s[70:71], v[34:35]
    s_mov_b32 s95, 0x40000
    s_nop 0
    s_cmp_eq_u64 vcc, 0
    s_cbranch_scc1 L_pkv_ok
L_pkv_spin:
    s_sleep 1
    buffer_load_dwordx2 v[34:35], v46, s[44:47], s83 offen sc1
    s_waitcnt vmcnt(0)
    v_cmp_ne_u64 vcc, s[70:71], v[34:35]
    s_sub_u32 s95, s95, 1
    s_cmp_eq_u32 s95, 0
    s_cbranch_scc1 L_pkv_ok
    s_cmp_lg_u64 vcc, 0
    s_cbranch_scc1 L_pkv_spin
L_pkv_ok:
    s_add_u32 m0, s66, 98304
    s_nop 0
    buffer_load_dwordx4 v1, s[44:47], s80 offen offset:0 sc1 lds
    buffer_load_dwordx4 v1, s[44:47], s80 offen offset:1024 sc1 lds
    buffer_load_dwordx4 v1, s[44:47], s80 offen offset:2048 sc1 lds
    buffer_load_dwordx4 v1, s[44:47], s80 offen offset:3072 sc1 lds
    s_add_u32 m0, s66, 131072
    s_nop 0
    buffer_load_dwordx4 v1, s[44:47], s81 offen offset:0 sc1 lds
    buffer_load_dwordx4 v1, s[44:47], s81 offen offset:1024 sc1 lds
    buffer_load_dwordx4 v1, s[44:47], s81 offen offset:2048 sc1 lds
    buffer_load_dwordx4 v1, s[44:47], s81 offen offset:3072 sc1 lds
L_pkv_skip:
    v_pk_mul_f32 v[64:65], v[168:169], v[168:169]
    v_pk_mul_f32 v[66:67], v[170:171], v[170:171]
    v_pk_fma_f32 v[64:65], v[64:65], v[4:5], v[2:3] op_sel_hi:[1,0,0]
    v_pk_fma_f32 v[66:67], v[66:67], v[4:5], v[2:3] op_sel_hi:[1,0,0]
    v_pk_mul_f32 v[64:65], v[64:65], v[168:169]
    v_pk_mul_f32 v[66:67], v[66:67], v[170:171]
    v_exp_f32 v64, v64
    v_exp_f32 v65, v65
    v_exp_f32 v66, v66
    v_exp_f32 v67, v67
    v_pk_add_f32 v[64:65], v[64:65], 1.0 op_sel_hi:[1,0]
    v_pk_add_f32 v[66:67], v[66:67], 1.0 op_sel_hi:[1,0]
    v_rcp_f32 v64, v64
    v_rcp_f32 v65, v65
    v_rcp_f32 v66, v66
    v_rcp_f32 v67, v67
    v_pk_mul_f32 v[168:169], v[168:169], v[64:65]
    v_pk_mul_f32 v[170:171], v[170:171], v[66:67]
    v_permlane16_swap_b32 v160, v162
    v_permlane16_swap_b32 v161, v163
    v_cvt_pk_bf16_f32 v168, v168, v169
    v_cvt_pk_bf16_f32 v169, v170, v171
    v_pk_mul_f32 v[68:69], v[172:173], v[172:173]
    v_pk_mul_f32 v[70:71], v[174:175], v[174:175]
    v_pk_fma_f32 v[68:69], v[68:69], v[4:5], v[2:3] op_sel_hi:[1,0,0]
    v_pk_fma_f32 v[70:71], v[70:71], v[4:5], v[2:3] op_sel_hi:[1,0,0]
    v_pk_mul_f32 v[68:69], v[68:69], v[172:173]
    v_pk_mul_f32 v[70:71], v[70:71], v[174:175]
    v_exp_f32 v68, v68
    v_exp_f32 v69, v69
    v_exp_f32 v70, v70
    v_exp_f32 v71, v71
    v_pk_add_f32 v[68:69], v[68:69], 1.0 op_sel_hi:[1,0]
    v_pk_add_f32 v[70:71], v[70:71], 1.0 op_sel_hi:[1,0]
    v_rcp_f32 v68, v68
    v_rcp_f32 v69, v69
    v_rcp_f32 v70, v70
    v_rcp_f32 v71, v71
    v_pk_mul_f32 v[172:173], v[172:173], v[68:69]
    v_pk_mul_f32 v[174:175], v[174:175], v[70:71]
    v_cvt_pk_bf16_f32 v170, v172, v173
    v_cvt_pk_bf16_f32 v171, v174, v175
    s_add_u32 s87, s84, 0
    buffer_store_dwordx4 v[144:147], v33, s[44:47], s87 offen sc1
    v_pk_mul_f32 v[64:65], v[176:177], v[176:177]
    v_pk_mul_f32 v[66:67], v[178:179], v[178:179]
    v_pk_fma_f32 v[64:65], v[64:65], v[4:5], v[2:3] op_sel_hi:[1,0,0]
    v_pk_fma_f32 v[66:67], v[66:67], v[4:5], v[2:3] op_sel_hi:[1,0,0]
    v_pk_mul_f32 v[64:65], v[64:65], v[176:177]
    v_pk_mul_f32 v[66:67], v[66:67], v[178:179]
    v_exp_f32 v64, v64
    v_exp_f32 v65, v65
    v_exp_f32 v66, v66
    v_exp_f32 v67, v67
    v_pk_add_f32 v[64:65], v[64:65], 1.0 op_sel_hi:[1,0]
    v_pk_add_f32 v[66:67], v[66:67], 1.0 op_sel_hi:[1,0]
    v_rcp_f32 v64, v64
    v_rcp_f32 v65, v65
    v_rcp_f32 v66, v66
    v_rcp_f32 v67, v67
    v_pk_mul_f32 v[176:177], v[176:177], v[64:65]
    v_pk_mul_f32 v[178:179], v[178:179], v[66:67]
    v_permlane16_swap_b32 v168, v170
    v_permlane16_swap_b32 v169, v171
    v_cvt_pk_bf16_f32 v176, v176, v177
    v_cvt_pk_bf16_f32 v177, v178, v179
    v_pk_mul_f32 v[68:69], v[180:181], v[180:181]
    v_pk_mul_f32 v[70:71], v[182:183], v[182:183]
    v_pk_fma_f32 v[68:69], v[68:69], v[4:5], v[2:3] op_sel_hi:[1,0,0]
    v_pk_fma_f32 v[70:71], v[70:71], v[4:5], v[2:3] op_sel_hi:[1,0,0]
    v_pk_mul_f32 v[68:69], v[68:69], v[180:181]
    v_pk_mul_f32 v[70:71], v[70:71], v[182:183]
    v_exp_f32 v68, v68
    v_exp_f32 v69, v69
    v_exp_f32 v70, v70
    v_exp_f32 v71, v71
    v_pk_add_f32 v[68:69], v[68:69], 1.0 op_sel_hi:[1,0]
    v_pk_add_f32 v[70:71], v[70:71], 1.0 op_sel_hi:[1,0]
    v_rcp_f32 v68, v68
    v_rcp_f32 v69, v69
    v_rcp_f32 v70, v70
    v_rcp_f32 v71, v71
    v_pk_mul_f32 v[180:181], v[180:181], v[68:69]
    v_pk_mul_f32 v[182:183], v[182:183], v[70:71]
    v_cvt_pk_bf16_f32 v178, v180, v181
    v_cvt_pk_bf16_f32 v179, v182, v183
    v_pk_mul_f32 v[64:65], v[184:185], v[184:185]
    v_pk_mul_f32 v[66:67], v[186:187], v[186:187]
    v_pk_fma_f32 v[64:65], v[64:65], v[4:5], v[2:3] op_sel_hi:[1,0,0]
    v_pk_fma_f32 v[66:67], v[66:67], v[4:5], v[2:3] op_sel_hi:[1,0,0]
    v_pk_mul_f32 v[64:65], v[64:65], v[184:185]
    v_pk_mul_f32 v[66:67], v[66:67], v[186:187]
    v_exp_f32 v64, v64
    v_exp_f32 v65, v65
    v_exp_f32 v66, v66
    v_exp_f32 v67, v67
    v_pk_add_f32 v[64:65], v[64:65], 1.0 op_sel_hi:[1,0]
    v_pk_add_f32 v[66:67], v[66:67], 1.0 op_sel_hi:[1,0]
    v_rcp_f32 v64, v64
    v_rcp_f32 v65, v65
    v_rcp_f32 v66, v66
    v_rcp_f32 v67, v67
    v_pk_mul_f32 v[184:185], v[184:185], v[64:65]
    v_pk_mul_f32 v[186:187], v[186:187], v[66:67]
    v_permlane16_swap_b32 v176, v178
    v_permlane16_swap_b32 v177, v179
    v_cvt_pk_bf16_f32 v184, v184, v185
    v_cvt_pk_bf16_f32 v185, v186, v187
    v_pk_mul_f32 v[68:69], v[188:189], v[188:189]
    v_pk_mul_f32 v[70:71], v[190:191], v[190:191]
    v_pk_fma_f32 v[68:69], v[68:69], v[4:5], v[2:3] op_sel_hi:[1,0,0]
    v_pk_fma_f32 v[70:71], v[70:71], v[4:5], v[2:3] op_sel_hi:[1,0,0]
    v_pk_mul_f32 v[68:69], v[68:69], v[188:189]
    v_pk_mul_f32 v[70:71], v[70:71], v[190:191]
    v_exp_f32 v68, v68
    v_exp_f32 v69, v69
    v_exp_f32 v70, v70
    v_exp_f32 v71, v71
    v_pk_add_f32 v[68:69], v[68:69], 1.0 op_sel_hi:[1,0]
    v_pk_add_f32 v[70:71], v[70:71], 1.0 op_sel_hi:[1,0]
    v_rcp_f32 v68, v68
    v_rcp_f32 v69, v69
    v_rcp_f32 v70, v70
    v_rcp_f32 v71, v71
    v_pk_mul_f32 v[188:189], v[188:189], v[68:69]
    v_pk_mul_f32 v[190:191], v[190:191], v[70:71]
    v_cvt_pk_bf16_f32 v186, v188, v189
    v_cvt_pk_bf16_f32 v187, v190, v191
    s_add_u32 s87, s84, 294912
    buffer_store_dwordx4 v[152:155], v33, s[44:47], s87 offen sc1
    v_pk_mul_f32 v[64:65], v[192:193], v[192:193]
    v_pk_mul_f32 v[66:67], v[194:195], v[194:195]
    v_pk_fma_f32 v[64:65], v[64:65], v[4:5], v[2:3] op_sel_hi:[1,0,0]
    v_pk_fma_f32 v[66:67], v[66:67], v[4:5], v[2:3] op_sel_hi:[1,0,0]
    v_pk_mul_f32 v[64:65], v[64:65], v[192:193]
    v_pk_mul_f32 v[66:67], v[66:67], v[194:195]
    v_exp_f32 v64, v64
    v_exp_f32 v65, v65
    v_exp_f32 v66, v66
    v_exp_f32 v67, v67
    v_pk_add_f32 v[64:65], v[64:65], 1.0 op_sel_hi:[1,0]
    v_pk_add_f32 v[66:67], v[66:67], 1.0 op_sel_hi:[1,0]
    v_rcp_f32 v64, v64
    v_rcp_f32 v65, v65
    v_rcp_f32 v66, v66
    v_rcp_f32 v67, v67
    v_pk_mul_f32 v[192:193], v[192:193], v[64:65]
    v_pk_mul_f32 v[194:195], v[194:195], v[66:67]
    v_permlane16_swap_b32 v184, v186
    v_permlane16_swap_b32 v185, v187
    v_cvt_pk_bf16_f32 v192, v192, v193
    v_cvt_pk_bf16_f32 v193, v194, v195
    v_pk_mul_f32 v[68:69], v[196:197], v[196:197]
    v_pk_mul_f32 v[70:71], v[198:199], v[198:199]
    v_pk_fma_f32 v[68:69], v[68:69], v[4:5], v[2:3] op_sel_hi:[1,0,0]
    v_pk_fma_f32 v[70:71], v[70:71], v[4:5], v[2:3] op_sel_hi:[1,0,0]
    v_pk_mul_f32 v[68:69], v[68:69], v[196:197]
    v_pk_mul_f32 v[70:71], v[70:71], v[198:199]
    v_exp_f32 v68, v68
    v_exp_f32 v69, v69
    v_exp_f32 v70, v70
    v_exp_f32 v71, v71
    v_pk_add_f32 v[68:69], v[68:69], 1.0 op_sel_hi:[1,0]
    v_pk_add_f32 v[70:71], v[70:71], 1.0 op_sel_hi:[1,0]
    v_rcp_f32 v68, v68
    v_rcp_f32 v69, v69
    v_rcp_f32 v70, v70
    v_rcp_f32 v71, v71
    v_pk_mul_f32 v[196:197], v[196:197], v[68:69]
    v_pk_mul_f32 v[198:199], v[198:199], v[70:71]
    v_cvt_pk_bf16_f32 v194, v196, v197
    v_cvt_pk_bf16_f32 v195, v198, v199
    v_pk_mul_f32 v[64:65], v[200:201], v[200:201]
    v_pk_mul_f32 v[66:67], v[202:203], v[202:203]
    v_pk_fma_f32 v[64:65], v[64:65], v[4:5], v[2:3] op_sel_hi:[1,0,0]
    v_pk_fma_f32 v[66:67], v[66:67], v[4:5], v[2:3] op_sel_hi:[1,0,0]
    v_pk_mul_f32 v[64:65], v[64:65], v[200:201]
    v_pk_mul_f32 v[66:67], v[66:67], v[202:203]
    v_exp_f32 v64, v64
    v_exp_f32 v65, v65
    v_exp_f32 v66, v66
    v_exp_f32 v67, v67
    v_pk_add_f32 v[64:65], v[64:65], 1.0 op_sel_hi:[1,0]
    v_pk_add_f32 v[66:67], v[66:67], 1.0 op_sel_hi:[1,0]
    v_rcp_f32 v64, v64
    v_rcp_f32 v65, v65
    v_rcp_f32 v66, v66
    v_rcp_f32 v67, v67
    v_pk_mul_f32 v[200:201], v[200:201], v[64:65]
    v_pk_mul_f32 v[202:203], v[202:203], v[66:67]
    v_permlane16_swap_b32 v192, v194
    v_permlane16_swap_b32 v193, v195
    v_cvt_pk_bf16_f32 v200, v200, v201
    v_cvt_pk_bf16_f32 v201, v202, v203
    v_pk_mul_f32 v[68:69], v[204:205], v[204:205]
    v_pk_mul_f32 v[70:71], v[206:207], v[206:207]
    v_pk_fma_f32 v[68:69], v[68:69], v[4:5], v[2:3] op_sel_hi:[1,0,0]
    v_pk_fma_f32 v[70:71], v[70:71], v[4:5], v[2:3] op_sel_hi:[1,0,0]
    v_pk_mul_f32 v[68:69], v[68:69], v[204:205]
    v_pk_mul_f32 v[70:71], v[70:71], v[206:207]
    v_exp_f32 v68, v68
    v_exp_f32 v69, v69
    v_exp_f32 v70, v70
    v_exp_f32 v71, v71
    v_pk_add_f32 v[68:69], v[68:69], 1.0 op_sel_hi:[1,0]
    v_pk_add_f32 v[70:71], v[70:71], 1.0 op_sel_hi:[1,0]
    v_rcp_f32 v68, v68
    v_rcp_f32 v69, v69
    v_rcp_f32 v70, v70
    v_rcp_f32 v71, v71
    v_pk_mul_f32 v[204:205], v[204:205], v[68:69]
    v_pk_mul_f32 v[206:207], v[206:207], v[70:71]
    v_cvt_pk_bf16_f32 v202, v204, v205
    v_cvt_pk_bf16_f32 v203, v206, v207
    s_add_u32 s87, s84, 512
    buffer_store_dwordx4 v[160:163], v33, s[44:47], s87 offen sc1
    v_pk_mul_f32 v[64:65], v[208:209], v[208:209]
    v_pk_mul_f32 v[66:67], v[210:211], v[210:211]
    v_pk_fma_f32 v[64:65], v[64:65], v[4:5], v[2:3] op_sel_hi:[1,0,0]
    v_pk_fma_f32 v[66:67], v[66:67], v[4:5], v[2:3] op_sel_hi:[1,0,0]
    v_pk_mul_f32 v[64:65], v[64:65], v[208:209]
    v_pk_mul_f32 v[66:67], v[66:67], v[210:211]
    v_exp_f32 v64, v64
    v_exp_f32 v65, v65
    v_exp_f32 v66, v66
    v_exp_f32 v67, v67
    v_pk_add_f32 v[64:65], v[64:65], 1.0 op_sel_hi:[1,0]
    v_pk_add_f32 v[66:67], v[66:67], 1.0 op_sel_hi:[1,0]
    v_rcp_f32 v64, v64
    v_rcp_f32 v65, v65
    v_rcp_f32 v66, v66
    v_rcp_f32 v67, v67
    v_pk_mul_f32 v[208:209], v[208:209], v[64:65]
    v_pk_mul_f32 v[210:211], v[210:211], v[66:67]
    v_permlane16_swap_b32 v200, v202
    v_permlane16_swap_b32 v201, v203
    v_cvt_pk_bf16_f32 v208, v208, v209
    v_cvt_pk_bf16_f32 v209, v210, v211
    v_pk_mul_f32 v[68:69], v[212:213], v[212:213]
    v_pk_mul_f32 v[70:71], v[214:215], v[214:215]
    v_pk_fma_f32 v[68:69], v[68:69], v[4:5], v[2:3] op_sel_hi:[1,0,0]
    v_pk_fma_f32 v[70:71], v[70:71], v[4:5], v[2:3] op_sel_hi:[1,0,0]
    v_pk_mul_f32 v[68:69], v[68:69], v[212:213]
    v_pk_mul_f32 v[70:71], v[70:71], v[214:215]
    v_exp_f32 v68, v68
    v_exp_f32 v69, v69
    v_exp_f32 v70, v70
    v_exp_f32 v71, v71
    v_pk_add_f32 v[68:69], v[68:69], 1.0 op_sel_hi:[1,0]
    v_pk_add_f32 v[70:71], v[70:71], 1.0 op_sel_hi:[1,0]
    v_rcp_f32 v68, v68
    v_rcp_f32 v69, v69
    v_rcp_f32 v70, v70
    v_rcp_f32 v71, v71
    v_pk_mul_f32 v[212:213], v[212:213], v[68:69]
    v_pk_mul_f32 v[214:215], v[214:215], v[70:71]
    v_cvt_pk_bf16_f32 v210, v212, v213
    v_cvt_pk_bf16_f32 v211, v214, v215
    v_pk_mul_f32 v[64:65], v[216:217], v[216:217]
    v_pk_mul_f32 v[66:67], v[218:219], v[218:219]
    v_pk_fma_f32 v[64:65], v[64:65], v[4:5], v[2:3] op_sel_hi:[1,0,0]
    v_pk_fma_f32 v[66:67], v[66:67], v[4:5], v[2:3] op_sel_hi:[1,0,0]
    v_pk_mul_f32 v[64:65], v[64:65], v[216:217]
    v_pk_mul_f32 v[66:67], v[66:67], v[218:219]
    v_exp_f32 v64, v64
    v_exp_f32 v65, v65
    v_exp_f32 v66, v66
    v_exp_f32 v67, v67
    v_pk_add_f32 v[64:65], v[64:65], 1.0 op_sel_hi:[1,0]
    v_pk_add_f32 v[66:67], v[66:67], 1.0 op_sel_hi:[1,0]
    v_rcp_f32 v64, v64
    v_rcp_f32 v65, v65
    v_rcp_f32 v66, v66
    v_rcp_f32 v67, v67
    v_pk_mul_f32 v[216:217], v[216:217], v[64:65]
    v_pk_mul_f32 v[218:219], v[218:219], v[66:67]
    v_permlane16_swap_b32 v208, v210
    v_permlane16_swap_b32 v209, v211
    v_cvt_pk_bf16_f32 v216, v216, v217
    v_cvt_pk_bf16_f32 v217, v218, v219
    v_pk_mul_f32 v[68:69], v[220:221], v[220:221]
    v_pk_mul_f32 v[70:71], v[222:223], v[222:223]
    v_pk_fma_f32 v[68:69], v[68:69], v[4:5], v[2:3] op_sel_hi:[1,0,0]
    v_pk_fma_f32 v[70:71], v[70:71], v[4:5], v[2:3] op_sel_hi:[1,0,0]
    v_pk_mul_f32 v[68:69], v[68:69], v[220:221]
    v_pk_mul_f32 v[70:71], v[70:71], v[222:223]
    v_exp_f32 v68, v68
    v_exp_f32 v69, v69
    v_exp_f32 v70, v70
    v_exp_f32 v71, v71
    v_pk_add_f32 v[68:69], v[68:69], 1.0 op_sel_hi:[1,0]
    v_pk_add_f32 v[70:71], v[70:71], 1.0 op_sel_hi:[1,0]
    v_rcp_f32 v68, v68
    v_rcp_f32 v69, v69
    v_rcp_f32 v70, v70
    v_rcp_f32 v71, v71
    v_pk_mul_f32 v[220:221], v[220:221], v[68:69]
    v_pk_mul_f32 v[222:223], v[222:223], v[70:71]
    v_cvt_pk_bf16_f32 v218, v220, v221
    v_cvt_pk_bf16_f32 v219, v222, v223
    s_add_u32 s87, s84, 295424
    buffer_store_dwordx4 v[168:171], v33, s[44:47], s87 offen sc1
    v_pk_mul_f32 v[64:65], v[224:225], v[224:225]
    v_pk_mul_f32 v[66:67], v[226:227], v[226:227]
    v_pk_fma_f32 v[64:65], v[64:65], v[4:5], v[2:3] op_sel_hi:[1,0,0]
    v_pk_fma_f32 v[66:67], v[66:67], v[4:5], v[2:3] op_sel_hi:[1,0,0]
    v_pk_mul_f32 v[64:65], v[64:65], v[224:225]
    v_pk_mul_f32 v[66:67], v[66:67], v[226:227]
    v_exp_f32 v64, v64
    v_exp_f32 v65, v65
    v_exp_f32 v66, v66
    v_exp_f32 v67, v67
    v_pk_add_f32 v[64:65], v[64:65], 1.0 op_sel_hi:[1,0]
    v_pk_add_f32 v[66:67], v[66:67], 1.0 op_sel_hi:[1,0]
    v_rcp_f32 v64, v64
    v_rcp_f32 v65, v65
    v_rcp_f32 v66, v66
    v_rcp_f32 v67, v67
    v_pk_mul_f32 v[224:225], v[224:225], v[64:65]
    v_pk_mul_f32 v[226:227], v[226:227], v[66:67]
    v_permlane16_swap_b32 v216, v218
    v_permlane16_swap_b32 v217, v219
    v_cvt_pk_bf16_f32 v224, v224, v225
    v_cvt_pk_bf16_f32 v225, v226, v227
    v_pk_mul_f32 v[68:69], v[228:229], v[228:229]
    v_pk_mul_f32 v[70:71], v[230:231], v[230:231]
    v_pk_fma_f32 v[68:69], v[68:69], v[4:5], v[2:3] op_sel_hi:[1,0,0]
    v_pk_fma_f32 v[70:71], v[70:71], v[4:5], v[2:3] op_sel_hi:[1,0,0]
    v_pk_mul_f32 v[68:69], v[68:69], v[228:229]
    v_pk_mul_f32 v[70:71], v[70:71], v[230:231]
    v_exp_f32 v68, v68
    v_exp_f32 v69, v69
    v_exp_f32 v70, v70
    v_exp_f32 v71, v71
    v_pk_add_f32 v[68:69], v[68:69], 1.0 op_sel_hi:[1,0]
    v_pk_add_f32 v[70:71], v[70:71], 1.0 op_sel_hi:[1,0]
    v_rcp_f32 v68, v68
    v_rcp_f32 v69, v69
    v_rcp_f32 v70, v70
    v_rcp_f32 v71, v71
    v_pk_mul_f32 v[228:229], v[228:229], v[68:69]
    v_pk_mul_f32 v[230:231], v[230:231], v[70:71]
    v_cvt_pk_bf16_f32 v226, v228, v229
    v_cvt_pk_bf16_f32 v227, v230, v231
    v_pk_mul_f32 v[64:65], v[232:233], v[232:233]
    v_pk_mul_f32 v[66:67], v[234:235], v[234:235]
    v_pk_fma_f32 v[64:65], v[64:65], v[4:5], v[2:3] op_sel_hi:[1,0,0]
    v_pk_fma_f32 v[66:67], v[66:67], v[4:5], v[2:3] op_sel_hi:[1,0,0]
    v_pk_mul_f32 v[64:65], v[64:65], v[232:233]
    v_pk_mul_f32 v[66:67], v[66:67], v[234:235]
    v_exp_f32 v64, v64
    v_exp_f32 v65, v65
    v_exp_f32 v66, v66
    v_exp_f32 v67, v67
    v_pk_add_f32 v[64:65], v[64:65], 1.0 op_sel_hi:[1,0]
    v_pk_add_f32 v[66:67], v[66:67], 1.0 op_sel_hi:[1,0]
    v_rcp_f32 v64, v64
    v_rcp_f32 v65, v65
    v_rcp_f32 v66, v66
    v_rcp_f32 v67, v67
    v_pk_mul_f32 v[232:233], v[232:233], v[64:65]
    v_pk_mul_f32 v[234:235], v[234:235], v[66:67]
    v_permlane16_swap_b32 v224, v226
    v_permlane16_swap_b32 v225, v227
    v_cvt_pk_bf16_f32 v232, v232, v233
    v_cvt_pk_bf16_f32 v233, v234, v235
    v_pk_mul_f32 v[68:69], v[236:237], v[236:237]
    v_pk_mul_f32 v[70:71], v[238:239], v[238:239]
    v_pk_fma_f32 v[68:69], v[68:69], v[4:5], v[2:3] op_sel_hi:[1,0,0]
    v_pk_fma_f32 v[70:71], v[70:71], v[4:5], v[2:3] op_sel_hi:[1,0,0]
    v_pk_mul_f32 v[68:69], v[68:69], v[236:237]
    v_pk_mul_f32 v[70:71], v[70:71], v[238:239]
    v_exp_f32 v68, v68
    v_exp_f32 v69, v69
    v_exp_f32 v70, v70
    v_exp_f32 v71, v71
    v_pk_add_f32 v[68:69], v[68:69], 1.0 op_sel_hi:[1,0]
    v_pk_add_f32 v[70:71], v[70:71], 1.0 op_sel_hi:[1,0]
    v_rcp_f32 v68, v68
    v_rcp_f32 v69, v69
    v_rcp_f32 v70, v70
    v_rcp_f32 v71, v71
    v_pk_mul_f32 v[236:237], v[236:237], v[68:69]
    v_pk_mul_f32 v[238:239], v[238:239], v[70:71]
    v_cvt_pk_bf16_f32 v234, v236, v237
    v_cvt_pk_bf16_f32 v235, v238, v239
    s_add_u32 s87, s84, 2048
    buffer_store_dwordx4 v[176:179], v33, s[44:47], s87 offen sc1
    v_pk_mul_f32 v[64:65], v[240:241], v[240:241]
    v_pk_mul_f32 v[66:67], v[242:243], v[242:243]
    v_pk_fma_f32 v[64:65], v[64:65], v[4:5], v[2:3] op_sel_hi:[1,0,0]
    v_pk_fma_f32 v[66:67], v[66:67], v[4:5], v[2:3] op_sel_hi:[1,0,0]
    v_pk_mul_f32 v[64:65], v[64:65], v[240:241]
    v_pk_mul_f32 v[66:67], v[66:67], v[242:243]
    v_exp_f32 v64, v64
    v_exp_f32 v65, v65
    v_exp_f32 v66, v66
    v_exp_f32 v67, v67
    v_pk_add_f32 v[64:65], v[64:65], 1.0 op_sel_hi:[1,0]
    v_pk_add_f32 v[66:67], v[66:67], 1.0 op_sel_hi:[1,0]
    v_rcp_f32 v64, v64
    v_rcp_f32 v65, v65
    v_rcp_f32 v66, v66
    v_rcp_f32 v67, v67
    v_pk_mul_f32 v[240:241], v[240:241], v[64:65]
    v_pk_mul_f32 v[242:243], v[242:243], v[66:67]
    v_permlane16_swap_b32 v232, v234
    v_permlane16_swap_b32 v233, v235
    v_cvt_pk_bf16_f32 v240, v240, v241
    v_cvt_pk_bf16_f32 v241, v242, v243
    v_pk_mul_f32 v[68:69], v[244:245], v[244:245]
    v_pk_mul_f32 v[70:71], v[246:247], v[246:247]
    v_pk_fma_f32 v[68:69], v[68:69], v[4:5], v[2:3] op_sel_hi:[1,0,0]
    v_pk_fma_f32 v[70:71], v[70:71], v[4:5], v[2:3] op_sel_hi:[1,0,0]
    v_pk_mul_f32 v[68:69], v[68:69], v[244:245]
    v_pk_mul_f32 v[70:71], v[70:71], v[246:247]
    v_exp_f32 v68, v68
    v_exp_f32 v69, v69
    v_exp_f32 v70, v70
    v_exp_f32 v71, v71
    v_pk_add_f32 v[68:69], v[68:69], 1.0 op_sel_hi:[1,0]
    v_pk_add_f32 v[70:71], v[70:71], 1.0 op_sel_hi:[1,0]
    v_rcp_f32 v68, v68
    v_rcp_f32 v69, v69
    v_rcp_f32 v70, v70
    v_rcp_f32 v71, v71
    v_pk_mul_f32 v[244:245], v[244:245], v[68:69]
    v_pk_mul_f32 v[246:247], v[246:247], v[70:71]
    v_cvt_pk_bf16_f32 v242, v244, v245
    v_cvt_pk_bf16_f32 v243, v246, v247
    v_pk_mul_f32 v[64:65], v[248:249], v[248:249]
    v_pk_mul_f32 v[66:67], v[250:251], v[250:251]
    v_pk_fma_f32 v[64:65], v[64:65], v[4:5], v[2:3] op_sel_hi:[1,0,0]
    v_pk_fma_f32 v[66:67], v[66:67], v[4:5], v[2:3] op_sel_hi:[1,0,0]
    v_pk_mul_f32 v[64:65], v[64:65], v[248:249]
    v_pk_mul_f32 v[66:67], v[66:67], v[250:251]
    v_exp_f32 v64, v64
    v_exp_f32 v65, v65
    v_exp_f32 v66, v66
    v_exp_f32 v67, v67
    v_pk_add_f32 v[64:65], v[64:65], 1.0 op_sel_hi:[1,0]
    v_pk_add_f32 v[66:67], v[66:67], 1.0 op_sel_hi:[1,0]
    v_rcp_f32 v64, v64
    v_rcp_f32 v65, v65
    v_rcp_f32 v66, v66
    v_rcp_f32 v67, v67
    v_pk_mul_f32 v[248:249], v[248:249], v[64:65]
    v_pk_mul_f32 v[250:251], v[250:251], v[66:67]
    v_permlane16_swap_b32 v240, v242
    v_permlane16_swap_b32 v241, v243
    v_cvt_pk_bf16_f32 v248, v248, v249
    v_cvt_pk_bf16_f32 v249, v250, v251
    v_pk_mul_f32 v[68:69], v[252:253], v[252:253]
    v_pk_mul_f32 v[70:71], v[254:255], v[254:255]
    v_pk_fma_f32 v[68:69], v[68:69], v[4:5], v[2:3] op_sel_hi:[1,0,0]
    v_pk_fma_f32 v[70:71], v[70:71], v[4:5], v[2:3] op_sel_hi:[1,0,0]
    v_pk_mul_f32 v[68:69], v[68:69], v[252:253]
    v_pk_mul_f32 v[70:71], v[70:71], v[254:255]
    v_exp_f32 v68, v68
    v_exp_f32 v69, v69
    v_exp_f32 v70, v70
    v_exp_f32 v71, v71
    v_pk_add_f32 v[68:69], v[68:69], 1.0 op_sel_hi:[1,0]
    v_pk_add_f32 v[70:71], v[70:71], 1.0 op_sel_hi:[1,0]
    v_rcp_f32 v68, v68
    v_rcp_f32 v69, v69
    v_rcp_f32 v70, v70
    v_rcp_f32 v71, v71
    v_pk_mul_f32 v[252:253], v[252:253], v[68:69]
    v_pk_mul_f32 v[254:255], v[254:255], v[70:71]
    v_cvt_pk_bf16_f32 v250, v252, v253
    v_cvt_pk_bf16_f32 v251, v254, v255
    s_add_u32 s87, s84, 296960
    buffer_store_dwordx4 v[184:187], v33, s[44:47], s87 offen sc1
    s_nop 1
    v_permlane16_swap_b32 v248, v250
    v_permlane16_swap_b32 v249, v251
    s_waitcnt vmcnt(6)
    s_waitcnt lgkmcnt(0)
    s_barrier
    ds_read_b128 a[212:215], v37 offset:19456
    ds_read_b128 a[208:211], v37 offset:18432
    ds_read_b128 a[204:207], v37 offset:17408
    ds_read_b128 a[200:203], v37 offset:16384
    s_waitcnt lgkmcnt(3)
    v_mfma_f32_16x16x32_bf16 v[64:67], a[212:215], v[60:63], v[100:103]
    ds_read_b128 a[212:215], v36 offset:3072
    s_add_u32 s87, s84, 2560
    buffer_store_dwordx4 v[192:195], v33, s[44:47], s87 offen sc1
    s_nop 1
    s_waitcnt lgkmcnt(3)
    v_mfma_f32_16x16x32_bf16 v[68:71], a[208:211], v[56:59], v[100:103]
    s_nop 1
    v_mfma_f32_16x16x32_bf16 v[72:75], a[208:211], v[60:63], 0
    ds_read_b128 a[208:211], v36 offset:2048
    s_nop 1
    s_waitcnt lgkmcnt(3)
    v_mfma_f32_16x16x32_bf16 v[76:79], a[204:207], v[52:55], v[100:103]
    s_nop 1
    v_max3_f32 v107, v107, v64, v65
    v_max3_f32 v107, v107, v66, v67
    v_mfma_f32_16x16x32_bf16 v[80:83], a[204:207], v[56:59], 0
    s_add_u32 s87, s84, 297472
    buffer_store_dwordx4 v[200:203], v33, s[44:47], s87 offen sc1
    v_max3_f32 v106, v106, v68, v69
    v_max3_f32 v106, v106, v70, v71
    v_mfma_f32_16x16x32_bf16 v[64:67], a[204:207], v[60:63], 0
    ds_read_b128 a[204:207], v36 offset:1024
    v_max3_f32 v107, v107, v72, v73
    v_max3_f32 v107, v107, v74, v75
    s_waitcnt lgkmcnt(3)
    v_mfma_f32_16x16x32_bf16 v[68:71], a[200:203], v[48:51], v[100:103]
    v_max3_f32 v105, v105, v76, v77
    v_max3_f32 v105, v105, v78, v79
    v_mfma_f32_16x16x32_bf16 v[84:87], a[200:203], v[52:55], 0
    v_max3_f32 v106, v106, v80, v81
    v_max3_f32 v106, v106, v82, v83
    v_mfma_f32_16x16x32_bf16 v[88:91], a[200:203], v[56:59], 0
    s_add_u32 s87, s84, 4096
    buffer_store_dwordx4 v[208:211], v33, s[44:47], s87 offen sc1
    v_max3_f32 v107, v107, v64, v65
    v_max3_f32 v107, v107, v66, v67
    v_mfma_f32_16x16x32_bf16 v[92:95], a[200:203], v[60:63], 0
    ds_read_b128 a[200:203], v36 offset:0
    v_max3_f32 v104, v104, v68, v69
    v_max3_f32 v104, v104, v70, v71
    s_mov_b32 s67, s92
    s_cmp_eq_u32 s92, 0
    s_cbranch_scc1 L_atA_exit
L_atA_loop:
    v_subrev_u32 v36, 4096, v36
    s_waitcnt lgkmcnt(3)
    v_mfma_f32_16x16x32_bf16 v[64:67], a[212:215], v[48:51], 0
    v_max3_f32 v105, v105, v84, v85
    v_max3_f32 v105, v105, v86, v87
    v_mfma_f32_16x16x32_bf16 v[68:71], a[212:215], v[52:55], 0
    v_max3_f32 v106, v106, v88, v89
    v_max3_f32 v106, v106, v90, v91
    v_mfma_f32_16x16x32_bf16 v[72:75], a[212:215], v[56:59], 0
    v_max3_f32 v107, v107, v92, v93
    v_max3_f32 v107, v107, v94, v95
    v_mfma_f32_16x16x32_bf16 v[76:79], a[212:215], v[60:63], 0
    ds_read_b128 a[212:215], v36 offset:3072
    v_max3_f32 v104, v104, v64, v65
    v_max3_f32 v104, v104, v66, v67
    s_waitcnt lgkmcnt(3)
    v_mfma_f32_16x16x32_bf16 v[80:83], a[208:211], v[48:51], 0
    v_max3_f32 v105, v105, v68, v69
    v_max3_f32 v105, v105, v70, v71
    v_mfma_f32_16x16x32_bf16 v[84:87], a[208:211], v[52:55], 0
    v_max3_f32 v106, v106, v72, v73
    v_max3_f32 v106, v106, v74, v75
    v_mfma_f32_16x16x32_bf16 v[88:91], a[208:211], v[56:59], 0
    v_max3_f32 v107, v107, v76, v77
    v_max3_f32 v107, v107, v78, v79
    v_mfma_f32_16x16x32_bf16 v[92:95], a[208:211], v[60:63], 0
    ds_read_b128 a[208:211], v36 offset:2048
    v_max3_f32 v104, v104, v80, v81
    v_max3_f32 v104, v104, v82, v83
    s_waitcnt lgkmcnt(3)
    v_mfma_f32_16x16x32_bf16 v[64:67], a[204:207], v[48:51], 0
    v_max3_f32 v105, v105, v84, v85
    v_max3_f32 v105, v105, v86, v87
    v_mfma_f32_16x16x32_bf16 v[68:71], a[204:207], v[52:55], 0
    v_max3_f32 v106, v106, v88, v89
    v_max3_f32 v106, v106, v90, v91
    v_mfma_f32_16x16x32_bf16 v[72:75], a[204:207], v[56:59], 0
    v_max3_f32 v107, v107, v92, v93
    v_max3_f32 v107, v107, v94, v95
    v_mfma_f32_16x16x32_bf16 v[76:79], a[204:207], v[60:63], 0
    ds_read_b128 a[204:207], v36 offset:1024
    v_max3_f32 v104, v104, v64, v65
    v_max3_f32 v104, v104, v66, v67
    s_waitcnt lgkmcnt(3)
    v_mfma_f32_16x16x32_bf16 v[80:83], a[200:203], v[48:51], 0
    v_max3_f32 v105, v105, v68, v69
    v_max3_f32 v105, v105, v70, v71
    v_mfma_f32_16x16x32_bf16 v[84:87], a[200:203], v[52:55], 0
    v_max3_f32 v106, v106, v72, v73
    v_max3_f32 v106, v106, v74, v75
    v_mfma_f32_16x16x32_bf16 v[88:91], a[200:203], v[56:59], 0
    v_max3_f32 v107, v107, v76, v77
    v_max3_f32 v107, v107, v78, v79
    v_mfma_f32_16x16x32_bf16 v[92:95], a[200:203], v[60:63], 0
    ds_read_b128 a[200:203], v36 offset:0
    v_max3_f32 v104, v104, v80, v81
    v_max3_f32 v104, v104, v82, v83
    s_sub_u32 s67, s67, 1
    s_cmp_lg_u32 s67, 0
    s_cbranch_scc1 L_atA_loop
    s_cmp_eq_u32 s27, 0
    s_cbranch_scc1 L_atA_exit
    s_waitcnt lgkmcnt(3)
    v_mfma_f32_16x16x32_bf16 v[64:67], a[212:215], v[48:51], 0
    v_max3_f32 v105, v105, v84, v85
    v_max3_f32 v105, v105, v86, v87
    v_mfma_f32_16x16x32_bf16 v[68:71], a[212:215], v[52:55], 0
    v_max3_f32 v106, v106, v88, v89
    v_max3_f32 v106, v106, v90, v91
    v_mfma_f32_16x16x32_bf16 v[72:75], a[212:215], v[56:59], 0
    v_max3_f32 v107, v107, v92, v93
    v_max3_f32 v107, v107, v94, v95
    v_mfma_f32_16x16x32_bf16 v[76:79], a[212:215], v[60:63], v[96:99]
    v_max3_f32 v104, v104, v64, v65
    v_max3_f32 v104, v104, v66, v67
    s_waitcnt lgkmcnt(2)
    v_mfma_f32_16x16x32_bf16 v[80:83], a[208:211], v[48:51], 0
    v_max3_f32 v105, v105, v68, v69
    v_max3_f32 v105, v105, v70, v71
    v_mfma_f32_16x16x32_bf16 v[84:87], a[208:211], v[52:55], 0
    v_max3_f32 v106, v106, v72, v73
    v_max3_f32 v106, v106, v74, v75
    v_mfma_f32_16x16x32_bf16 v[88:91], a[208:211], v[56:59], v[96:99]
    v_max3_f32 v107, v107, v76, v77
    v_max3_f32 v107, v107, v78, v79
    s_waitcnt lgkmcnt(1)
    v_mfma_f32_16x16x32_bf16 v[92:95], a[204:207], v[48:51], 0
    v_max3_f32 v104, v104, v80, v81
    v_max3_f32 v104, v104, v82, v83
    v_mfma_f32_16x16x32_bf16 v[64:67], a[204:207], v[52:55], v[96:99]
    v_max3_f32 v105, v105, v84, v85
    v_max3_f32 v105, v105, v86, v87
    s_waitcnt lgkmcnt(0)
    v_mfma_f32_16x16x32_bf16 v[68:71], a[200:203], v[48:51], v[96:99]
    v_max3_f32 v106, v106, v88, v89
    v_max3_f32 v106, v106, v90, v91
    s_nop 7
    v_max3_f32 v104, v104, v92, v93
    v_max3_f32 v104, v104, v94, v95
    v_max3_f32 v105, v105, v64, v65
    v_max3_f32 v105, v105, v66, v67
    v_max3_f32 v104, v104, v68, v69
    v_max3_f32 v104, v104, v70, v71
    s_branch L_atA_done
L_atA_exit:
    s_nop 7
    v_max3_f32 v105, v105, v84, v85
    v_max3_f32 v105, v105, v86, v87
    v_max3_f32 v106, v106, v88, v89
    v_max3_f32 v106, v106, v90, v91
    v_max3_f32 v107, v107, v92, v93
    v_max3_f32 v107, v107, v94, v95
L_atA_done:
    s_add_u32 s87, s84, 299008
    buffer_store_dwordx4 v[216:219], v33, s[44:47], s87 offen sc1
    s_waitcnt lgkmcnt(0)
    ds_read_b128 a[212:215], v37 offset:19456
    ds_read_b128 a[208:211], v37 offset:18432
    ds_read_b128 a[204:207], v37 offset:17408
    ds_read_b128 a[200:203], v37 offset:16384
    ds_read_b128 a[224:227], v37 offset:51200
    ds_read_b128 a[228:231], v37 offset:52224
    ds_read_b128 a[216:219], v37 offset:49152
    ds_read_b128 a[220:223], v37 offset:50176
    v_add_u32 v36, 12288, v37
    v_mov_b32 v108, v104
    v_mov_b32 v109, v105
    v_mov_b32 v110, v106
    v_mov_b32 v111, v107
    v_permlane32_swap_b32 v104, v108
    v_permlane32_swap_b32 v105, v109
    v_permlane32_swap_b32 v106, v110
    v_permlane32_swap_b32 v107, v111
    v_max_f32 v104, v104, v108
    v_max_f32 v105, v105, v109
    v_max_f32 v106, v106, v110
    v_max_f32 v107, v107, v111
    v_mov_b32 v108, v104
    v_mov_b32 v109, v105
    v_mov_b32 v110, v106
    v_mov_b32 v111, v107
    v_permlane16_swap_b32 v104, v108
    v_permlane16_swap_b32 v105, v109
    v_permlane16_swap_b32 v106, v110
    v_permlane16_swap_b32 v107, v111
    v_max_f32 v104, v104, v108
    v_max_f32 v105, v105, v109
    v_max_f32 v106, v106, v110
    v_max_f32 v107, v107, v111
    v_sub_f32 v200, 0, v106
    v_sub_f32 v216, v100, v106
    v_sub_f32 v201, 0, v106
    v_sub_f32 v217, v101, v106
    v_sub_f32 v202, 0, v106
    v_sub_f32 v218, v102, v106
    v_sub_f32 v203, 0, v106
    v_sub_f32 v219, v103, v106
    v_sub_f32 v204, 0, v107
    v_sub_f32 v220, v100, v107
    v_sub_f32 v205, 0, v107
    v_sub_f32 v221, v101, v107
    v_sub_f32 v206, 0, v107
    v_sub_f32 v222, v102, v107
    v_sub_f32 v207, 0, v107
    v_sub_f32 v223, v103, v107
    v_sub_f32 v192, 0, v104
    v_sub_f32 v208, v100, v104
    v_sub_f32 v193, 0, v104
    v_sub_f32 v209, v101, v104
    v_sub_f32 v194, 0, v104
    v_sub_f32 v210, v102, v104
    v_sub_f32 v195, 0, v104
    v_sub_f32 v211, v103, v104
    v_sub_f32 v196, 0, v105
    v_sub_f32 v212, v100, v105
    v_sub_f32 v197, 0, v105
    v_sub_f32 v213, v101, v105
    v_sub_f32 v198, 0, v105
    v_sub_f32 v214, v102, v105
    v_sub_f32 v199, 0, v105
    v_sub_f32 v215, v103, v105
    v_sub_f32 v112, v96, v104
    v_sub_f32 v113, v97, v104
    v_sub_f32 v114, v98, v104
    v_sub_f32 v115, v99, v104
    v_sub_f32 v116, v96, v105
    v_sub_f32 v117, v97, v105
    v_sub_f32 v118, v98, v105
    v_sub_f32 v119, v99, v105
    v_sub_f32 v120, v96, v106
    v_sub_f32 v121, v97, v106
    v_sub_f32 v122, v98, v106
    v_sub_f32 v123, v99, v106
    v_sub_f32 v124, v96, v107
    v_sub_f32 v125, v97, v107
    v_sub_f32 v126, v98, v107
    v_sub_f32 v127, v99, v107
    s_waitcnt lgkmcnt(6)
    v_mfma_f32_16x16x32_bf16 v[64:67], a[208:211], v[56:59], v[216:219]
    s_nop 7
    s_waitcnt lgkmcnt(2)
    v_mfma_f32_16x16x32_bf16 v[72:75], a[208:211], v[60:63], v[204:207]
    s_add_u32 s87, s84, 4608
    v_exp_f32 v64, v64
    v_exp_f32 v65, v65
    v_mfma_f32_16x16x32_bf16 v[76:79], a[212:215], v[60:63], v[220:223]
    ds_read_b128 a[212:215], v36 offset:3072
    ds_read_b128 a[208:211], v36 offset:2048
    v_exp_f32 v66, v66
    v_exp_f32 v67, v67
    buffer_store_dwordx4 v[224:227], v33, s[44:47], s87 offen sc1
    v_cvt_pk_bf16_f32 v80, v64, v65
    v_cvt_pk_bf16_f32 v81, v66, v67
    v_mov_b32 v82, 0
    v_mov_b32 v83, 0
    s_waitcnt lgkmcnt(2)
    v_mfma_f32_16x16x32_bf16 v[64:67], a[200:203], v[48:51], v[208:211]
    v_exp_f32 v72, v72
    v_exp_f32 v73, v73
    v_mfma_f32_16x16x32_bf16 v[160:163], a[224:227], v[80:83], 0
    v_exp_f32 v74, v74
    v_exp_f32 v75, v75
    v_mfma_f32_16x16x32_bf16 v[164:167], a[228:231], v[80:83], 0
    v_exp_f32 v76, v76
    v_exp_f32 v77, v77
    v_mfma_f32_16x16x32_bf16 v[184:187], a[232:235], v[80:83], 0
    v_exp_f32 v78, v78
    v_exp_f32 v79, v79
    v_cvt_pk_bf16_f32 v84, v72, v73
    v_cvt_pk_bf16_f32 v85, v74, v75
    v_cvt_pk_bf16_f32 v86, v76, v77
    v_cvt_pk_bf16_f32 v87, v78, v79
    s_waitcnt lgkmcnt(2)
    v_mfma_f32_16x16x32_bf16 v[72:75], a[200:203], v[52:55], v[196:199]
    s_add_u32 s87, s84, 299520
    v_exp_f32 v64, v64
    v_exp_f32 v65, v65
    v_mfma_f32_16x16x32_bf16 v[76:79], a[204:207], v[52:55], v[212:215]
    buffer_store_dwordx4 v[232:235], v33, s[44:47], s87 offen sc1
    v_exp_f32 v66, v66
    v_exp_f32 v67, v67
    v_mfma_f32_16x16x32_bf16 v[168:171], a[224:227], v[84:87], 0
    v_mfma_f32_16x16x32_bf16 v[172:175], a[228:231], v[84:87], 0
    ds_read_b128 a[224:227], v36 offset:34816
    v_mfma_f32_16x16x32_bf16 v[188:191], a[232:235], v[84:87], 0
    ds_read_b128 a[228:231], v36 offset:35840
    v_cvt_pk_bf16_f32 v80, v64, v65
    v_cvt_pk_bf16_f32 v81, v66, v67
    v_mov_b32 v82, 0
    v_mov_b32 v83, 0
    s_waitcnt lgkmcnt(2)
    v_mfma_f32_16x16x32_bf16 v[64:67], a[200:203], v[56:59], v[200:203]
    v_exp_f32 v72, v72
    v_exp_f32 v73, v73
    v_mfma_f32_16x16x32_bf16 v[68:71], a[204:207], v[56:59], v[200:203]
    v_exp_f32 v74, v74
    v_exp_f32 v75, v75
    v_mfma_f32_16x16x32_bf16 v[144:147], a[216:219], v[80:83], 0
    v_exp_f32 v76, v76
    v_exp_f32 v77, v77
    v_mfma_f32_16x16x32_bf16 v[148:151], a[220:223], v[80:83], 0
    v_exp_f32 v78, v78
    v_exp_f32 v79, v79
    v_mfma_f32_16x16x32_bf16 v[176:179], a[232:235], v[80:83], 0
    v_cvt_pk_bf16_f32 v84, v72, v73
    v_cvt_pk_bf16_f32 v85, v74, v75
    v_cvt_pk_bf16_f32 v86, v76, v77
    v_cvt_pk_bf16_f32 v87, v78, v79
    s_waitcnt lgkmcnt(2)
    v_mfma_f32_16x16x32_bf16 v[72:75], a[200:203], v[60:63], v[204:207]
    s_add_u32 s87, s85, 0
    v_exp_f32 v64, v64
    v_exp_f32 v65, v65
    v_mfma_f32_16x16x32_bf16 v[76:79], a[204:207], v[60:63], v[204:207]
    ds_read_b128 a[204:207], v36 offset:1024
    v_exp_f32 v66, v66
    v_exp_f32 v67, v67
    v_mfma_f32_16x16x32_bf16 v[152:155], a[216:219], v[84:87], 0
    ds_read_b128 a[200:203], v36 offset:0
    v_exp_f32 v68, v68
    v_exp_f32 v69, v69
    v_mfma_f32_16x16x32_bf16 v[156:159], a[220:223], v[84:87], 0
    buffer_store_dwordx4 v[240:243], v33, s[44:47], s87 offen sc1
    v_exp_f32 v70, v70
    v_exp_f32 v71, v71
    v_mfma_f32_16x16x32_bf16 v[180:183], a[232:235], v[84:87], 0
    v_cvt_pk_bf16_f32 v80, v64, v65
    v_cvt_pk_bf16_f32 v81, v66, v67
    v_cvt_pk_bf16_f32 v82, v68, v69
    v_cvt_pk_bf16_f32 v83, v70, v71
    s_waitcnt lgkmcnt(2)
    v_mfma_f32_16x16x32_bf16 v[64:67], a[208:211], v[48:51], v[192:195]
    v_exp_f32 v72, v72
    v_exp_f32 v73, v73
    v_mfma_f32_16x16x32_bf16 v[68:71], a[212:215], v[48:51], v[192:195]
    v_exp_f32 v74, v74
    v_exp_f32 v75, v75
    v_mfma_f32_16x16x32_bf16 v[160:163], a[216:219], v[80:83], v[160:163]
    v_exp_f32 v76, v76
    v_exp_f32 v77, v77
    v_mfma_f32_16x16x32_bf16 v[164:167], a[220:223], v[80:83], v[164:167]
    v_exp_f32 v78, v78
    v_exp_f32 v79, v79
    v_mfma_f32_16x16x32_bf16 v[184:187], a[232:235], v[80:83], v[184:187]
    v_cvt_pk_bf16_f32 v84, v72, v73
    v_cvt_pk_bf16_f32 v85, v74, v75
    v_cvt_pk_bf16_f32 v86, v76, v77
    v_cvt_pk_bf16_f32 v87, v78, v79
    s_cmp_lt_u32 s92, 1
    s_cbranch_scc1 L_atB_skip1
    v_subrev_u32 v36, 4096, v36
    v_mfma_f32_16x16x32_bf16 v[72:75], a[208:211], v[52:55], v[196:199]
    s_add_u32 s87, s85, 294912
    v_exp_f32 v64, v64
    v_exp_f32 v65, v65
    v_mfma_f32_16x16x32_bf16 v[76:79], a[212:215], v[52:55], v[196:199]
    buffer_store_dwordx4 v[248:251], v33, s[44:47], s87 offen sc1
    v_exp_f32 v66, v66
    v_exp_f32 v67, v67
    v_mfma_f32_16x16x32_bf16 v[168:171], a[216:219], v[84:87], v[168:171]
    v_exp_f32 v68, v68
    v_exp_f32 v69, v69
    v_mfma_f32_16x16x32_bf16 v[172:175], a[220:223], v[84:87], v[172:175]
    ds_read_b128 a[216:219], v36 offset:36864
    v_exp_f32 v70, v70
    v_exp_f32 v71, v71
    v_mfma_f32_16x16x32_bf16 v[188:191], a[232:235], v[84:87], v[188:191]
    ds_read_b128 a[220:223], v36 offset:37888
    v_cvt_pk_bf16_f32 v80, v64, v65
    v_cvt_pk_bf16_f32 v81, v66, v67
    v_cvt_pk_bf16_f32 v82, v68, v69
    v_cvt_pk_bf16_f32 v83, v70, v71
    s_waitcnt lgkmcnt(2)
    v_mfma_f32_16x16x32_bf16 v[64:67], a[208:211], v[56:59], v[200:203]
    s_add_u32 m0, s66, 65536
    v_exp_f32 v72, v72
    v_exp_f32 v73, v73
    v_mfma_f32_16x16x32_bf16 v[68:71], a[212:215], v[56:59], v[200:203]
    buffer_load_dwordx4 v40, s[36:39], s56 offen offset:0 lds
    v_exp_f32 v74, v74
    v_exp_f32 v75, v75
    v_mfma_f32_16x16x32_bf16 v[144:147], a[224:227], v[80:83], v[144:147]
    buffer_load_dwordx4 v41, s[36:39], s56 offen offset:1024 lds
    v_exp_f32 v76, v76
    v_exp_f32 v77, v77
    v_mfma_f32_16x16x32_bf16 v[148:151], a[228:231], v[80:83], v[148:151]
    v_exp_f32 v78, v78
    v_exp_f32 v79, v79
    v_mfma_f32_16x16x32_bf16 v[176:179], a[232:235], v[80:83], v[176:179]
    v_cvt_pk_bf16_f32 v84, v72, v73
    v_cvt_pk_bf16_f32 v85, v74, v75
    v_cvt_pk_bf16_f32 v86, v76, v77
    v_cvt_pk_bf16_f32 v87, v78, v79
    v_mfma_f32_16x16x32_bf16 v[72:75], a[208:211], v[60:63], v[204:207]
    buffer_load_dwordx4 v42, s[36:39], s56 offen offset:2048 lds
    v_exp_f32 v64, v64
    v_exp_f32 v65, v65
    v_mfma_f32_16x16x32_bf16 v[76:79], a[212:215], v[60:63], v[204:207]
    ds_read_b128 a[212:215], v36 offset:3072
    v_exp_f32 v66, v66
    v_exp_f32 v67, v67
    v_mfma_f32_16x16x32_bf16 v[152:155], a[224:227], v[84:87], v[152:155]
    ds_read_b128 a[208:211], v36 offset:2048
    v_exp_f32 v68, v68
    v_exp_f32 v69, v69
    v_mfma_f32_16x16x32_bf16 v[156:159], a[228:231], v[84:87], v[156:159]
    buffer_load_dwordx4 v43, s[36:39], s56 offen offset:3072 lds
    v_exp_f32 v70, v70
    v_exp_f32 v71, v71
    v_mfma_f32_16x16x32_bf16 v[180:183], a[232:235], v[84:87], v[180:183]
    s_add_u32 s56, s56, 524288
    v_cvt_pk_bf16_f32 v80, v64, v65
    v_cvt_pk_bf16_f32 v81, v66, v67
    v_cvt_pk_bf16_f32 v82, v68, v69
    v_cvt_pk_bf16_f32 v83, v70, v71
    s_waitcnt lgkmcnt(2)
    v_mfma_f32_16x16x32_bf16 v[64:67], a[200:203], v[48:51], v[192:195]
    s_add_u32 m0, s66, 81920
    v_exp_f32 v72, v72
    v_exp_f32 v73, v73
    v_mfma_f32_16x16x32_bf16 v[68:71], a[204:207], v[48:51], v[192:195]
    buffer_load_dwordx4 v40, s[36:39], s57 offen offset:0 lds
    v_exp_f32 v74, v74
    v_exp_f32 v75, v75
    v_mfma_f32_16x16x32_bf16 v[160:163], a[224:227], v[80:83], v[160:163]
    buffer_load_dwordx4 v41, s[36:39], s57 offen offset:1024 lds
    v_exp_f32 v76, v76
    v_exp_f32 v77, v77
    v_mfma_f32_16x16x32_bf16 v[164:167], a[228:231], v[80:83], v[164:167]
    v_exp_f32 v78, v78
    v_exp_f32 v79, v79
    v_mfma_f32_16x16x32_bf16 v[184:187], a[232:235], v[80:83], v[184:187]
    v_cvt_pk_bf16_f32 v84, v72, v73
    v_cvt_pk_bf16_f32 v85, v74, v75
    v_cvt_pk_bf16_f32 v86, v76, v77
    v_cvt_pk_bf16_f32 v87, v78, v79
    v_mfma_f32_16x16x32_bf16 v[72:75], a[200:203], v[52:55], v[196:199]
    buffer_load_dwordx4 v42, s[36:39], s57 offen offset:2048 lds
    v_exp_f32 v64, v64
    v_exp_f32 v65, v65
    v_mfma_f32_16x16x32_bf16 v[76:79], a[204:207], v[52:55], v[196:199]
    buffer_load_dwordx4 v43, s[36:39], s57 offen offset:3072 lds
    v_exp_f32 v66, v66
    v_exp_f32 v67, v67
    v_mfma_f32_16x16x32_bf16 v[168:171], a[224:227], v[84:87], v[168:171]
    s_add_u32 s57, s57, 524288
    v_exp_f32 v68, v68
    v_exp_f32 v69, v69
    v_mfma_f32_16x16x32_bf16 v[172:175], a[228:231], v[84:87], v[172:175]
    ds_read_b128 a[224:227], v36 offset:34816
    v_exp_f32 v70, v70
    v_exp_f32 v71, v71
    v_mfma_f32_16x16x32_bf16 v[188:191], a[232:235], v[84:87], v[188:191]
    ds_read_b128 a[228:231], v36 offset:35840
    v_cvt_pk_bf16_f32 v80, v64, v65
    v_cvt_pk_bf16_f32 v81, v66, v67
    v_cvt_pk_bf16_f32 v82, v68, v69
    v_cvt_pk_bf16_f32 v83, v70, v71
    s_waitcnt lgkmcnt(2)
    v_mfma_f32_16x16x32_bf16 v[64:67], a[200:203], v[56:59], v[200:203]
    s_waitcnt vmcnt(8)
    s_mov_b64 exec, 1
    buffer_store_dwordx2 v[44:45], v46, s[44:47], s90 offen sc1
    s_mov_b64 exec, -1
    v_exp_f32 v72, v72
    v_exp_f32 v73, v73
    v_mfma_f32_16x16x32_bf16 v[68:71], a[204:207], v[56:59], v[200:203]
    s_mov_b32 s48, s18
    v_exp_f32 v74, v74
    v_exp_f32 v75, v75
    v_mfma_f32_16x16x32_bf16 v[144:147], a[216:219], v[80:83], v[144:147]
    s_and_b32 s49, s19, 0xffff
    v_exp_f32 v76, v76
    v_exp_f32 v77, v77
    v_mfma_f32_16x16x32_bf16 v[148:151], a[220:223], v[80:83], v[148:151]
    s_mov_b32 s50, 2048
    v_exp_f32 v78, v78
    v_exp_f32 v79, v79
    v_mfma_f32_16x16x32_bf16 v[176:179], a[232:235], v[80:83], v[176:179]
    v_cvt_pk_bf16_f32 v84, v72, v73
    v_cvt_pk_bf16_f32 v85, v74, v75
    v_cvt_pk_bf16_f32 v86, v76, v77
    v_cvt_pk_bf16_f32 v87, v78, v79
    v_mfma_f32_16x16x32_bf16 v[72:75], a[200:203], v[60:63], v[204:207]
    s_mov_b32 s51, 0x20000
    v_exp_f32 v64, v64
    v_exp_f32 v65, v65
    v_mfma_f32_16x16x32_bf16 v[76:79], a[204:207], v[60:63], v[204:207]
    ds_read_b128 a[204:207], v36 offset:1024
    v_exp_f32 v66, v66
    v_exp_f32 v67, v67
    v_mfma_f32_16x16x32_bf16 v[152:155], a[216:219], v[84:87], v[152:155]
    ds_read_b128 a[200:203], v36 offset:0
    v_exp_f32 v68, v68
    v_exp_f32 v69, v69
    v_mfma_f32_16x16x32_bf16 v[156:159], a[220:223], v[84:87], v[156:159]
    buffer_load_dwordx2 v[16:17], v141, s[48:51], s73 offen offset:0
    v_exp_f32 v70, v70
    v_exp_f32 v71, v71
    v_mfma_f32_16x16x32_bf16 v[180:183], a[232:235], v[84:87], v[180:183]
    buffer_load_dwordx2 v[18:19], v141, s[48:51], s73 offen offset:32
    v_cvt_pk_bf16_f32 v80, v64, v65
    v_cvt_pk_bf16_f32 v81, v66, v67
    v_cvt_pk_bf16_f32 v82, v68, v69
    v_cvt_pk_bf16_f32 v83, v70, v71
    s_waitcnt lgkmcnt(2)
    v_mfma_f32_16x16x32_bf16 v[64:67], a[208:211], v[48:51], v[192:195]
    buffer_load_dwordx2 v[20:21], v141, s[48:51], s73 offen offset:64
    v_exp_f32 v72, v72
    v_exp_f32 v73, v73
    v_mfma_f32_16x16x32_bf16 v[68:71], a[212:215], v[48:51], v[192:195]
    buffer_load_dwordx2 v[22:23], v141, s[48:51], s73 offen offset:96
    v_exp_f32 v74, v74
    v_exp_f32 v75, v75
    v_mfma_f32_16x16x32_bf16 v[160:163], a[216:219], v[80:83], v[160:163]
    s_add_u32 m0, s69, 0
    v_exp_f32 v76, v76
    v_exp_f32 v77, v77
    v_mfma_f32_16x16x32_bf16 v[164:167], a[220:223], v[80:83], v[164:167]
    s_xor_b32 s65, s101, 1048576
    v_exp_f32 v78, v78
    v_exp_f32 v79, v79
    v_mfma_f32_16x16x32_bf16 v[184:187], a[232:235], v[80:83], v[184:187]
    v_cvt_pk_bf16_f32 v84, v72, v73
    v_cvt_pk_bf16_f32 v85, v74, v75
    v_cvt_pk_bf16_f32 v86, v76, v77
    v_cvt_pk_bf16_f32 v87, v78, v79
    s_cmp_lt_u32 s92, 2
    s_cbranch_scc1 L_atB_skip2
    v_subrev_u32 v36, 4096, v36
    v_mfma_f32_16x16x32_bf16 v[72:75], a[208:211], v[52:55], v[196:199]
    s_add_u32 s65, s65, s100
    v_exp_f32 v64, v64
    v_exp_f32 v65, v65
    v_mfma_f32_16x16x32_bf16 v[76:79], a[212:215], v[52:55], v[196:199]
    buffer_load_dwordx4 v12, s[40:43], s65 offen offset:0 lds
    v_exp_f32 v66, v66
    v_exp_f32 v67, v67
    v_mfma_f32_16x16x32_bf16 v[168:171], a[216:219], v[84:87], v[168:171]
    buffer_load_dwordx4 v13, s[40:43], s65 offen offset:1024 lds
    v_exp_f32 v68, v68
    v_exp_f32 v69, v69
    v_mfma_f32_16x16x32_bf16 v[172:175], a[220:223], v[84:87], v[172:175]
    ds_read_b128 a[216:219], v36 offset:36864
    v_exp_f32 v70, v70
    v_exp_f32 v71, v71
    v_mfma_f32_16x16x32_bf16 v[188:191], a[232:235], v[84:87], v[188:191]
    ds_read_b128 a[220:223], v36 offset:37888
    v_cvt_pk_bf16_f32 v80, v64, v65
    v_cvt_pk_bf16_f32 v81, v66, v67
    v_cvt_pk_bf16_f32 v82, v68, v69
    v_cvt_pk_bf16_f32 v83, v70, v71
    s_waitcnt lgkmcnt(2)
    v_mfma_f32_16x16x32_bf16 v[64:67], a[208:211], v[56:59], v[200:203]
    s_add_u32 m0, s69, 8192
    v_exp_f32 v72, v72
    v_exp_f32 v73, v73
    v_mfma_f32_16x16x32_bf16 v[68:71], a[212:215], v[56:59], v[200:203]
    s_xor_b32 s65, s101, 1179648
    v_exp_f32 v74, v74
    v_exp_f32 v75, v75
    v_mfma_f32_16x16x32_bf16 v[144:147], a[224:227], v[80:83], v[144:147]
    s_add_u32 s65, s65, s100
    v_exp_f32 v76, v76
    v_exp_f32 v77, v77
    v_mfma_f32_16x16x32_bf16 v[148:151], a[228:231], v[80:83], v[148:151]
    buffer_load_dwordx4 v12, s[40:43], s65 offen offset:0 lds
    v_exp_f32 v78, v78
    v_exp_f32 v79, v79
    v_mfma_f32_16x16x32_bf16 v[176:179], a[232:235], v[80:83], v[176:179]
    v_cvt_pk_bf16_f32 v84, v72, v73
    v_cvt_pk_bf16_f32 v85, v74, v75
    v_cvt_pk_bf16_f32 v86, v76, v77
    v_cvt_pk_bf16_f32 v87, v78, v79
    v_mfma_f32_16x16x32_bf16 v[72:75], a[208:211], v[60:63], v[204:207]
    buffer_load_dwordx4 v13, s[40:43], s65 offen offset:1024 lds
    v_exp_f32 v64, v64
    v_exp_f32 v65, v65
    v_mfma_f32_16x16x32_bf16 v[76:79], a[212:215], v[60:63], v[204:207]
    ds_read_b128 a[212:215], v36 offset:3072
    v_exp_f32 v66, v66
    v_exp_f32 v67, v67
    v_mfma_f32_16x16x32_bf16 v[152:155], a[224:227], v[84:87], v[152:155]
    ds_read_b128 a[208:211], v36 offset:2048
    v_exp_f32 v68, v68
    v_exp_f32 v69, v69
    v_mfma_f32_16x16x32_bf16 v[156:159], a[228:231], v[84:87], v[156:159]
    s_add_u32 m0, s69, 16384
    v_exp_f32 v70, v70
    v_exp_f32 v71, v71
    v_mfma_f32_16x16x32_bf16 v[180:183], a[232:235], v[84:87], v[180:183]
    s_xor_b32 s65, s101, 1310720
    v_cvt_pk_bf16_f32 v80, v64, v65
    v_cvt_pk_bf16_f32 v81, v66, v67
    v_cvt_pk_bf16_f32 v82, v68, v69
    v_cvt_pk_bf16_f32 v83, v70, v71
    s_waitcnt lgkmcnt(2)
    v_mfma_f32_16x16x32_bf16 v[64:67], a[200:203], v[48:51], v[192:195]
    s_add_u32 s65, s65, s100
    v_exp_f32 v72, v72
    v_exp_f32 v73, v73
    v_mfma_f32_16x16x32_bf16 v[68:71], a[204:207], v[48:51], v[192:195]
    buffer_load_dwordx4 v12, s[40:43], s65 offen offset:0 lds
    v_exp_f32 v74, v74
    v_exp_f32 v75, v75
    v_mfma_f32_16x16x32_bf16 v[160:163], a[224:227], v[80:83], v[160:163]
    buffer_load_dwordx4 v13, s[40:43], s65 offen offset:1024 lds
    v_exp_f32 v76, v76
    v_exp_f32 v77, v77
    v_mfma_f32_16x16x32_bf16 v[164:167], a[228:231], v[80:83], v[164:167]
    s_add_u32 m0, s69, 24576
    v_exp_f32 v78, v78
    v_exp_f32 v79, v79
    v_mfma_f32_16x16x32_bf16 v[184:187], a[232:235], v[80:83], v[184:187]
    v_cvt_pk_bf16_f32 v84, v72, v73
    v_cvt_pk_bf16_f32 v85, v74, v75
    v_cvt_pk_bf16_f32 v86, v76, v77
    v_cvt_pk_bf16_f32 v87, v78, v79
    v_mfma_f32_16x16x32_bf16 v[72:75], a[200:203], v[52:55], v[196:199]
    s_xor_b32 s65, s101, 1441792
    v_exp_f32 v64, v64
    v_exp_f32 v65, v65
    v_mfma_f32_16x16x32_bf16 v[76:79], a[204:207], v[52:55], v[196:199]
    s_add_u32 s65, s65, s100
    v_exp_f32 v66, v66
    v_exp_f32 v67, v67
    v_mfma_f32_16x16x32_bf16 v[168:171], a[224:227], v[84:87], v[168:171]
    buffer_load_dwordx4 v12, s[40:43], s65 offen offset:0 lds
    v_exp_f32 v68, v68
    v_exp_f32 v69, v69
    v_mfma_f32_16x16x32_bf16 v[172:175], a[228:231], v[84:87], v[172:175]
    ds_read_b128 a[224:227], v36 offset:34816
    v_exp_f32 v70, v70
    v_exp_f32 v71, v71
    v_mfma_f32_16x16x32_bf16 v[188:191], a[232:235], v[84:87], v[188:191]
    ds_read_b128 a[228:231], v36 offset:35840
    v_cvt_pk_bf16_f32 v80, v64, v65
    v_cvt_pk_bf16_f32 v81, v66, v67
    v_cvt_pk_bf16_f32 v82, v68, v69
    v_cvt_pk_bf16_f32 v83, v70, v71
    s_waitcnt lgkmcnt(2)
    v_mfma_f32_16x16x32_bf16 v[64:67], a[200:203], v[56:59], v[200:203]
    buffer_load_dwordx4 v13, s[40:43], s65 offen offset:1024 lds
    v_exp_f32 v72, v72
    v_exp_f32 v73, v73
    v_mfma_f32_16x16x32_bf16 v[68:71], a[204:207], v[56:59], v[200:203]
    s_add_u32 m0, s69, 32768
    v_exp_f32 v74, v74
    v_exp_f32 v75, v75
    v_mfma_f32_16x16x32_bf16 v[144:147], a[216:219], v[80:83], v[144:147]
    s_xor_b32 s65, s101, 1572864
    v_exp_f32 v76, v76
    v_exp_f32 v77, v77
    v_mfma_f32_16x16x32_bf16 v[148:151], a[220:223], v[80:83], v[148:151]
    s_add_u32 s65, s65, s100
    v_exp_f32 v78, v78
    v_exp_f32 v79, v79
    v_mfma_f32_16x16x32_bf16 v[176:179], a[232:235], v[80:83], v[176:179]
    v_cvt_pk_bf16_f32 v84, v72, v73
    v_cvt_pk_bf16_f32 v85, v74, v75
    v_cvt_pk_bf16_f32 v86, v76, v77
    v_cvt_pk_bf16_f32 v87, v78, v79
    v_mfma_f32_16x16x32_bf16 v[72:75], a[200:203], v[60:63], v[204:207]
    buffer_load_dwordx4 v12, s[40:43], s65 offen offset:0 lds
    v_exp_f32 v64, v64
    v_exp_f32 v65, v65
    v_mfma_f32_16x16x32_bf16 v[76:79], a[204:207], v[60:63], v[204:207]
    ds_read_b128 a[204:207], v36 offset:1024
    v_exp_f32 v66, v66
    v_exp_f32 v67, v67
    v_mfma_f32_16x16x32_bf16 v[152:155], a[216:219], v[84:87], v[152:155]
    ds_read_b128 a[200:203], v36 offset:0
    v_exp_f32 v68, v68
    v_exp_f32 v69, v69
    v_mfma_f32_16x16x32_bf16 v[156:159], a[220:223], v[84:87], v[156:159]
    buffer_load_dwordx4 v13, s[40:43], s65 offen offset:1024 lds
    v_exp_f32 v70, v70
    v_exp_f32 v71, v71
    v_mfma_f32_16x16x32_bf16 v[180:183], a[232:235], v[84:87], v[180:183]
    s_add_u32 m0, s69, 40960
    v_cvt_pk_bf16_f32 v80, v64, v65
    v_cvt_pk_bf16_f32 v81, v66, v67
    v_cvt_pk_bf16_f32 v82, v68, v69
    v_cvt_pk_bf16_f32 v83, v70, v71
    s_waitcnt lgkmcnt(2)
    v_mfma_f32_16x16x32_bf16 v[64:67], a[208:211], v[48:51], v[192:195]
    s_xor_b32 s65, s101, 1703936
    v_exp_f32 v72, v72
    v_exp_f32 v73, v73
    v_mfma_f32_16x16x32_bf16 v[68:71], a[212:215], v[48:51], v[192:195]
    s_add_u32 s65, s65, s100
    v_exp_f32 v74, v74
    v_exp_f32 v75, v75
    v_mfma_f32_16x16x32_bf16 v[160:163], a[216:219], v[80:83], v[160:163]
    buffer_load_dwordx4 v12, s[40:43], s65 offen offset:0 lds
    v_exp_f32 v76, v76
    v_exp_f32 v77, v77
    v_mfma_f32_16x16x32_bf16 v[164:167], a[220:223], v[80:83], v[164:167]
    buffer_load_dwordx4 v13, s[40:43], s65 offen offset:1024 lds
    v_exp_f32 v78, v78
    v_exp_f32 v79, v79
    v_mfma_f32_16x16x32_bf16 v[184:187], a[232:235], v[80:83], v[184:187]
    v_cvt_pk_bf16_f32 v84, v72, v73
    v_cvt_pk_bf16_f32 v85, v74, v75
    v_cvt_pk_bf16_f32 v86, v76, v77
    v_cvt_pk_bf16_f32 v87, v78, v79
    s_cmp_lt_u32 s92, 3
    s_cbranch_scc1 L_atB_skip3
    v_subrev_u32 v36, 4096, v36
    v_mfma_f32_16x16x32_bf16 v[72:75], a[208:211], v[52:55], v[196:199]
    s_add_u32 m0, s69, 49152
    v_exp_f32 v64, v64
    v_exp_f32 v65, v65
    v_mfma_f32_16x16x32_bf16 v[76:79], a[212:215], v[52:55], v[196:199]
    s_xor_b32 s65, s101, 1835008
    v_exp_f32 v66, v66
    v_exp_f32 v67, v67
    v_mfma_f32_16x16x32_bf16 v[168:171], a[216:219], v[84:87], v[168:171]
    s_add_u32 s65, s65, s100
    v_exp_f32 v68, v68
    v_exp_f32 v69, v69
    v_mfma_f32_16x16x32_bf16 v[172:175], a[220:223], v[84:87], v[172:175]
    ds_read_b128 a[216:219], v36 offset:36864
    v_exp_f32 v70, v70
    v_exp_f32 v71, v71
    v_mfma_f32_16x16x32_bf16 v[188:191], a[232:235], v[84:87], v[188:191]
    ds_read_b128 a[220:223], v36 offset:37888
    v_cvt_pk_bf16_f32 v80, v64, v65
    v_cvt_pk_bf16_f32 v81, v66, v67
    v_cvt_pk_bf16_f32 v82, v68, v69
    v_cvt_pk_bf16_f32 v83, v70, v71
    s_waitcnt lgkmcnt(2)
    v_mfma_f32_16x16x32_bf16 v[64:67], a[208:211], v[56:59], v[200:203]
    buffer_load_dwordx4 v12, s[40:43], s65 offen offset:0 lds
    v_exp_f32 v72, v72
    v_exp_f32 v73, v73
    v_mfma_f32_16x16x32_bf16 v[68:71], a[212:215], v[56:59], v[200:203]
    buffer_load_dwordx4 v13, s[40:43], s65 offen offset:1024 lds
    v_exp_f32 v74, v74
    v_exp_f32 v75, v75
    v_mfma_f32_16x16x32_bf16 v[144:147], a[224:227], v[80:83], v[144:147]
    s_add_u32 m0, s69, 57344
    v_exp_f32 v76, v76
    v_exp_f32 v77, v77
    v_mfma_f32_16x16x32_bf16 v[148:151], a[228:231], v[80:83], v[148:151]
    s_xor_b32 s65, s101, 1966080
    v_exp_f32 v78, v78
    v_exp_f32 v79, v79
    v_mfma_f32_16x16x32_bf16 v[176:179], a[232:235], v[80:83], v[176:179]
    v_cvt_pk_bf16_f32 v84, v72, v73
    v_cvt_pk_bf16_f32 v85, v74, v75
    v_cvt_pk_bf16_f32 v86, v76, v77
    v_cvt_pk_bf16_f32 v87, v78, v79
    v_mfma_f32_16x16x32_bf16 v[72:75], a[208:211], v[60:63], v[204:207]
    s_add_u32 s65, s65, s100
    v_exp_f32 v64, v64
    v_exp_f32 v65, v65
    v_mfma_f32_16x16x32_bf16 v[76:79], a[212:215], v[60:63], v[204:207]
    ds_read_b128 a[212:215], v36 offset:3072
    v_exp_f32 v66, v66
    v_exp_f32 v67, v67
    v_mfma_f32_16x16x32_bf16 v[152:155], a[224:227], v[84:87], v[152:155]
    ds_read_b128 a[208:211], v36 offset:2048
    v_exp_f32 v68, v68
    v_exp_f32 v69, v69
    v_mfma_f32_16x16x32_bf16 v[156:159], a[228:231], v[84:87], v[156:159]
    buffer_load_dwordx4 v12, s[40:43], s65 offen offset:0 lds
    v_exp_f32 v70, v70
    v_exp_f32 v71, v71
    v_mfma_f32_16x16x32_bf16 v[180:183], a[232:235], v[84:87], v[180:183]
    buffer_load_dwordx4 v13, s[40:43], s65 offen offset:1024 lds
    v_cvt_pk_bf16_f32 v80, v64, v65
    v_cvt_pk_bf16_f32 v81, v66, v67
    v_cvt_pk_bf16_f32 v82, v68, v69
    v_cvt_pk_bf16_f32 v83, v70, v71
    s_waitcnt lgkmcnt(2)
    v_mfma_f32_16x16x32_bf16 v[64:67], a[200:203], v[48:51], v[192:195]
    v_exp_f32 v72, v72
    v_exp_f32 v73, v73
    v_mfma_f32_16x16x32_bf16 v[68:71], a[204:207], v[48:51], v[192:195]
    v_exp_f32 v74, v74
    v_exp_f32 v75, v75
    v_mfma_f32_16x16x32_bf16 v[160:163], a[224:227], v[80:83], v[160:163]
    v_exp_f32 v76, v76
    v_exp_f32 v77, v77
    v_mfma_f32_16x16x32_bf16 v[164:167], a[228:231], v[80:83], v[164:167]
    v_exp_f32 v78, v78
    v_exp_f32 v79, v79
    v_mfma_f32_16x16x32_bf16 v[184:187], a[232:235], v[80:83], v[184:187]
    v_cvt_pk_bf16_f32 v84, v72, v73
    v_cvt_pk_bf16_f32 v85, v74, v75
    v_cvt_pk_bf16_f32 v86, v76, v77
    v_cvt_pk_bf16_f32 v87, v78, v79
    v_mfma_f32_16x16x32_bf16 v[72:75], a[200:203], v[52:55], v[196:199]
    v_exp_f32 v64, v64
    v_exp_f32 v65, v65
    v_mfma_f32_16x16x32_bf16 v[76:79], a[204:207], v[52:55], v[196:199]
    v_exp_f32 v66, v66
    v_exp_f32 v67, v67
    v_mfma_f32_16x16x32_bf16 v[168:171], a[224:227], v[84:87], v[168:171]
    v_exp_f32 v68, v68
    v_exp_f32 v69, v69
    v_mfma_f32_16x16x32_bf16 v[172:175], a[228:231], v[84:87], v[172:175]
    ds_read_b128 a[224:227], v36 offset:34816
    v_exp_f32 v70, v70
    v_exp_f32 v71, v71
    v_mfma_f32_16x16x32_bf16 v[188:191], a[232:235], v[84:87], v[188:191]
    ds_read_b128 a[228:231], v36 offset:35840
    v_cvt_pk_bf16_f32 v80, v64, v65
    v_cvt_pk_bf16_f32 v81, v66, v67
    v_cvt_pk_bf16_f32 v82, v68, v69
    v_cvt_pk_bf16_f32 v83, v70, v71
    s_waitcnt lgkmcnt(2)
    v_mfma_f32_16x16x32_bf16 v[64:67], a[200:203], v[56:59], v[200:203]
    v_exp_f32 v72, v72
    v_exp_f32 v73, v73
    v_mfma_f32_16x16x32_bf16 v[68:71], a[204:207], v[56:59], v[200:203]
    v_exp_f32 v74, v74
    v_exp_f32 v75, v75
    v_mfma_f32_16x16x32_bf16 v[144:147], a[216:219], v[80:83], v[144:147]
    v_exp_f32 v76, v76
    v_exp_f32 v77, v77
    v_mfma_f32_16x16x32_bf16 v[148:151], a[220:223], v[80:83], v[148:151]
    v_exp_f32 v78, v78
    v_exp_f32 v79, v79
    v_mfma_f32_16x16x32_bf16 v[176:179], a[232:235], v[80:83], v[176:179]
    v_cvt_pk_bf16_f32 v84, v72, v73
    v_cvt_pk_bf16_f32 v85, v74, v75
    v_cvt_pk_bf16_f32 v86, v76, v77
    v_cvt_pk_bf16_f32 v87, v78, v79
    v_mfma_f32_16x16x32_bf16 v[72:75], a[200:203], v[60:63], v[204:207]
    buffer_load_dwordx2 v[2:3], v38, s[44:47], s93 offen sc1
    v_exp_f32 v64, v64
    v_exp_f32 v65, v65
    v_mfma_f32_16x16x32_bf16 v[76:79], a[204:207], v[60:63], v[204:207]
    ds_read_b128 a[204:207], v36 offset:1024
    v_exp_f32 v66, v66
    v_exp_f32 v67, v67
    v_mfma_f32_16x16x32_bf16 v[152:155], a[216:219], v[84:87], v[152:155]
    ds_read_b128 a[200:203], v36 offset:0
    v_exp_f32 v68, v68
    v_exp_f32 v69, v69
    v_mfma_f32_16x16x32_bf16 v[156:159], a[220:223], v[84:87], v[156:159]
    v_exp_f32 v70, v70
    v_exp_f32 v71, v71
    v_mfma_f32_16x16x32_bf16 v[180:183], a[232:235], v[84:87], v[180:183]
    v_cvt_pk_bf16_f32 v80, v64, v65
    v_cvt_pk_bf16_f32 v81, v66, v67
    v_cvt_pk_bf16_f32 v82, v68, v69
    v_cvt_pk_bf16_f32 v83, v70, v71
    s_waitcnt lgkmcnt(2)
    v_mfma_f32_16x16x32_bf16 v[64:67], a[208:211], v[48:51], v[192:195]
    v_exp_f32 v72, v72
    v_exp_f32 v73, v73
    v_mfma_f32_16x16x32_bf16 v[68:71], a[212:215], v[48:51], v[192:195]
    v_exp_f32 v74, v74
    v_exp_f32 v75, v75
    v_mfma_f32_16x16x32_bf16 v[160:163], a[216:219], v[80:83], v[160:163]
    v_exp_f32 v76, v76
    v_exp_f32 v77, v77
    v_mfma_f32_16x16x32_bf16 v[164:167], a[220:223], v[80:83], v[164:167]
    v_exp_f32 v78, v78
    v_exp_f32 v79, v79
    v_mfma_f32_16x16x32_bf16 v[184:187], a[232:235], v[80:83], v[184:187]
    v_cvt_pk_bf16_f32 v84, v72, v73
    v_cvt_pk_bf16_f32 v85, v74, v75
    v_cvt_pk_bf16_f32 v86, v76, v77
    v_cvt_pk_bf16_f32 v87, v78, v79
    s_branch L_atB_x1
L_atB_skip1:
    s_add_u32 s87, s85, 294912
    buffer_store_dwordx4 v[248:251], v33, s[44:47], s87 offen sc1
    s_add_u32 m0, s66, 65536
    s_nop 0
    buffer_load_dwordx4 v40, s[36:39], s56 offen offset:0 lds
    buffer_load_dwordx4 v41, s[36:39], s56 offen offset:1024 lds
    buffer_load_dwordx4 v42, s[36:39], s56 offen offset:2048 lds
    buffer_load_dwordx4 v43, s[36:39], s56 offen offset:3072 lds
    s_add_u32 s56, s56, 524288
    s_add_u32 m0, s66, 81920
    s_nop 0
    buffer_load_dwordx4 v40, s[36:39], s57 offen offset:0 lds
    buffer_load_dwordx4 v41, s[36:39], s57 offen offset:1024 lds
    buffer_load_dwordx4 v42, s[36:39], s57 offen offset:2048 lds
    buffer_load_dwordx4 v43, s[36:39], s57 offen offset:3072 lds
    s_add_u32 s57, s57, 524288
    s_waitcnt vmcnt(8)
    s_mov_b64 exec, 1
    buffer_store_dwordx2 v[44:45], v46, s[44:47], s90 offen sc1
    s_mov_b64 exec, -1
    s_mov_b32 s48, s18
    s_and_b32 s49, s19, 0xffff
    s_mov_b32 s50, 2048
    s_mov_b32 s51, 0x20000
    buffer_load_dwordx2 v[16:17], v141, s[48:51], s73 offen offset:0
    buffer_load_dwordx2 v[18:19], v141, s[48:51], s73 offen offset:32
    buffer_load_dwordx2 v[20:21], v141, s[48:51], s73 offen offset:64
    buffer_load_dwordx2 v[22:23], v141, s[48:51], s73 offen offset:96
    s_add_u32 m0, s69, 0
    s_xor_b32 s65, s101, 1048576
L_atB_skip2:
    s_add_u32 s65, s65, s100
    buffer_load_dwordx4 v12, s[40:43], s65 offen offset:0 lds
    buffer_load_dwordx4 v13, s[40:43], s65 offen offset:1024 lds
    s_add_u32 m0, s69, 8192
    s_xor_b32 s65, s101, 1179648
    s_add_u32 s65, s65, s100
    buffer_load_dwordx4 v12, s[40:43], s65 offen offset:0 lds
    buffer_load_dwordx4 v13, s[40:43], s65 offen offset:1024 lds
    s_add_u32 m0, s69, 16384
    s_xor_b32 s65, s101, 1310720
    s_add_u32 s65, s65, s100
    buffer_load_dwordx4 v12, s[40:43], s65 offen offset:0 lds
    buffer_load_dwordx4 v13, s[40:43], s65 offen offset:1024 lds
    s_add_u32 m0, s69, 24576
    s_xor_b32 s65, s101, 1441792
    s_add_u32 s65, s65, s100
    buffer_load_dwordx4 v12, s[40:43], s65 offen offset:0 lds
    buffer_load_dwordx4 v13, s[40:43], s65 offen offset:1024 lds
    s_add_u32 m0, s69, 32768
    s_xor_b32 s65, s101, 1572864
    s_add_u32 s65, s65, s100
    buffer_load_dwordx4 v12, s[40:43], s65 offen offset:0 lds
    buffer_load_dwordx4 v13, s[40:43], s65 offen offset:1024 lds
    s_add_u32 m0, s69, 40960
    s_xor_b32 s65, s101, 1703936
    s_add_u32 s65, s65, s100
    buffer_load_dwordx4 v12, s[40:43], s65 offen offset:0 lds
    buffer_load_dwordx4 v13, s[40:43], s65 offen offset:1024 lds
L_atB_skip3:
    s_add_u32 m0, s69, 49152
    s_xor_b32 s65, s101, 1835008
    s_add_u32 s65, s65, s100
    buffer_load_dwordx4 v12, s[40:43], s65 offen offset:0 lds
    buffer_load_dwordx4 v13, s[40:43], s65 offen offset:1024 lds
    s_add_u32 m0, s69, 57344
    s_xor_b32 s65, s101, 1966080
    s_add_u32 s65, s65, s100
    buffer_load_dwordx4 v12, s[40:43], s65 offen offset:0 lds
    buffer_load_dwordx4 v13, s[40:43], s65 offen offset:1024 lds
    buffer_load_dwordx2 v[2:3], v38, s[44:47], s93 offen sc1
L_atB_x1:
    s_waitcnt vmcnt(0)
    v_cmp_ne_u64 vcc, s[70:71], v[2:3]
    s_mov_b32 s95, 0x40000
    s_nop 0
    s_cmp_eq_u64 vcc, 0
    s_cbranch_scc1 L_pfh_ok
L_pfh_spin:
    s_sleep 1
    buffer_load_dwordx2 v[2:3], v38, s[44:47], s93 offen sc1
    s_waitcnt vmcnt(0)
    v_cmp_ne_u64 vcc, s[70:71], v[2:3]
    s_sub_u32 s95, s95, 1
    s_cmp_eq_u32 s95, 0
    s_cbranch_scc1 L_pfh_ok
    s_cmp_lg_u64 vcc, 0
    s_cbranch_scc1 L_pfh_spin
L_pfh_ok:
    buffer_load_dwordx4 a[0:3], v1, s[32:35], s52 offen offset:0 sc1
    buffer_load_dwordx4 a[4:7], v1, s[32:35], s52 offen offset:1024 sc1
    v_lshlrev_b32 v240, 16, v16
    v_and_b32 v241, 0xffff0000, v16
    v_lshlrev_b32 v242, 16, v17
    v_and_b32 v243, 0xffff0000, v17
    v_lshlrev_b32 v244, 16, v18
    v_and_b32 v245, 0xffff0000, v18
    v_lshlrev_b32 v246, 16, v19
    v_and_b32 v247, 0xffff0000, v19
    v_lshlrev_b32 v248, 16, v20
    v_and_b32 v249, 0xffff0000, v20
    v_lshlrev_b32 v250, 16, v21
    v_and_b32 v251, 0xffff0000, v21
    v_lshlrev_b32 v252, 16, v22
    v_and_b32 v253, 0xffff0000, v22
    v_lshlrev_b32 v254, 16, v23
    v_and_b32 v255, 0xffff0000, v23
    s_cmp_eq_u32 s27, 0
    s_cbranch_scc1 L_atB_exit
    v_mfma_f32_16x16x32_bf16 v[72:75], a[208:211], v[52:55], v[196:199]
    buffer_load_dwordx4 a[8:11], v1, s[32:35], s52 offen offset:2048 sc1
    v_exp_f32 v64, v64
    v_exp_f32 v65, v65
    v_mfma_f32_16x16x32_bf16 v[76:79], a[212:215], v[52:55], v[196:199]
    buffer_load_dwordx4 a[12:15], v1, s[32:35], s52 offen offset:3072 sc1
    v_exp_f32 v66, v66
    v_exp_f32 v67, v67
    v_mfma_f32_16x16x32_bf16 v[168:171], a[216:219], v[84:87], v[168:171]
    s_add_u32 s52, s52, 16384
    v_exp_f32 v68, v68
    v_exp_f32 v69, v69
    v_mfma_f32_16x16x32_bf16 v[172:175], a[220:223], v[84:87], v[172:175]
    ds_read_b128 a[216:219], v36 offset:32768
    v_exp_f32 v70, v70
    v_exp_f32 v71, v71
    v_mfma_f32_16x16x32_bf16 v[188:191], a[232:235], v[84:87], v[188:191]
    ds_read_b128 a[220:223], v36 offset:33792
    buffer_load_dwordx4 a[16:19], v1, s[32:35], s53 offen offset:0 sc1
    v_cvt_pk_bf16_f32 v80, v64, v65
    v_cvt_pk_bf16_f32 v81, v66, v67
    v_cvt_pk_bf16_f32 v82, v68, v69
    v_cvt_pk_bf16_f32 v83, v70, v71
    s_waitcnt lgkmcnt(2)
    v_mfma_f32_16x16x32_bf16 v[64:67], a[208:211], v[56:59], v[120:123]
    buffer_load_dwordx4 a[20:23], v1, s[32:35], s53 offen offset:1024 sc1
    v_exp_f32 v72, v72
    v_exp_f32 v73, v73
    v_mfma_f32_16x16x32_bf16 v[68:71], a[212:215], v[56:59], v[200:203]
    buffer_load_dwordx4 a[24:27], v1, s[32:35], s53 offen offset:2048 sc1
    v_exp_f32 v74, v74
    v_exp_f32 v75, v75
    v_mfma_f32_16x16x32_bf16 v[144:147], a[224:227], v[80:83], v[144:147]
    buffer_load_dwordx4 a[28:31], v1, s[32:35], s53 offen offset:3072 sc1
    v_exp_f32 v76, v76
    v_exp_f32 v77, v77
    v_mfma_f32_16x16x32_bf16 v[148:151], a[228:231], v[80:83], v[148:151]
    s_add_u32 s53, s53, 16384
    v_exp_f32 v78, v78
    v_exp_f32 v79, v79
    v_mfma_f32_16x16x32_bf16 v[176:179], a[232:235], v[80:83], v[176:179]
    v_cvt_pk_bf16_f32 v84, v72, v73
    v_cvt_pk_bf16_f32 v85, v74, v75
    v_cvt_pk_bf16_f32 v86, v76, v77
    v_cvt_pk_bf16_f32 v87, v78, v79
    v_mfma_f32_16x16x32_bf16 v[76:79], a[212:215], v[60:63], v[124:127]
    buffer_load_dwordx4 a[32:35], v1, s[32:35], s54 offen offset:0 sc1
    v_exp_f32 v64, v64
    v_exp_f32 v65, v65
    v_mfma_f32_16x16x32_bf16 v[152:155], a[224:227], v[84:87], v[152:155]
    buffer_load_dwordx4 a[36:39], v1, s[32:35], s54 offen offset:1024 sc1
    v_exp_f32 v66, v66
    v_exp_f32 v67, v67
    v_mfma_f32_16x16x32_bf16 v[156:159], a[228:231], v[84:87], v[156:159]
    buffer_load_dwordx4 a[40:43], v1, s[32:35], s54 offen offset:2048 sc1
    v_exp_f32 v68, v68
    v_exp_f32 v69, v69
    v_mfma_f32_16x16x32_bf16 v[180:183], a[232:235], v[84:87], v[180:183]
    v_exp_f32 v70, v70
    v_exp_f32 v71, v71
    v_cvt_pk_bf16_f32 v80, v64, v65
    v_cvt_pk_bf16_f32 v81, v66, v67
    v_cvt_pk_bf16_f32 v82, v68, v69
    v_cvt_pk_bf16_f32 v83, v70, v71
    s_waitcnt lgkmcnt(0)
    v_mfma_f32_16x16x32_bf16 v[64:67], a[200:203], v[48:51], v[112:115]
    buffer_load_dwordx4 a[44:47], v1, s[32:35], s54 offen offset:3072 sc1
    v_exp_f32 v76, v76
    v_exp_f32 v77, v77
    v_mfma_f32_16x16x32_bf16 v[68:71], a[204:207], v[48:51], v[192:195]
    s_add_u32 s54, s54, 16384
    v_exp_f32 v78, v78
    v_exp_f32 v79, v79
    v_mfma_f32_16x16x32_bf16 v[160:163], a[224:227], v[80:83], v[160:163]
    buffer_load_dwordx4 a[48:51], v1, s[32:35], s55 offen offset:0 sc1
    v_mfma_f32_16x16x32_bf16 v[164:167], a[228:231], v[80:83], v[164:167]
    buffer_load_dwordx4 a[52:55], v1, s[32:35], s55 offen offset:1024 sc1
    v_mfma_f32_16x16x32_bf16 v[184:187], a[232:235], v[80:83], v[184:187]
    v_mov_b32 v84, 0
    v_mov_b32 v85, 0
    v_cvt_pk_bf16_f32 v86, v76, v77
    v_cvt_pk_bf16_f32 v87, v78, v79
    v_mfma_f32_16x16x32_bf16 v[76:79], a[204:207], v[52:55], v[116:119]
    buffer_load_dwordx4 a[56:59], v1, s[32:35], s55 offen offset:2048 sc1
    v_exp_f32 v64, v64
    v_exp_f32 v65, v65
    v_mfma_f32_16x16x32_bf16 v[168:171], a[224:227], v[84:87], v[168:171]
    buffer_load_dwordx4 a[60:63], v1, s[32:35], s55 offen offset:3072 sc1
    v_exp_f32 v66, v66
    v_exp_f32 v67, v67
    v_mfma_f32_16x16x32_bf16 v[172:175], a[228:231], v[84:87], v[172:175]
    s_add_u32 s55, s55, 16384
    v_exp_f32 v68, v68
    v_exp_f32 v69, v69
    v_mfma_f32_16x16x32_bf16 v[188:191], a[232:235], v[84:87], v[188:191]
    v_exp_f32 v70, v70
    v_exp_f32 v71, v71
    v_cvt_pk_bf16_f32 v80, v64, v65
    v_cvt_pk_bf16_f32 v81, v66, v67
    v_cvt_pk_bf16_f32 v82, v68, v69
    v_cvt_pk_bf16_f32 v83, v70, v71
    s_waitcnt lgkmcnt(0)
    s_nop 0
    v_mfma_f32_16x16x32_bf16 v[144:147], a[216:219], v[80:83], v[144:147]
    v_exp_f32 v76, v76
    v_exp_f32 v77, v77
    v_mfma_f32_16x16x32_bf16 v[148:151], a[220:223], v[80:83], v[148:151]
    v_exp_f32 v78, v78
    v_exp_f32 v79, v79
    v_mfma_f32_16x16x32_bf16 v[176:179], a[232:235], v[80:83], v[176:179]
    v_mov_b32 v84, 0
    v_mov_b32 v85, 0
    v_cvt_pk_bf16_f32 v86, v76, v77
    v_cvt_pk_bf16_f32 v87, v78, v79
    s_waitcnt lgkmcnt(0)
    s_nop 0
    v_mfma_f32_16x16x32_bf16 v[152:155], a[216:219], v[84:87], v[152:155]
    v_mfma_f32_16x16x32_bf16 v[156:159], a[220:223], v[84:87], v[156:159]
    v_mfma_f32_16x16x32_bf16 v[180:183], a[232:235], v[84:87], v[180:183]
    s_branch L_atB_done
L_atB_exit:
    v_mfma_f32_16x16x32_bf16 v[168:171], a[216:219], v[84:87], v[168:171]
    v_mfma_f32_16x16x32_bf16 v[172:175], a[220:223], v[84:87], v[172:175]
    v_mfma_f32_16x16x32_bf16 v[188:191], a[232:235], v[84:87], v[188:191]
    buffer_load_dwordx4 a[8:11], v1, s[32:35], s52 offen offset:2048 sc1
    buffer_load_dwordx4 a[12:15], v1, s[32:35], s52 offen offset:3072 sc1
    s_add_u32 s52, s52, 16384
    buffer_load_dwordx4 a[16:19], v1, s[32:35], s53 offen offset:0 sc1
    buffer_load_dwordx4 a[20:23], v1, s[32:35], s53 offen offset:1024 sc1
    buffer_load_dwordx4 a[24:27], v1, s[32:35], s53 offen offset:2048 sc1
    buffer_load_dwordx4 a[28:31], v1, s[32:35], s53 offen offset:3072 sc1
    s_add_u32 s53, s53, 16384
    buffer_load_dwordx4 a[32:35], v1, s[32:35], s54 offen offset:0 sc1
    buffer_load_dwordx4 a[36:39], v1, s[32:35], s54 offen offset:1024 sc1
    buffer_load_dwordx4 a[40:43], v1, s[32:35], s54 offen offset:2048 sc1
    buffer_load_dwordx4 a[44:47], v1, s[32:35], s54 offen offset:3072 sc1
    s_add_u32 s54, s54, 16384
    buffer_load_dwordx4 a[48:51], v1, s[32:35], s55 offen offset:0 sc1
    buffer_load_dwordx4 a[52:55], v1, s[32:35], s55 offen offset:1024 sc1
    buffer_load_dwordx4 a[56:59], v1, s[32:35], s55 offen offset:2048 sc1
    buffer_load_dwordx4 a[60:63], v1, s[32:35], s55 offen offset:3072 sc1
    s_add_u32 s55, s55, 16384
    s_waitcnt lgkmcnt(0)
L_atB_done:
    s_barrier
    s_add_u32 m0, s66, 98304
    s_nop 0
    buffer_load_dwordx4 v40, s[36:39], s58 offen offset:0 lds
    buffer_load_dwordx4 v41, s[36:39], s58 offen offset:1024 lds
    buffer_load_dwordx4 v42, s[36:39], s58 offen offset:2048 lds
    buffer_load_dwordx4 v43, s[36:39], s58 offen offset:3072 lds
    s_add_u32 s58, s58, 524288
    s_add_u32 m0, s66, 114688
    s_nop 0
    buffer_load_dwordx4 v40, s[36:39], s59 offen offset:0 lds
    buffer_load_dwordx4 v41, s[36:39], s59 offen offset:1024 lds
    buffer_load_dwordx4 v42, s[36:39], s59 offen offset:2048 lds
    buffer_load_dwordx4 v43, s[36:39], s59 offen offset:3072 lds
    s_add_u32 s59, s59, 524288
    ds_read_b64_tr_b16 a[128:129], v132 offset:0
    ds_read_b64_tr_b16 a[130:131], v132 offset:4096
    ds_read_b64_tr_b16 a[132:133], v133 offset:0
    ds_read_b64_tr_b16 a[134:135], v133 offset:4096
    ds_read_b64_tr_b16 a[136:137], v134 offset:0
    ds_read_b64_tr_b16 a[138:139], v134 offset:4096
    ds_read_b64_tr_b16 a[140:141], v135 offset:0
    ds_read_b64_tr_b16 a[142:143], v135 offset:4096
    ds_read_b64_tr_b16 a[144:145], v132 offset:2048
    ds_read_b64_tr_b16 a[146:147], v132 offset:6144
    ds_read_b64_tr_b16 a[148:149], v133 offset:2048
    ds_read_b64_tr_b16 a[150:151], v133 offset:6144
    ds_read_b64_tr_b16 a[152:153], v134 offset:2048
    ds_read_b64_tr_b16 a[154:155], v134 offset:6144
    ds_read_b64_tr_b16 a[156:157], v135 offset:2048
    ds_read_b64_tr_b16 a[158:159], v135 offset:6144
    ds_read_b64_tr_b16 a[160:161], v132 offset:8192
    ds_read_b64_tr_b16 a[162:163], v132 offset:12288
    ds_read_b64_tr_b16 a[164:165], v133 offset:8192
    ds_read_b64_tr_b16 a[166:167], v133 offset:12288
    ds_read_b64_tr_b16 a[168:169], v134 offset:8192
    ds_read_b64_tr_b16 a[170:171], v134 offset:12288
    ds_read_b64_tr_b16 a[172:173], v135 offset:8192
    ds_read_b64_tr_b16 a[174:175], v135 offset:12288
    ds_read_b64_tr_b16 a[176:177], v132 offset:10240
    ds_read_b64_tr_b16 a[178:179], v132 offset:14336
    ds_read_b64_tr_b16 a[180:181], v133 offset:10240
    ds_read_b64_tr_b16 a[182:183], v133 offset:14336
    ds_read_b64_tr_b16 a[184:185], v134 offset:10240
    ds_read_b64_tr_b16 a[186:187], v134 offset:14336
    ds_read_b64_tr_b16 a[188:189], v135 offset:10240
    ds_read_b64_tr_b16 a[190:191], v135 offset:14336
    s_add_u32 s87, s86, 294912
    v_rcp_f32 v4, v184
    s_nop 0
    v_pk_mul_f32 v[160:161], v[160:161], v[4:5] op_sel_hi:[1,0]
    v_pk_mul_f32 v[162:163], v[162:163], v[4:5] op_sel_hi:[1,0]
    v_pk_mul_f32 v[164:165], v[164:165], v[4:5] op_sel_hi:[1,0]
    v_pk_mul_f32 v[166:167], v[166:167], v[4:5] op_sel_hi:[1,0]
    v_cvt_pk_bf16_f32 v160, v160, v161
    v_cvt_pk_bf16_f32 v161, v162, v163
    v_cvt_pk_bf16_f32 v162, v164, v165
    v_cvt_pk_bf16_f32 v163, v166, v167
    buffer_store_dwordx4 v[160:163], v1, s[44:47], s87 offen offset:0 sc1
    v_rcp_f32 v4, v188
    s_nop 0
    v_pk_mul_f32 v[168:169], v[168:169], v[4:5] op_sel_hi:[1,0]
    v_pk_mul_f32 v[170:171], v[170:171], v[4:5] op_sel_hi:[1,0]
    v_pk_mul_f32 v[172:173], v[172:173], v[4:5] op_sel_hi:[1,0]
    v_pk_mul_f32 v[174:175], v[174:175], v[4:5] op_sel_hi:[1,0]
    v_cvt_pk_bf16_f32 v168, v168, v169
    v_cvt_pk_bf16_f32 v169, v170, v171
    v_cvt_pk_bf16_f32 v170, v172, v173
    v_cvt_pk_bf16_f32 v171, v174, v175
    buffer_store_dwordx4 v[168:171], v1, s[44:47], s87 offen offset:1024 sc1
    v_rcp_f32 v4, v176
    s_nop 0
    v_pk_mul_f32 v[144:145], v[144:145], v[4:5] op_sel_hi:[1,0]
    v_pk_mul_f32 v[146:147], v[146:147], v[4:5] op_sel_hi:[1,0]
    v_pk_mul_f32 v[148:149], v[148:149], v[4:5] op_sel_hi:[1,0]
    v_pk_mul_f32 v[150:151], v[150:151], v[4:5] op_sel_hi:[1,0]
    v_cvt_pk_bf16_f32 v144, v144, v145
    v_cvt_pk_bf16_f32 v145, v146, v147
    v_cvt_pk_bf16_f32 v146, v148, v149
    v_cvt_pk_bf16_f32 v147, v150, v151
    buffer_store_dwordx4 v[144:147], v1, s[44:47], s86 offen offset:0 sc1
    v_rcp_f32 v4, v180
    s_nop 0
    v_pk_mul_f32 v[152:153], v[152:153], v[4:5] op_sel_hi:[1,0]
    v_pk_mul_f32 v[154:155], v[154:155], v[4:5] op_sel_hi:[1,0]
    v_pk_mul_f32 v[156:157], v[156:157], v[4:5] op_sel_hi:[1,0]
    v_pk_mul_f32 v[158:159], v[158:159], v[4:5] op_sel_hi:[1,0]
    v_cvt_pk_bf16_f32 v152, v152, v153
    v_cvt_pk_bf16_f32 v153, v154, v155
    v_cvt_pk_bf16_f32 v154, v156, v157
    v_cvt_pk_bf16_f32 v155, v158, v159
    buffer_store_dwordx4 v[152:155], v1, s[44:47], s86 offen offset:1024 sc1
    s_waitcnt vmcnt(26)
    s_waitcnt lgkmcnt(15)
    v_mfma_f32_16x16x32_bf16 v[64:67], a[128:131], a[0:3], v[240:243]
    s_barrier
    v_mfma_f32_16x16x32_bf16 v[68:71], a[128:131], a[4:7], v[240:243]
    ds_read_b64_tr_b16 a[128:129], v132 offset:16384
    v_mfma_f32_16x16x32_bf16 v[72:75], a[132:135], a[0:3], v[244:247]
    ds_read_b64_tr_b16 a[130:131], v132 offset:20480
    v_mfma_f32_16x16x32_bf16 v[76:79], a[132:135], a[4:7], v[244:247]
    ds_read_b64_tr_b16 a[132:133], v133 offset:16384
    v_mfma_f32_16x16x32_bf16 v[80:83], a[136:139], a[0:3], v[248:251]
    ds_read_b64_tr_b16 a[134:135], v133 offset:20480
    v_mfma_f32_16x16x32_bf16 v[84:87], a[136:139], a[4:7], v[248:251]
    ds_read_b64_tr_b16 a[136:137], v134 offset:16384
    v_mfma_f32_16x16x32_bf16 v[88:91], a[140:143], a[0:3], v[252:255]
    ds_read_b64_tr_b16 a[138:139], v134 offset:20480
    v_mfma_f32_16x16x32_bf16 v[92:95], a[140:143], a[4:7], v[252:255]
    ds_read_b64_tr_b16 a[140:141], v135 offset:16384
    v_mfma_f32_16x16x32_bf16 v[96:99], a[144:147], a[0:3], 0
    ds_read_b64_tr_b16 a[142:143], v135 offset:20480
    v_mfma_f32_16x16x32_bf16 v[100:103], a[144:147], a[4:7], 0
    ds_read_b64_tr_b16 a[144:145], v132 offset:18432
    v_mfma_f32_16x16x32_bf16 v[104:107], a[148:151], a[0:3], 0
    ds_read_b64_tr_b16 a[146:147], v132 offset:22528
    v_mfma_f32_16x16x32_bf16 v[108:111], a[148:151], a[4:7], 0
    ds_read_b64_tr_b16 a[148:149], v133 offset:18432
    v_mfma_f32_16x16x32_bf16 v[112:115], a[152:155], a[0:3], 0
    ds_read_b64_tr_b16 a[150:151], v133 offset:22528
    s_waitcnt vmcnt(24)
    v_mfma_f32_16x16x32_bf16 v[116:119], a[152:155], a[4:7], 0
    ds_read_b64_tr_b16 a[152:153], v134 offset:18432
    v_mfma_f32_16x16x32_bf16 v[120:123], a[156:159], a[0:3], 0
    ds_read_b64_tr_b16 a[154:155], v134 offset:22528
    s_waitcnt lgkmcnt(14)
    v_mfma_f32_16x16x32_bf16 v[124:127], a[156:159], a[4:7], 0
    ds_read_b64_tr_b16 a[156:157], v135 offset:18432
    ds_read_b64_tr_b16 a[158:159], v135 offset:22528
    v_mfma_f32_16x16x32_bf16 v[64:67], a[160:163], a[8:11], v[64:67]
    v_mfma_f32_16x16x32_bf16 v[68:71], a[160:163], a[12:15], v[68:71]
    ds_read_b64_tr_b16 a[160:161], v132 offset:24576
    v_mfma_f32_16x16x32_bf16 v[72:75], a[164:167], a[8:11], v[72:75]
    ds_read_b64_tr_b16 a[162:163], v132 offset:28672
    v_mfma_f32_16x16x32_bf16 v[76:79], a[164:167], a[12:15], v[76:79]
    ds_read_b64_tr_b16 a[164:165], v133 offset:24576
    v_mfma_f32_16x16x32_bf16 v[80:83], a[168:171], a[8:11], v[80:83]
    ds_read_b64_tr_b16 a[166:167], v133 offset:28672
    v_mfma_f32_16x16x32_bf16 v[84:87], a[168:171], a[12:15], v[84:87]
    ds_read_b64_tr_b16 a[168:169], v134 offset:24576
    v_mfma_f32_16x16x32_bf16 v[88:91], a[172:175], a[8:11], v[88:91]
    ds_read_b64_tr_b16 a[170:171], v134 offset:28672
    v_mfma_f32_16x16x32_bf16 v[92:95], a[172:175], a[12:15], v[92:95]
    ds_read_b64_tr_b16 a[172:173], v135 offset:24576
    v_mfma_f32_16x16x32_bf16 v[96:99], a[176:179], a[8:11], v[96:99]
    ds_read_b64_tr_b16 a[174:175], v135 offset:28672
    v_mfma_f32_16x16x32_bf16 v[100:103], a[176:179], a[12:15], v[100:103]
    ds_read_b64_tr_b16 a[176:177], v132 offset:26624
    v_mfma_f32_16x16x32_bf16 v[104:107], a[180:183], a[8:11], v[104:107]
    ds_read_b64_tr_b16 a[178:179], v132 offset:30720
    v_mfma_f32_16x16x32_bf16 v[108:111], a[180:183], a[12:15], v[108:111]
    ds_read_b64_tr_b16 a[180:181], v133 offset:26624
    v_mfma_f32_16x16x32_bf16 v[112:115], a[184:187], a[8:11], v[112:115]
    ds_read_b64_tr_b16 a[182:183], v133 offset:30720
    s_waitcnt vmcnt(8)
    v_mfma_f32_16x16x32_bf16 v[116:119], a[184:187], a[12:15], v[116:119]
    ds_read_b64_tr_b16 a[184:185], v134 offset:26624
    v_mfma_f32_16x16x32_bf16 v[120:123], a[188:191], a[8:11], v[120:123]
    ds_read_b64_tr_b16 a[186:187], v134 offset:30720
    s_waitcnt lgkmcnt(14)
    v_mfma_f32_16x16x32_bf16 v[124:127], a[188:191], a[12:15], v[124:127]
    ds_read_b64_tr_b16 a[188:189], v135 offset:26624
    ds_read_b64_tr_b16 a[190:191], v135 offset:30720
    v_mfma_f32_16x16x32_bf16 v[64:67], a[128:131], a[16:19], v[64:67]
    s_barrier
    s_add_u32 m0, s66, 65536
    v_mfma_f32_16x16x32_bf16 v[68:71], a[128:131], a[20:23], v[68:71]
    ds_read_b64_tr_b16 a[128:129], v132 offset:32768
    v_mfma_f32_16x16x32_bf16 v[72:75], a[132:135], a[16:19], v[72:75]
    ds_read_b64_tr_b16 a[130:131], v132 offset:36864
    buffer_load_dwordx4 v40, s[36:39], s56 offen offset:0 lds
    v_mfma_f32_16x16x32_bf16 v[76:79], a[132:135], a[20:23], v[76:79]
    ds_read_b64_tr_b16 a[132:133], v133 offset:32768
    v_mfma_f32_16x16x32_bf16 v[80:83], a[136:139], a[16:19], v[80:83]
    ds_read_b64_tr_b16 a[134:135], v133 offset:36864
    v_mfma_f32_16x16x32_bf16 v[84:87], a[136:139], a[20:23], v[84:87]
    ds_read_b64_tr_b16 a[136:137], v134 offset:32768
    buffer_load_dwordx4 v41, s[36:39], s56 offen offset:1024 lds
    v_mfma_f32_16x16x32_bf16 v[88:91], a[140:143], a[16:19], v[88:91]
    ds_read_b64_tr_b16 a[138:139], v134 offset:36864
    v_mfma_f32_16x16x32_bf16 v[92:95], a[140:143], a[20:23], v[92:95]
    ds_read_b64_tr_b16 a[140:141], v135 offset:32768
    buffer_load_dwordx4 a[0:3], v1, s[32:35], s52 offen offset:0 sc1
    v_mfma_f32_16x16x32_bf16 v[96:99], a[144:147], a[16:19], v[96:99]
    ds_read_b64_tr_b16 a[142:143], v135 offset:36864
    v_mfma_f32_16x16x32_bf16 v[100:103], a[144:147], a[20:23], v[100:103]
    ds_read_b64_tr_b16 a[144:145], v132 offset:34816
    v_mfma_f32_16x16x32_bf16 v[104:107], a[148:151], a[16:19], v[104:107]
    ds_read_b64_tr_b16 a[146:147], v132 offset:38912
    buffer_load_dwordx4 a[4:7], v1, s[32:35], s52 offen offset:1024 sc1
    v_mfma_f32_16x16x32_bf16 v[108:111], a[148:151], a[20:23], v[108:111]
    ds_read_b64_tr_b16 a[148:149], v133 offset:34816
    v_mfma_f32_16x16x32_bf16 v[112:115], a[152:155], a[16:19], v[112:115]
    ds_read_b64_tr_b16 a[150:151], v133 offset:38912
    s_waitcnt vmcnt(24)
    v_mfma_f32_16x16x32_bf16 v[116:119], a[152:155], a[20:23], v[116:119]
    ds_read_b64_tr_b16 a[152:153], v134 offset:34816
    v_mfma_f32_16x16x32_bf16 v[120:123], a[156:159], a[16:19], v[120:123]
    ds_read_b64_tr_b16 a[154:155], v134 offset:38912
    s_waitcnt lgkmcnt(14)
    v_mfma_f32_16x16x32_bf16 v[124:127], a[156:159], a[20:23], v[124:127]
    ds_read_b64_tr_b16 a[156:157], v135 offset:34816
    ds_read_b64_tr_b16 a[158:159], v135 offset:38912
    v_mfma_f32_16x16x32_bf16 v[64:67], a[160:163], a[24:27], v[64:67]
    buffer_load_dwordx4 v42, s[36:39], s56 offen offset:2048 lds
    buffer_load_dwordx4 v43, s[36:39], s56 offen offset:3072 lds
    v_mfma_f32_16x16x32_bf16 v[68:71], a[160:163], a[28:31], v[68:71]
    ds_read_b64_tr_b16 a[160:161], v132 offset:40960
    v_mfma_f32_16x16x32_bf16 v[72:75], a[164:167], a[24:27], v[72:75]
    ds_read_b64_tr_b16 a[162:163], v132 offset:45056
    s_add_u32 s56, s56, 524288
    v_mfma_f32_16x16x32_bf16 v[76:79], a[164:167], a[28:31], v[76:79]
    ds_read_b64_tr_b16 a[164:165], v133 offset:40960
    v_mfma_f32_16x16x32_bf16 v[80:83], a[168:171], a[24:27], v[80:83]
    ds_read_b64_tr_b16 a[166:167], v133 offset:45056
    v_mfma_f32_16x16x32_bf16 v[84:87], a[168:171], a[28:31], v[84:87]
    ds_read_b64_tr_b16 a[168:169], v134 offset:40960
    buffer_load_dwordx4 a[8:11], v1, s[32:35], s52 offen offset:2048 sc1
    v_mfma_f32_16x16x32_bf16 v[88:91], a[172:175], a[24:27], v[88:91]
    ds_read_b64_tr_b16 a[170:171], v134 offset:45056
    v_mfma_f32_16x16x32_bf16 v[92:95], a[172:175], a[28:31], v[92:95]
    ds_read_b64_tr_b16 a[172:173], v135 offset:40960
    buffer_load_dwordx4 a[12:15], v1, s[32:35], s52 offen offset:3072 sc1
    v_mfma_f32_16x16x32_bf16 v[96:99], a[176:179], a[24:27], v[96:99]
    ds_read_b64_tr_b16 a[174:175], v135 offset:45056
    v_mfma_f32_16x16x32_bf16 v[100:103], a[176:179], a[28:31], v[100:103]
    ds_read_b64_tr_b16 a[176:177], v132 offset:43008
    v_mfma_f32_16x16x32_bf16 v[104:107], a[180:183], a[24:27], v[104:107]
    ds_read_b64_tr_b16 a[178:179], v132 offset:47104
    s_add_u32 s52, s52, 16384
    v_mfma_f32_16x16x32_bf16 v[108:111], a[180:183], a[28:31], v[108:111]
    ds_read_b64_tr_b16 a[180:181], v133 offset:43008
    v_mfma_f32_16x16x32_bf16 v[112:115], a[184:187], a[24:27], v[112:115]
    ds_read_b64_tr_b16 a[182:183], v133 offset:47104
    s_waitcnt vmcnt(12)
    v_mfma_f32_16x16x32_bf16 v[116:119], a[184:187], a[28:31], v[116:119]
    ds_read_b64_tr_b16 a[184:185], v134 offset:43008
    v_mfma_f32_16x16x32_bf16 v[120:123], a[188:191], a[24:27], v[120:123]
    ds_read_b64_tr_b16 a[186:187], v134 offset:47104
    s_waitcnt lgkmcnt(14)
    v_mfma_f32_16x16x32_bf16 v[124:127], a[188:191], a[28:31], v[124:127]
    ds_read_b64_tr_b16 a[188:189], v135 offset:43008
    ds_read_b64_tr_b16 a[190:191], v135 offset:47104
    v_mfma_f32_16x16x32_bf16 v[64:67], a[128:131], a[32:35], v[64:67]
    s_barrier
    s_add_u32 m0, s66, 81920
    v_mfma_f32_16x16x32_bf16 v[68:71], a[128:131], a[36:39], v[68:71]
    ds_read_b64_tr_b16 a[128:129], v132 offset:49152
    v_mfma_f32_16x16x32_bf16 v[72:75], a[132:135], a[32:35], v[72:75]
    ds_read_b64_tr_b16 a[130:131], v132 offset:53248
    buffer_load_dwordx4 v40, s[36:39], s57 offen offset:0 lds
    v_mfma_f32_16x16x32_bf16 v[76:79], a[132:135], a[36:39], v[76:79]
    ds_read_b64_tr_b16 a[132:133], v133 offset:49152
    v_mfma_f32_16x16x32_bf16 v[80:83], a[136:139], a[32:35], v[80:83]
    ds_read_b64_tr_b16 a[134:135], v133 offset:53248
    v_mfma_f32_16x16x32_bf16 v[84:87], a[136:139], a[36:39], v[84:87]
    ds_read_b64_tr_b16 a[136:137], v134 offset:49152
    buffer_load_dwordx4 v41, s[36:39], s57 offen offset:1024 lds
    v_mfma_f32_16x16x32_bf16 v[88:91], a[140:143], a[32:35], v[88:91]
    ds_read_b64_tr_b16 a[138:139], v134 offset:53248
    v_mfma_f32_16x16x32_bf16 v[92:95], a[140:143], a[36:39], v[92:95]
    ds_read_b64_tr_b16 a[140:141], v135 offset:49152
    buffer_load_dwordx4 a[16:19], v1, s[32:35], s53 offen offset:0 sc1
    v_mfma_f32_16x16x32_bf16 v[96:99], a[144:147], a[32:35], v[96:99]
    ds_read_b64_tr_b16 a[142:143], v135 offset:53248
    v_mfma_f32_16x16x32_bf16 v[100:103], a[144:147], a[36:39], v[100:103]
    ds_read_b64_tr_b16 a[144:145], v132 offset:51200
    v_mfma_f32_16x16x32_bf16 v[104:107], a[148:151], a[32:35], v[104:107]
    ds_read_b64_tr_b16 a[146:147], v132 offset:55296
    buffer_load_dwordx4 a[20:23], v1, s[32:35], s53 offen offset:1024 sc1
    v_mfma_f32_16x16x32_bf16 v[108:111], a[148:151], a[36:39], v[108:111]
    ds_read_b64_tr_b16 a[148:149], v133 offset:51200
    v_mfma_f32_16x16x32_bf16 v[112:115], a[152:155], a[32:35], v[112:115]
    ds_read_b64_tr_b16 a[150:151], v133 offset:55296
    s_waitcnt vmcnt(28)
    v_mfma_f32_16x16x32_bf16 v[116:119], a[152:155], a[36:39], v[116:119]
    ds_read_b64_tr_b16 a[152:153], v134 offset:51200
    v_mfma_f32_16x16x32_bf16 v[120:123], a[156:159], a[32:35], v[120:123]
    ds_read_b64_tr_b16 a[154:155], v134 offset:55296
    s_waitcnt lgkmcnt(14)
    v_mfma_f32_16x16x32_bf16 v[124:127], a[156:159], a[36:39], v[124:127]
    ds_read_b64_tr_b16 a[156:157], v135 offset:51200
    ds_read_b64_tr_b16 a[158:159], v135 offset:55296
    v_mfma_f32_16x16x32_bf16 v[64:67], a[160:163], a[40:43], v[64:67]
    buffer_load_dwordx4 v42, s[36:39], s57 offen offset:2048 lds
    buffer_load_dwordx4 v43, s[36:39], s57 offen offset:3072 lds
    v_mfma_f32_16x16x32_bf16 v[68:71], a[160:163], a[44:47], v[68:71]
    ds_read_b64_tr_b16 a[160:161], v132 offset:57344
    v_mfma_f32_16x16x32_bf16 v[72:75], a[164:167], a[40:43], v[72:75]
    ds_read_b64_tr_b16 a[162:163], v132 offset:61440
    s_add_u32 s57, s57, 524288
    v_mfma_f32_16x16x32_bf16 v[76:79], a[164:167], a[44:47], v[76:79]
    ds_read_b64_tr_b16 a[164:165], v133 offset:57344
    v_mfma_f32_16x16x32_bf16 v[80:83], a[168:171], a[40:43], v[80:83]
    ds_read_b64_tr_b16 a[166:167], v133 offset:61440
    v_mfma_f32_16x16x32_bf16 v[84:87], a[168:171], a[44:47], v[84:87]
    ds_read_b64_tr_b16 a[168:169], v134 offset:57344
    buffer_load_dwordx4 a[24:27], v1, s[32:35], s53 offen offset:2048 sc1
    v_mfma_f32_16x16x32_bf16 v[88:91], a[172:175], a[40:43], v[88:91]
    ds_read_b64_tr_b16 a[170:171], v134 offset:61440
    v_mfma_f32_16x16x32_bf16 v[92:95], a[172:175], a[44:47], v[92:95]
    ds_read_b64_tr_b16 a[172:173], v135 offset:57344
    buffer_load_dwordx4 a[28:31], v1, s[32:35], s53 offen offset:3072 sc1
    v_mfma_f32_16x16x32_bf16 v[96:99], a[176:179], a[40:43], v[96:99]
    ds_read_b64_tr_b16 a[174:175], v135 offset:61440
    v_mfma_f32_16x16x32_bf16 v[100:103], a[176:179], a[44:47], v[100:103]
    ds_read_b64_tr_b16 a[176:177], v132 offset:59392
    v_mfma_f32_16x16x32_bf16 v[104:107], a[180:183], a[40:43], v[104:107]
    ds_read_b64_tr_b16 a[178:179], v132 offset:63488
    s_add_u32 s53, s53, 16384
    v_mfma_f32_16x16x32_bf16 v[108:111], a[180:183], a[44:47], v[108:111]
    ds_read_b64_tr_b16 a[180:181], v133 offset:59392
    v_mfma_f32_16x16x32_bf16 v[112:115], a[184:187], a[40:43], v[112:115]
    ds_read_b64_tr_b16 a[182:183], v133 offset:63488
    s_waitcnt vmcnt(10)
    v_mfma_f32_16x16x32_bf16 v[116:119], a[184:187], a[44:47], v[116:119]
    ds_read_b64_tr_b16 a[184:185], v134 offset:59392
    v_mfma_f32_16x16x32_bf16 v[120:123], a[188:191], a[40:43], v[120:123]
    ds_read_b64_tr_b16 a[186:187], v134 offset:63488
    s_waitcnt lgkmcnt(14)
    v_mfma_f32_16x16x32_bf16 v[124:127], a[188:191], a[44:47], v[124:127]
    ds_read_b64_tr_b16 a[188:189], v135 offset:59392
    ds_read_b64_tr_b16 a[190:191], v135 offset:63488
    v_mfma_f32_16x16x32_bf16 v[64:67], a[128:131], a[48:51], v[64:67]
    s_barrier
    s_add_u32 m0, s66, 98304
    v_mfma_f32_16x16x32_bf16 v[68:71], a[128:131], a[52:55], v[68:71]
    ds_read_b64_tr_b16 a[128:129], v132 offset:0
    v_mfma_f32_16x16x32_bf16 v[72:75], a[132:135], a[48:51], v[72:75]
    ds_read_b64_tr_b16 a[130:131], v132 offset:4096
    buffer_load_dwordx4 v40, s[36:39], s58 offen offset:0 lds
    v_mfma_f32_16x16x32_bf16 v[76:79], a[132:135], a[52:55], v[76:79]
    ds_read_b64_tr_b16 a[132:133], v133 offset:0
    v_mfma_f32_16x16x32_bf16 v[80:83], a[136:139], a[48:51], v[80:83]
    ds_read_b64_tr_b16 a[134:135], v133 offset:4096
    v_mfma_f32_16x16x32_bf16 v[84:87], a[136:139], a[52:55], v[84:87]
    ds_read_b64_tr_b16 a[136:137], v134 offset:0
    buffer_load_dwordx4 v41, s[36:39], s58 offen offset:1024 lds
    v_mfma_f32_16x16x32_bf16 v[88:91], a[140:143], a[48:51], v[88:91]
    ds_read_b64_tr_b16 a[138:139], v134 offset:4096
    v_mfma_f32_16x16x32_bf16 v[92:95], a[140:143], a[52:55], v[92:95]
    ds_read_b64_tr_b16 a[140:141], v135 offset:0
    buffer_load_dwordx4 a[32:35], v1, s[32:35], s54 offen offset:0 sc1
    v_mfma_f32_16x16x32_bf16 v[96:99], a[144:147], a[48:51], v[96:99]
    ds_read_b64_tr_b16 a[142:143], v135 offset:4096
    v_mfma_f32_16x16x32_bf16 v[100:103], a[144:147], a[52:55], v[100:103]
    ds_read_b64_tr_b16 a[144:145], v132 offset:2048
    v_mfma_f32_16x16x32_bf16 v[104:107], a[148:151], a[48:51], v[104:107]
    ds_read_b64_tr_b16 a[146:147], v132 offset:6144
    buffer_load_dwordx4 a[36:39], v1, s[32:35], s54 offen offset:1024 sc1
    v_mfma_f32_16x16x32_bf16 v[108:111], a[148:151], a[52:55], v[108:111]
    ds_read_b64_tr_b16 a[148:149], v133 offset:2048
    v_mfma_f32_16x16x32_bf16 v[112:115], a[152:155], a[48:51], v[112:115]
    ds_read_b64_tr_b16 a[150:151], v133 offset:6144
    s_waitcnt vmcnt(32)
    v_mfma_f32_16x16x32_bf16 v[116:119], a[152:155], a[52:55], v[116:119]
    ds_read_b64_tr_b16 a[152:153], v134 offset:2048
    v_mfma_f32_16x16x32_bf16 v[120:123], a[156:159], a[48:51], v[120:123]
    ds_read_b64_tr_b16 a[154:155], v134 offset:6144
    s_waitcnt lgkmcnt(14)
    v_mfma_f32_16x16x32_bf16 v[124:127], a[156:159], a[52:55], v[124:127]
    ds_read_b64_tr_b16 a[156:157], v135 offset:2048
    ds_read_b64_tr_b16 a[158:159], v135 offset:6144
    v_mfma_f32_16x16x32_bf16 v[64:67], a[160:163], a[56:59], v[64:67]
    buffer_load_dwordx4 v42, s[36:39], s58 offen offset:2048 lds
    buffer_load_dwordx4 v43, s[36:39], s58 offen offset:3072 lds
    v_mfma_f32_16x16x32_bf16 v[68:71], a[160:163], a[60:63], v[68:71]
    ds_read_b64_tr_b16 a[160:161], v132 offset:8192
    v_mfma_f32_16x16x32_bf16 v[72:75], a[164:167], a[56:59], v[72:75]
    ds_read_b64_tr_b16 a[162:163], v132 offset:12288
    s_add_u32 s58, s58, 524288
    v_mfma_f32_16x16x32_bf16 v[76:79], a[164:167], a[60:63], v[76:79]
    ds_read_b64_tr_b16 a[164:165], v133 offset:8192
    v_mfma_f32_16x16x32_bf16 v[80:83], a[168:171], a[56:59], v[80:83]
    ds_read_b64_tr_b16 a[166:167], v133 offset:12288
    v_mfma_f32_16x16x32_bf16 v[84:87], a[168:171], a[60:63], v[84:87]
    ds_read_b64_tr_b16 a[168:169], v134 offset:8192
    buffer_load_dwordx4 a[40:43], v1, s[32:35], s54 offen offset:2048 sc1
    v_mfma_f32_16x16x32_bf16 v[88:91], a[172:175], a[56:59], v[88:91]
    ds_read_b64_tr_b16 a[170:171], v134 offset:12288
    v_mfma_f32_16x16x32_bf16 v[92:95], a[172:175], a[60:63], v[92:95]
    ds_read_b64_tr_b16 a[172:173], v135 offset:8192
    buffer_load_dwordx4 a[44:47], v1, s[32:35], s54 offen offset:3072 sc1
    v_mfma_f32_16x16x32_bf16 v[96:99], a[176:179], a[56:59], v[96:99]
    ds_read_b64_tr_b16 a[174:175], v135 offset:12288
    v_mfma_f32_16x16x32_bf16 v[100:103], a[176:179], a[60:63], v[100:103]
    ds_read_b64_tr_b16 a[176:177], v132 offset:10240
    v_mfma_f32_16x16x32_bf16 v[104:107], a[180:183], a[56:59], v[104:107]
    ds_read_b64_tr_b16 a[178:179], v132 offset:14336
    s_add_u32 s54, s54, 16384
    v_mfma_f32_16x16x32_bf16 v[108:111], a[180:183], a[60:63], v[108:111]
    ds_read_b64_tr_b16 a[180:181], v133 offset:10240
    v_mfma_f32_16x16x32_bf16 v[112:115], a[184:187], a[56:59], v[112:115]
    ds_read_b64_tr_b16 a[182:183], v133 offset:14336
    s_waitcnt vmcnt(10)
    v_mfma_f32_16x16x32_bf16 v[116:119], a[184:187], a[60:63], v[116:119]
    ds_read_b64_tr_b16 a[184:185], v134 offset:10240
    v_mfma_f32_16x16x32_bf16 v[120:123], a[188:191], a[56:59], v[120:123]
    ds_read_b64_tr_b16 a[186:187], v134 offset:14336
    s_waitcnt lgkmcnt(14)
    v_mfma_f32_16x16x32_bf16 v[124:127], a[188:191], a[60:63], v[124:127]
    ds_read_b64_tr_b16 a[188:189], v135 offset:10240
    ds_read_b64_tr_b16 a[190:191], v135 offset:14336
    s_waitcnt vmcnt(24)
    s_mov_b64 exec, 1
    buffer_store_dwordx2 v[44:45], v46, s[44:47], s91 offen sc1
    s_mov_b64 exec, -1
    s_mov_b32 s67, 4
    .p2align 6
L_g2_loop:
    v_mfma_f32_16x16x32_bf16 v[64:67], a[128:131], a[0:3], v[64:67]
    s_barrier
    s_add_u32 m0, s66, 114688
    v_mfma_f32_16x16x32_bf16 v[68:71], a[128:131], a[4:7], v[68:71]
    ds_read_b64_tr_b16 a[128:129], v132 offset:16384
    v_mfma_f32_16x16x32_bf16 v[72:75], a[132:135], a[0:3], v[72:75]
    ds_read_b64_tr_b16 a[130:131], v132 offset:20480
    buffer_load_dwordx4 v40, s[36:39], s59 offen offset:0 lds
    v_mfma_f32_16x16x32_bf16 v[76:79], a[132:135], a[4:7], v[76:79]
    ds_read_b64_tr_b16 a[132:133], v133 offset:16384
    v_mfma_f32_16x16x32_bf16 v[80:83], a[136:139], a[0:3], v[80:83]
    ds_read_b64_tr_b16 a[134:135], v133 offset:20480
    v_mfma_f32_16x16x32_bf16 v[84:87], a[136:139], a[4:7], v[84:87]
    ds_read_b64_tr_b16 a[136:137], v134 offset:16384
    buffer_load_dwordx4 v41, s[36:39], s59 offen offset:1024 lds
    v_mfma_f32_16x16x32_bf16 v[88:91], a[140:143], a[0:3], v[88:91]
    ds_read_b64_tr_b16 a[138:139], v134 offset:20480
    v_mfma_f32_16x16x32_bf16 v[92:95], a[140:143], a[4:7], v[92:95]
    ds_read_b64_tr_b16 a[140:141], v135 offset:16384
    buffer_load_dwordx4 a[48:51], v1, s[32:35], s55 offen offset:0 sc1
    v_mfma_f32_16x16x32_bf16 v[96:99], a[144:147], a[0:3], v[96:99]
    ds_read_b64_tr_b16 a[142:143], v135 offset:20480
    v_mfma_f32_16x16x32_bf16 v[100:103], a[144:147], a[4:7], v[100:103]
    ds_read_b64_tr_b16 a[144:145], v132 offset:18432
    v_mfma_f32_16x16x32_bf16 v[104:107], a[148:151], a[0:3], v[104:107]
    ds_read_b64_tr_b16 a[146:147], v132 offset:22528
    buffer_load_dwordx4 a[52:55], v1, s[32:35], s55 offen offset:1024 sc1
    v_mfma_f32_16x16x32_bf16 v[108:111], a[148:151], a[4:7], v[108:111]
    ds_read_b64_tr_b16 a[148:149], v133 offset:18432
    v_mfma_f32_16x16x32_bf16 v[112:115], a[152:155], a[0:3], v[112:115]
    ds_read_b64_tr_b16 a[150:151], v133 offset:22528
    s_waitcnt vmcnt(20)
    v_mfma_f32_16x16x32_bf16 v[116:119], a[152:155], a[4:7], v[116:119]
    ds_read_b64_tr_b16 a[152:153], v134 offset:18432
    v_mfma_f32_16x16x32_bf16 v[120:123], a[156:159], a[0:3], v[120:123]
    ds_read_b64_tr_b16 a[154:155], v134 offset:22528
    s_waitcnt lgkmcnt(14)
    v_mfma_f32_16x16x32_bf16 v[124:127], a[156:159], a[4:7], v[124:127]
    ds_read_b64_tr_b16 a[156:157], v135 offset:18432
    ds_read_b64_tr_b16 a[158:159], v135 offset:22528
    v_mfma_f32_16x16x32_bf16 v[64:67], a[160:163], a[8:11], v[64:67]
    buffer_load_dwordx4 v42, s[36:39], s59 offen offset:2048 lds
    buffer_load_dwordx4 v43, s[36:39], s59 offen offset:3072 lds
    v_mfma_f32_16x16x32_bf16 v[68:71], a[160:163], a[12:15], v[68:71]
    ds_read_b64_tr_b16 a[160:161], v132 offset:24576
    v_mfma_f32_16x16x32_bf16 v[72:75], a[164:167], a[8:11], v[72:75]
    ds_read_b64_tr_b16 a[162:163], v132 offset:28672
    s_add_u32 s59, s59, 524288
    v_mfma_f32_16x16x32_bf16 v[76:79], a[164:167], a[12:15], v[76:79]
    ds_read_b64_tr_b16 a[164:165], v133 offset:24576
    v_mfma_f32_16x16x32_bf16 v[80:83], a[168:171], a[8:11], v[80:83]
    ds_read_b64_tr_b16 a[166:167], v133 offset:28672
    v_mfma_f32_16x16x32_bf16 v[84:87], a[168:171], a[12:15], v[84:87]
    ds_read_b64_tr_b16 a[168:169], v134 offset:24576
    buffer_load_dwordx4 a[56:59], v1, s[32:35], s55 offen offset:2048 sc1
    v_mfma_f32_16x16x32_bf16 v[88:91], a[172:175], a[8:11], v[88:91]
    ds_read_b64_tr_b16 a[170:171], v134 offset:28672
    v_mfma_f32_16x16x32_bf16 v[92:95], a[172:175], a[12:15], v[92:95]
    ds_read_b64_tr_b16 a[172:173], v135 offset:24576
    buffer_load_dwordx4 a[60:63], v1, s[32:35], s55 offen offset:3072 sc1
    v_mfma_f32_16x16x32_bf16 v[96:99], a[176:179], a[8:11], v[96:99]
    ds_read_b64_tr_b16 a[174:175], v135 offset:28672
    v_mfma_f32_16x16x32_bf16 v[100:103], a[176:179], a[12:15], v[100:103]
    ds_read_b64_tr_b16 a[176:177], v132 offset:26624
    v_mfma_f32_16x16x32_bf16 v[104:107], a[180:183], a[8:11], v[104:107]
    ds_read_b64_tr_b16 a[178:179], v132 offset:30720
    s_add_u32 s55, s55, 16384
    v_mfma_f32_16x16x32_bf16 v[108:111], a[180:183], a[12:15], v[108:111]
    ds_read_b64_tr_b16 a[180:181], v133 offset:26624
    v_mfma_f32_16x16x32_bf16 v[112:115], a[184:187], a[8:11], v[112:115]
    ds_read_b64_tr_b16 a[182:183], v133 offset:30720
    s_waitcnt vmcnt(10)
    v_mfma_f32_16x16x32_bf16 v[116:119], a[184:187], a[12:15], v[116:119]
    ds_read_b64_tr_b16 a[184:185], v134 offset:26624
    v_mfma_f32_16x16x32_bf16 v[120:123], a[188:191], a[8:11], v[120:123]
    ds_read_b64_tr_b16 a[186:187], v134 offset:30720
    s_waitcnt lgkmcnt(14)
    v_mfma_f32_16x16x32_bf16 v[124:127], a[188:191], a[12:15], v[124:127]
    ds_read_b64_tr_b16 a[188:189], v135 offset:26624
    ds_read_b64_tr_b16 a[190:191], v135 offset:30720
    v_mfma_f32_16x16x32_bf16 v[64:67], a[128:131], a[16:19], v[64:67]
    s_barrier
    s_add_u32 m0, s66, 65536
    v_mfma_f32_16x16x32_bf16 v[68:71], a[128:131], a[20:23], v[68:71]
    ds_read_b64_tr_b16 a[128:129], v132 offset:32768
    v_mfma_f32_16x16x32_bf16 v[72:75], a[132:135], a[16:19], v[72:75]
    ds_read_b64_tr_b16 a[130:131], v132 offset:36864
    buffer_load_dwordx4 v40, s[36:39], s56 offen offset:0 lds
    v_mfma_f32_16x16x32_bf16 v[76:79], a[132:135], a[20:23], v[76:79]
    ds_read_b64_tr_b16 a[132:133], v133 offset:32768
    v_mfma_f32_16x16x32_bf16 v[80:83], a[136:139], a[16:19], v[80:83]
    ds_read_b64_tr_b16 a[134:135], v133 offset:36864
    v_mfma_f32_16x16x32_bf16 v[84:87], a[136:139], a[20:23], v[84:87]
    ds_read_b64_tr_b16 a[136:137], v134 offset:32768
    buffer_load_dwordx4 v41, s[36:39], s56 offen offset:1024 lds
    v_mfma_f32_16x16x32_bf16 v[88:91], a[140:143], a[16:19], v[88:91]
    ds_read_b64_tr_b16 a[138:139], v134 offset:36864
    v_mfma_f32_16x16x32_bf16 v[92:95], a[140:143], a[20:23], v[92:95]
    ds_read_b64_tr_b16 a[140:141], v135 offset:32768
    buffer_load_dwordx4 a[0:3], v1, s[32:35], s52 offen offset:0 sc1
    v_mfma_f32_16x16x32_bf16 v[96:99], a[144:147], a[16:19], v[96:99]
    ds_read_b64_tr_b16 a[142:143], v135 offset:36864
    v_mfma_f32_16x16x32_bf16 v[100:103], a[144:147], a[20:23], v[100:103]
    ds_read_b64_tr_b16 a[144:145], v132 offset:34816
    v_mfma_f32_16x16x32_bf16 v[104:107], a[148:151], a[16:19], v[104:107]
    ds_read_b64_tr_b16 a[146:147], v132 offset:38912
    buffer_load_dwordx4 a[4:7], v1, s[32:35], s52 offen offset:1024 sc1
    v_mfma_f32_16x16x32_bf16 v[108:111], a[148:151], a[20:23], v[108:111]
    ds_read_b64_tr_b16 a[148:149], v133 offset:34816
    v_mfma_f32_16x16x32_bf16 v[112:115], a[152:155], a[16:19], v[112:115]
    ds_read_b64_tr_b16 a[150:151], v133 offset:38912
    s_waitcnt vmcnt(20)
    v_mfma_f32_16x16x32_bf16 v[116:119], a[152:155], a[20:23], v[116:119]
    ds_read_b64_tr_b16 a[152:153], v134 offset:34816
    v_mfma_f32_16x16x32_bf16 v[120:123], a[156:159], a[16:19], v[120:123]
    ds_read_b64_tr_b16 a[154:155], v134 offset:38912
    s_waitcnt lgkmcnt(14)
    v_mfma_f32_16x16x32_bf16 v[124:127], a[156:159], a[20:23], v[124:127]
    ds_read_b64_tr_b16 a[156:157], v135 offset:34816
    ds_read_b64_tr_b16 a[158:159], v135 offset:38912
    v_mfma_f32_16x16x32_bf16 v[64:67], a[160:163], a[24:27], v[64:67]
    buffer_load_dwordx4 v42, s[36:39], s56 offen offset:2048 lds
    buffer_load_dwordx4 v43, s[36:39], s56 offen offset:3072 lds
    v_mfma_f32_16x16x32_bf16 v[68:71], a[160:163], a[28:31], v[68:71]
    ds_read_b64_tr_b16 a[160:161], v132 offset:40960
    v_mfma_f32_16x16x32_bf16 v[72:75], a[164:167], a[24:27], v[72:75]
    ds_read_b64_tr_b16 a[162:163], v132 offset:45056
    s_add_u32 s56, s56, 524288
    v_mfma_f32_16x16x32_bf16 v[76:79], a[164:167], a[28:31], v[76:79]
    ds_read_b64_tr_b16 a[164:165], v133 offset:40960
    v_mfma_f32_16x16x32_bf16 v[80:83], a[168:171], a[24:27], v[80:83]
    ds_read_b64_tr_b16 a[166:167], v133 offset:45056
    v_mfma_f32_16x16x32_bf16 v[84:87], a[168:171], a[28:31], v[84:87]
    ds_read_b64_tr_b16 a[168:169], v134 offset:40960
    buffer_load_dwordx4 a[8:11], v1, s[32:35], s52 offen offset:2048 sc1
    v_mfma_f32_16x16x32_bf16 v[88:91], a[172:175], a[24:27], v[88:91]
    ds_read_b64_tr_b16 a[170:171], v134 offset:45056
    v_mfma_f32_16x16x32_bf16 v[92:95], a[172:175], a[28:31], v[92:95]
    ds_read_b64_tr_b16 a[172:173], v135 offset:40960
    buffer_load_dwordx4 a[12:15], v1, s[32:35], s52 offen offset:3072 sc1
    v_mfma_f32_16x16x32_bf16 v[96:99], a[176:179], a[24:27], v[96:99]
    ds_read_b64_tr_b16 a[174:175], v135 offset:45056
    v_mfma_f32_16x16x32_bf16 v[100:103], a[176:179], a[28:31], v[100:103]
    ds_read_b64_tr_b16 a[176:177], v132 offset:43008
    v_mfma_f32_16x16x32_bf16 v[104:107], a[180:183], a[24:27], v[104:107]
    ds_read_b64_tr_b16 a[178:179], v132 offset:47104
    s_add_u32 s52, s52, 16384
    v_mfma_f32_16x16x32_bf16 v[108:111], a[180:183], a[28:31], v[108:111]
    ds_read_b64_tr_b16 a[180:181], v133 offset:43008
    v_mfma_f32_16x16x32_bf16 v[112:115], a[184:187], a[24:27], v[112:115]
    ds_read_b64_tr_b16 a[182:183], v133 offset:47104
    s_waitcnt vmcnt(10)
    v_mfma_f32_16x16x32_bf16 v[116:119], a[184:187], a[28:31], v[116:119]
    ds_read_b64_tr_b16 a[184:185], v134 offset:43008
    v_mfma_f32_16x16x32_bf16 v[120:123], a[188:191], a[24:27], v[120:123]
    ds_read_b64_tr_b16 a[186:187], v134 offset:47104
    s_waitcnt lgkmcnt(14)
    v_mfma_f32_16x16x32_bf16 v[124:127], a[188:191], a[28:31], v[124:127]
    ds_read_b64_tr_b16 a[188:189], v135 offset:43008
    ds_read_b64_tr_b16 a[190:191], v135 offset:47104
    v_mfma_f32_16x16x32_bf16 v[64:67], a[128:131], a[32:35], v[64:67]
    s_barrier
    s_add_u32 m0, s66, 81920
    v_mfma_f32_16x16x32_bf16 v[68:71], a[128:131], a[36:39], v[68:71]
    ds_read_b64_tr_b16 a[128:129], v132 offset:49152
    v_mfma_f32_16x16x32_bf16 v[72:75], a[132:135], a[32:35], v[72:75]
    ds_read_b64_tr_b16 a[130:131], v132 offset:53248
    buffer_load_dwordx4 v40, s[36:39], s57 offen offset:0 lds
    v_mfma_f32_16x16x32_bf16 v[76:79], a[132:135], a[36:39], v[76:79]
    ds_read_b64_tr_b16 a[132:133], v133 offset:49152
    v_mfma_f32_16x16x32_bf16 v[80:83], a[136:139], a[32:35], v[80:83]
    ds_read_b64_tr_b16 a[134:135], v133 offset:53248
    v_mfma_f32_16x16x32_bf16 v[84:87], a[136:139], a[36:39], v[84:87]
    ds_read_b64_tr_b16 a[136:137], v134 offset:49152
    buffer_load_dwordx4 v41, s[36:39], s57 offen offset:1024 lds
    v_mfma_f32_16x16x32_bf16 v[88:91], a[140:143], a[32:35], v[88:91]
    ds_read_b64_tr_b16 a[138:139], v134 offset:53248
    v_mfma_f32_16x16x32_bf16 v[92:95], a[140:143], a[36:39], v[92:95]
    ds_read_b64_tr_b16 a[140:141], v135 offset:49152
    buffer_load_dwordx4 a[16:19], v1, s[32:35], s53 offen offset:0 sc1
    v_mfma_f32_16x16x32_bf16 v[96:99], a[144:147], a[32:35], v[96:99]
    ds_read_b64_tr_b16 a[142:143], v135 offset:53248
    v_mfma_f32_16x16x32_bf16 v[100:103], a[144:147], a[36:39], v[100:103]
    ds_read_b64_tr_b16 a[144:145], v132 offset:51200
    v_mfma_f32_16x16x32_bf16 v[104:107], a[148:151], a[32:35], v[104:107]
    ds_read_b64_tr_b16 a[146:147], v132 offset:55296
    buffer_load_dwordx4 a[20:23], v1, s[32:35], s53 offen offset:1024 sc1
    v_mfma_f32_16x16x32_bf16 v[108:111], a[148:151], a[36:39], v[108:111]
    ds_read_b64_tr_b16 a[148:149], v133 offset:51200
    v_mfma_f32_16x16x32_bf16 v[112:115], a[152:155], a[32:35], v[112:115]
    ds_read_b64_tr_b16 a[150:151], v133 offset:55296
    s_waitcnt vmcnt(20)
    v_mfma_f32_16x16x32_bf16 v[116:119], a[152:155], a[36:39], v[116:119]
    ds_read_b64_tr_b16 a[152:153], v134 offset:51200
    v_mfma_f32_16x16x32_bf16 v[120:123], a[156:159], a[32:35], v[120:123]
    ds_read_b64_tr_b16 a[154:155], v134 offset:55296
    s_waitcnt lgkmcnt(14)
    v_mfma_f32_16x16x32_bf16 v[124:127], a[156:159], a[36:39], v[124:127]
    ds_read_b64_tr_b16 a[156:157], v135 offset:51200
    ds_read_b64_tr_b16 a[158:159], v135 offset:55296
    v_mfma_f32_16x16x32_bf16 v[64:67], a[160:163], a[40:43], v[64:67]
    buffer_load_dwordx4 v42, s[36:39], s57 offen offset:2048 lds
    buffer_load_dwordx4 v43, s[36:39], s57 offen offset:3072 lds
    v_mfma_f32_16x16x32_bf16 v[68:71], a[160:163], a[44:47], v[68:71]
    ds_read_b64_tr_b16 a[160:161], v132 offset:57344
    v_mfma_f32_16x16x32_bf16 v[72:75], a[164:167], a[40:43], v[72:75]
    ds_read_b64_tr_b16 a[162:163], v132 offset:61440
    s_add_u32 s57, s57, 524288
    v_mfma_f32_16x16x32_bf16 v[76:79], a[164:167], a[44:47], v[76:79]
    ds_read_b64_tr_b16 a[164:165], v133 offset:57344
    v_mfma_f32_16x16x32_bf16 v[80:83], a[168:171], a[40:43], v[80:83]
    ds_read_b64_tr_b16 a[166:167], v133 offset:61440
    v_mfma_f32_16x16x32_bf16 v[84:87], a[168:171], a[44:47], v[84:87]
    ds_read_b64_tr_b16 a[168:169], v134 offset:57344
    buffer_load_dwordx4 a[24:27], v1, s[32:35], s53 offen offset:2048 sc1
    v_mfma_f32_16x16x32_bf16 v[88:91], a[172:175], a[40:43], v[88:91]
    ds_read_b64_tr_b16 a[170:171], v134 offset:61440
    v_mfma_f32_16x16x32_bf16 v[92:95], a[172:175], a[44:47], v[92:95]
    ds_read_b64_tr_b16 a[172:173], v135 offset:57344
    buffer_load_dwordx4 a[28:31], v1, s[32:35], s53 offen offset:3072 sc1
    v_mfma_f32_16x16x32_bf16 v[96:99], a[176:179], a[40:43], v[96:99]
    ds_read_b64_tr_b16 a[174:175], v135 offset:61440
    v_mfma_f32_16x16x32_bf16 v[100:103], a[176:179], a[44:47], v[100:103]
    ds_read_b64_tr_b16 a[176:177], v132 offset:59392
    v_mfma_f32_16x16x32_bf16 v[104:107], a[180:183], a[40:43], v[104:107]
    ds_read_b64_tr_b16 a[178:179], v132 offset:63488
    s_add_u32 s53, s53, 16384
    v_mfma_f32_16x16x32_bf16 v[108:111], a[180:183], a[44:47], v[108:111]
    ds_read_b64_tr_b16 a[180:181], v133 offset:59392
    v_mfma_f32_16x16x32_bf16 v[112:115], a[184:187], a[40:43], v[112:115]
    ds_read_b64_tr_b16 a[182:183], v133 offset:63488
    s_waitcnt vmcnt(10)
    v_mfma_f32_16x16x32_bf16 v[116:119], a[184:187], a[44:47], v[116:119]
    ds_read_b64_tr_b16 a[184:185], v134 offset:59392
    v_mfma_f32_16x16x32_bf16 v[120:123], a[188:191], a[40:43], v[120:123]
    ds_read_b64_tr_b16 a[186:187], v134 offset:63488
    s_waitcnt lgkmcnt(14)
    v_mfma_f32_16x16x32_bf16 v[124:127], a[188:191], a[44:47], v[124:127]
    ds_read_b64_tr_b16 a[188:189], v135 offset:59392
    ds_read_b64_tr_b16 a[190:191], v135 offset:63488
    v_mfma_f32_16x16x32_bf16 v[64:67], a[128:131], a[48:51], v[64:67]
    s_barrier
    s_add_u32 m0, s66, 98304
    v_mfma_f32_16x16x32_bf16 v[68:71], a[128:131], a[52:55], v[68:71]
    ds_read_b64_tr_b16 a[128:129], v132 offset:0
    v_mfma_f32_16x16x32_bf16 v[72:75], a[132:135], a[48:51], v[72:75]
    ds_read_b64_tr_b16 a[130:131], v132 offset:4096
    buffer_load_dwordx4 v40, s[36:39], s58 offen offset:0 lds
    v_mfma_f32_16x16x32_bf16 v[76:79], a[132:135], a[52:55], v[76:79]
    ds_read_b64_tr_b16 a[132:133], v133 offset:0
    v_mfma_f32_16x16x32_bf16 v[80:83], a[136:139], a[48:51], v[80:83]
    ds_read_b64_tr_b16 a[134:135], v133 offset:4096
    v_mfma_f32_16x16x32_bf16 v[84:87], a[136:139], a[52:55], v[84:87]
    ds_read_b64_tr_b16 a[136:137], v134 offset:0
    buffer_load_dwordx4 v41, s[36:39], s58 offen offset:1024 lds
    v_mfma_f32_16x16x32_bf16 v[88:91], a[140:143], a[48:51], v[88:91]
    ds_read_b64_tr_b16 a[138:139], v134 offset:4096
    v_mfma_f32_16x16x32_bf16 v[92:95], a[140:143], a[52:55], v[92:95]
    ds_read_b64_tr_b16 a[140:141], v135 offset:0
    buffer_load_dwordx4 a[32:35], v1, s[32:35], s54 offen offset:0 sc1
    v_mfma_f32_16x16x32_bf16 v[96:99], a[144:147], a[48:51], v[96:99]
    ds_read_b64_tr_b16 a[142:143], v135 offset:4096
    v_mfma_f32_16x16x32_bf16 v[100:103], a[144:147], a[52:55], v[100:103]
    ds_read_b64_tr_b16 a[144:145], v132 offset:2048
    v_mfma_f32_16x16x32_bf16 v[104:107], a[148:151], a[48:51], v[104:107]
    ds_read_b64_tr_b16 a[146:147], v132 offset:6144
    buffer_load_dwordx4 a[36:39], v1, s[32:35], s54 offen offset:1024 sc1
    v_mfma_f32_16x16x32_bf16 v[108:111], a[148:151], a[52:55], v[108:111]
    ds_read_b64_tr_b16 a[148:149], v133 offset:2048
    v_mfma_f32_16x16x32_bf16 v[112:115], a[152:155], a[48:51], v[112:115]
    ds_read_b64_tr_b16 a[150:151], v133 offset:6144
    s_waitcnt vmcnt(20)
    v_mfma_f32_16x16x32_bf16 v[116:119], a[152:155], a[52:55], v[116:119]
    ds_read_b64_tr_b16 a[152:153], v134 offset:2048
    v_mfma_f32_16x16x32_bf16 v[120:123], a[156:159], a[48:51], v[120:123]
    ds_read_b64_tr_b16 a[154:155], v134 offset:6144
    s_waitcnt lgkmcnt(14)
    v_mfma_f32_16x16x32_bf16 v[124:127], a[156:159], a[52:55], v[124:127]
    ds_read_b64_tr_b16 a[156:157], v135 offset:2048
    ds_read_b64_tr_b16 a[158:159], v135 offset:6144
    v_mfma_f32_16x16x32_bf16 v[64:67], a[160:163], a[56:59], v[64:67]
    buffer_load_dwordx4 v42, s[36:39], s58 offen offset:2048 lds
    buffer_load_dwordx4 v43, s[36:39], s58 offen offset:3072 lds
    v_mfma_f32_16x16x32_bf16 v[68:71], a[160:163], a[60:63], v[68:71]
    ds_read_b64_tr_b16 a[160:161], v132 offset:8192
    v_mfma_f32_16x16x32_bf16 v[72:75], a[164:167], a[56:59], v[72:75]
    ds_read_b64_tr_b16 a[162:163], v132 offset:12288
    s_add_u32 s58, s58, 524288
    v_mfma_f32_16x16x32_bf16 v[76:79], a[164:167], a[60:63], v[76:79]
    ds_read_b64_tr_b16 a[164:165], v133 offset:8192
    v_mfma_f32_16x16x32_bf16 v[80:83], a[168:171], a[56:59], v[80:83]
    ds_read_b64_tr_b16 a[166:167], v133 offset:12288
    v_mfma_f32_16x16x32_bf16 v[84:87], a[168:171], a[60:63], v[84:87]
    ds_read_b64_tr_b16 a[168:169], v134 offset:8192
    buffer_load_dwordx4 a[40:43], v1, s[32:35], s54 offen offset:2048 sc1
    v_mfma_f32_16x16x32_bf16 v[88:91], a[172:175], a[56:59], v[88:91]
    ds_read_b64_tr_b16 a[170:171], v134 offset:12288
    v_mfma_f32_16x16x32_bf16 v[92:95], a[172:175], a[60:63], v[92:95]
    ds_read_b64_tr_b16 a[172:173], v135 offset:8192
    buffer_load_dwordx4 a[44:47], v1, s[32:35], s54 offen offset:3072 sc1
    v_mfma_f32_16x16x32_bf16 v[96:99], a[176:179], a[56:59], v[96:99]
    ds_read_b64_tr_b16 a[174:175], v135 offset:12288
    v_mfma_f32_16x16x32_bf16 v[100:103], a[176:179], a[60:63], v[100:103]
    ds_read_b64_tr_b16 a[176:177], v132 offset:10240
    v_mfma_f32_16x16x32_bf16 v[104:107], a[180:183], a[56:59], v[104:107]
    ds_read_b64_tr_b16 a[178:179], v132 offset:14336
    s_add_u32 s54, s54, 16384
    v_mfma_f32_16x16x32_bf16 v[108:111], a[180:183], a[60:63], v[108:111]
    ds_read_b64_tr_b16 a[180:181], v133 offset:10240
    v_mfma_f32_16x16x32_bf16 v[112:115], a[184:187], a[56:59], v[112:115]
    ds_read_b64_tr_b16 a[182:183], v133 offset:14336
    s_waitcnt vmcnt(10)
    v_mfma_f32_16x16x32_bf16 v[116:119], a[184:187], a[60:63], v[116:119]
    ds_read_b64_tr_b16 a[184:185], v134 offset:10240
    v_mfma_f32_16x16x32_bf16 v[120:123], a[188:191], a[56:59], v[120:123]
    ds_read_b64_tr_b16 a[186:187], v134 offset:14336
    s_waitcnt lgkmcnt(14)
    v_mfma_f32_16x16x32_bf16 v[124:127], a[188:191], a[60:63], v[124:127]
    ds_read_b64_tr_b16 a[188:189], v135 offset:10240
    ds_read_b64_tr_b16 a[190:191], v135 offset:14336
    s_sub_u32 s67, s67, 1
    s_cmp_lg_u32 s67, 0
    s_cbranch_scc1 L_g2_loop
    v_mfma_f32_16x16x32_bf16 v[64:67], a[128:131], a[0:3], v[64:67]
    s_barrier
    s_mov_b32 s48, s4
    s_and_b32 s49, s5, 0xffff
    v_mfma_f32_16x16x32_bf16 v[68:71], a[128:131], a[4:7], v[68:71]
    ds_read_b64_tr_b16 a[128:129], v132 offset:16384
    s_mov_b32 s50, 4194304
    v_mfma_f32_16x16x32_bf16 v[72:75], a[132:135], a[0:3], v[72:75]
    ds_read_b64_tr_b16 a[130:131], v132 offset:20480
    s_mov_b32 s51, 0x20000
    v_mfma_f32_16x16x32_bf16 v[76:79], a[132:135], a[4:7], v[76:79]
    ds_read_b64_tr_b16 a[132:133], v133 offset:16384
    s_add_u32 s31, s30, 0
    v_mfma_f32_16x16x32_bf16 v[80:83], a[136:139], a[0:3], v[80:83]
    ds_read_b64_tr_b16 a[134:135], v133 offset:20480
    buffer_load_dwordx4 v[16:19], v140, s[48:51], s31 offen
    s_add_u32 s31, s30, 16384
    v_mfma_f32_16x16x32_bf16 v[84:87], a[136:139], a[4:7], v[84:87]
    ds_read_b64_tr_b16 a[136:137], v134 offset:16384
    buffer_load_dwordx4 v[20:23], v140, s[48:51], s31 offen
    v_mfma_f32_16x16x32_bf16 v[88:91], a[140:143], a[0:3], v[88:91]
    ds_read_b64_tr_b16 a[138:139], v134 offset:20480
    s_add_u32 s31, s30, 32768
    v_mfma_f32_16x16x32_bf16 v[92:95], a[140:143], a[4:7], v[92:95]
    ds_read_b64_tr_b16 a[140:141], v135 offset:16384
    buffer_load_dwordx4 v[24:27], v140, s[48:51], s31 offen
    v_mfma_f32_16x16x32_bf16 v[96:99], a[144:147], a[0:3], v[96:99]
    ds_read_b64_tr_b16 a[142:143], v135 offset:20480
    s_add_u32 s31, s30, 49152
    buffer_load_dwordx4 v[28:31], v140, s[48:51], s31 offen
    v_mfma_f32_16x16x32_bf16 v[100:103], a[144:147], a[4:7], v[100:103]
    ds_read_b64_tr_b16 a[144:145], v132 offset:18432
    s_add_u32 m0, s66, 114688
    v_mfma_f32_16x16x32_bf16 v[104:107], a[148:151], a[0:3], v[104:107]
    ds_read_b64_tr_b16 a[146:147], v132 offset:22528
    buffer_load_dwordx4 v40, s[36:39], s59 offen offset:0 lds
    v_mfma_f32_16x16x32_bf16 v[108:111], a[148:151], a[4:7], v[108:111]
    ds_read_b64_tr_b16 a[148:149], v133 offset:18432
    buffer_load_dwordx4 v41, s[36:39], s59 offen offset:1024 lds
    v_mfma_f32_16x16x32_bf16 v[112:115], a[152:155], a[0:3], v[112:115]
    ds_read_b64_tr_b16 a[150:151], v133 offset:22528
    s_waitcnt vmcnt(22)
    buffer_load_dwordx4 a[48:51], v1, s[32:35], s55 offen offset:0 sc1
    v_mfma_f32_16x16x32_bf16 v[116:119], a[152:155], a[4:7], v[116:119]
    ds_read_b64_tr_b16 a[152:153], v134 offset:18432
    buffer_load_dwordx4 a[52:55], v1, s[32:35], s55 offen offset:1024 sc1
    v_mfma_f32_16x16x32_bf16 v[120:123], a[156:159], a[0:3], v[120:123]
    ds_read_b64_tr_b16 a[154:155], v134 offset:22528
    s_waitcnt lgkmcnt(14)
    v_mfma_f32_16x16x32_bf16 v[124:127], a[156:159], a[4:7], v[124:127]
    ds_read_b64_tr_b16 a[156:157], v135 offset:18432
    ds_read_b64_tr_b16 a[158:159], v135 offset:22528
    v_mfma_f32_16x16x32_bf16 v[64:67], a[160:163], a[8:11], v[64:67]
    buffer_load_dwordx4 v42, s[36:39], s59 offen offset:2048 lds
    buffer_load_dwordx4 v43, s[36:39], s59 offen offset:3072 lds
    v_mfma_f32_16x16x32_bf16 v[68:71], a[160:163], a[12:15], v[68:71]
    ds_read_b64_tr_b16 a[160:161], v132 offset:24576
    v_mfma_f32_16x16x32_bf16 v[72:75], a[164:167], a[8:11], v[72:75]
    ds_read_b64_tr_b16 a[162:163], v132 offset:28672
    s_add_u32 s59, s59, 524288
    v_mfma_f32_16x16x32_bf16 v[76:79], a[164:167], a[12:15], v[76:79]
    ds_read_b64_tr_b16 a[164:165], v133 offset:24576
    v_mfma_f32_16x16x32_bf16 v[80:83], a[168:171], a[8:11], v[80:83]
    ds_read_b64_tr_b16 a[166:167], v133 offset:28672
    v_mfma_f32_16x16x32_bf16 v[84:87], a[168:171], a[12:15], v[84:87]
    ds_read_b64_tr_b16 a[168:169], v134 offset:24576
    buffer_load_dwordx4 a[56:59], v1, s[32:35], s55 offen offset:2048 sc1
    v_mfma_f32_16x16x32_bf16 v[88:91], a[172:175], a[8:11], v[88:91]
    ds_read_b64_tr_b16 a[170:171], v134 offset:28672
    v_mfma_f32_16x16x32_bf16 v[92:95], a[172:175], a[12:15], v[92:95]
    ds_read_b64_tr_b16 a[172:173], v135 offset:24576
    buffer_load_dwordx4 a[60:63], v1, s[32:35], s55 offen offset:3072 sc1
    v_mfma_f32_16x16x32_bf16 v[96:99], a[176:179], a[8:11], v[96:99]
    ds_read_b64_tr_b16 a[174:175], v135 offset:28672
    v_mfma_f32_16x16x32_bf16 v[100:103], a[176:179], a[12:15], v[100:103]
    ds_read_b64_tr_b16 a[176:177], v132 offset:26624
    v_mfma_f32_16x16x32_bf16 v[104:107], a[180:183], a[8:11], v[104:107]
    ds_read_b64_tr_b16 a[178:179], v132 offset:30720
    s_add_u32 s55, s55, 16384
    v_mfma_f32_16x16x32_bf16 v[108:111], a[180:183], a[12:15], v[108:111]
    ds_read_b64_tr_b16 a[180:181], v133 offset:26624
    v_mfma_f32_16x16x32_bf16 v[112:115], a[184:187], a[8:11], v[112:115]
    ds_read_b64_tr_b16 a[182:183], v133 offset:30720
    s_waitcnt vmcnt(14)
    v_mfma_f32_16x16x32_bf16 v[116:119], a[184:187], a[12:15], v[116:119]
    ds_read_b64_tr_b16 a[184:185], v134 offset:26624
    v_mfma_f32_16x16x32_bf16 v[120:123], a[188:191], a[8:11], v[120:123]
    ds_read_b64_tr_b16 a[186:187], v134 offset:30720
    s_waitcnt lgkmcnt(14)
    v_mfma_f32_16x16x32_bf16 v[124:127], a[188:191], a[12:15], v[124:127]
    ds_read_b64_tr_b16 a[188:189], v135 offset:26624
    ds_read_b64_tr_b16 a[190:191], v135 offset:30720
    v_mfma_f32_16x16x32_bf16 v[64:67], a[128:131], a[16:19], v[64:67]
    s_barrier
    s_add_u32 m0, s66, 65536
    v_mfma_f32_16x16x32_bf16 v[68:71], a[128:131], a[20:23], v[68:71]
    ds_read_b64_tr_b16 a[128:129], v132 offset:32768
    v_mfma_f32_16x16x32_bf16 v[72:75], a[132:135], a[16:19], v[72:75]
    ds_read_b64_tr_b16 a[130:131], v132 offset:36864
    buffer_load_dwordx4 v40, s[36:39], s56 offen offset:0 lds
    v_mfma_f32_16x16x32_bf16 v[76:79], a[132:135], a[20:23], v[76:79]
    ds_read_b64_tr_b16 a[132:133], v133 offset:32768
    v_mfma_f32_16x16x32_bf16 v[80:83], a[136:139], a[16:19], v[80:83]
    ds_read_b64_tr_b16 a[134:135], v133 offset:36864
    v_mfma_f32_16x16x32_bf16 v[84:87], a[136:139], a[20:23], v[84:87]
    ds_read_b64_tr_b16 a[136:137], v134 offset:32768
    buffer_load_dwordx4 v41, s[36:39], s56 offen offset:1024 lds
    v_mfma_f32_16x16x32_bf16 v[88:91], a[140:143], a[16:19], v[88:91]
    ds_read_b64_tr_b16 a[138:139], v134 offset:36864
    v_mfma_f32_16x16x32_bf16 v[92:95], a[140:143], a[20:23], v[92:95]
    ds_read_b64_tr_b16 a[140:141], v135 offset:32768
    buffer_load_dwordx4 a[0:3], v1, s[32:35], s52 offen offset:0 sc1
    v_mfma_f32_16x16x32_bf16 v[96:99], a[144:147], a[16:19], v[96:99]
    ds_read_b64_tr_b16 a[142:143], v135 offset:36864
    v_mfma_f32_16x16x32_bf16 v[100:103], a[144:147], a[20:23], v[100:103]
    ds_read_b64_tr_b16 a[144:145], v132 offset:34816
    v_mfma_f32_16x16x32_bf16 v[104:107], a[148:151], a[16:19], v[104:107]
    ds_read_b64_tr_b16 a[146:147], v132 offset:38912
    buffer_load_dwordx4 a[4:7], v1, s[32:35], s52 offen offset:1024 sc1
    v_mfma_f32_16x16x32_bf16 v[108:111], a[148:151], a[20:23], v[108:111]
    ds_read_b64_tr_b16 a[148:149], v133 offset:34816
    v_mfma_f32_16x16x32_bf16 v[112:115], a[152:155], a[16:19], v[112:115]
    ds_read_b64_tr_b16 a[150:151], v133 offset:38912
    s_waitcnt vmcnt(24)
    v_mfma_f32_16x16x32_bf16 v[116:119], a[152:155], a[20:23], v[116:119]
    ds_read_b64_tr_b16 a[152:153], v134 offset:34816
    v_mfma_f32_16x16x32_bf16 v[120:123], a[156:159], a[16:19], v[120:123]
    ds_read_b64_tr_b16 a[154:155], v134 offset:38912
    s_waitcnt lgkmcnt(14)
    v_mfma_f32_16x16x32_bf16 v[124:127], a[156:159], a[20:23], v[124:127]
    ds_read_b64_tr_b16 a[156:157], v135 offset:34816
    ds_read_b64_tr_b16 a[158:159], v135 offset:38912
    v_mfma_f32_16x16x32_bf16 v[64:67], a[160:163], a[24:27], v[64:67]
    v_and_b32 v142, 15, v0
    v_lshlrev_b32 v142, 6, v142
    v_lshl_add_u32 v142, v141, 1, v142
    v_mfma_f32_16x16x32_bf16 v[68:71], a[160:163], a[28:31], v[68:71]
    ds_read_b64_tr_b16 a[160:161], v132 offset:40960
    v_lshrrev_b32 v143, 3, v0
    v_mfma_f32_16x16x32_bf16 v[72:75], a[164:167], a[24:27], v[72:75]
    ds_read_b64_tr_b16 a[162:163], v132 offset:45056
    v_lshlrev_b32 v143, 6, v143
    v_mfma_f32_16x16x32_bf16 v[76:79], a[164:167], a[28:31], v[76:79]
    ds_read_b64_tr_b16 a[164:165], v133 offset:40960
    v_and_b32 v2, 3, v0
    v_mfma_f32_16x16x32_bf16 v[80:83], a[168:171], a[24:27], v[80:83]
    ds_read_b64_tr_b16 a[166:167], v133 offset:45056
    v_lshl_add_u32 v143, v2, 4, v143
    v_mfma_f32_16x16x32_bf16 v[84:87], a[168:171], a[28:31], v[84:87]
    ds_read_b64_tr_b16 a[168:169], v134 offset:40960
    v_bfe_u32 v2, v0, 2, 1
    v_mfma_f32_16x16x32_bf16 v[88:91], a[172:175], a[24:27], v[88:91]
    ds_read_b64_tr_b16 a[170:171], v134 offset:45056
    v_lshl_add_u32 v143, v2, 10, v143
    v_mfma_f32_16x16x32_bf16 v[92:95], a[172:175], a[28:31], v[92:95]
    ds_read_b64_tr_b16 a[172:173], v135 offset:40960
    buffer_load_dwordx4 v42, s[36:39], s56 offen offset:2048 lds
    v_mfma_f32_16x16x32_bf16 v[96:99], a[176:179], a[24:27], v[96:99]
    ds_read_b64_tr_b16 a[174:175], v135 offset:45056
    buffer_load_dwordx4 v43, s[36:39], s56 offen offset:3072 lds
    v_mfma_f32_16x16x32_bf16 v[100:103], a[176:179], a[28:31], v[100:103]
    ds_read_b64_tr_b16 a[176:177], v132 offset:43008
    s_add_u32 s56, s56, 524288
    v_mfma_f32_16x16x32_bf16 v[104:107], a[180:183], a[24:27], v[104:107]
    ds_read_b64_tr_b16 a[178:179], v132 offset:47104
    buffer_load_dwordx4 a[8:11], v1, s[32:35], s52 offen offset:2048 sc1
    v_mfma_f32_16x16x32_bf16 v[108:111], a[180:183], a[28:31], v[108:111]
    ds_read_b64_tr_b16 a[180:181], v133 offset:43008
    buffer_load_dwordx4 a[12:15], v1, s[32:35], s52 offen offset:3072 sc1
    v_mfma_f32_16x16x32_bf16 v[112:115], a[184:187], a[24:27], v[112:115]
    ds_read_b64_tr_b16 a[182:183], v133 offset:47104
    s_waitcnt vmcnt(10)
    v_mfma_f32_16x16x32_bf16 v[116:119], a[184:187], a[28:31], v[116:119]
    ds_read_b64_tr_b16 a[184:185], v134 offset:43008
    s_add_u32 s52, s52, 16384
    v_mfma_f32_16x16x32_bf16 v[120:123], a[188:191], a[24:27], v[120:123]
    ds_read_b64_tr_b16 a[186:187], v134 offset:47104
    s_waitcnt lgkmcnt(14)
    v_mfma_f32_16x16x32_bf16 v[124:127], a[188:191], a[28:31], v[124:127]
    ds_read_b64_tr_b16 a[188:189], v135 offset:43008
    ds_read_b64_tr_b16 a[190:191], v135 offset:47104
    buffer_load_dwordx2 v[10:11], v39, s[44:47], s94 offen sc1
    v_mfma_f32_16x16x32_bf16 v[64:67], a[128:131], a[32:35], v[64:67]
    s_barrier
    s_add_u32 m0, s66, 81920
    v_mfma_f32_16x16x32_bf16 v[68:71], a[128:131], a[36:39], v[68:71]
    ds_read_b64_tr_b16 a[128:129], v132 offset:49152
    v_mfma_f32_16x16x32_bf16 v[72:75], a[132:135], a[32:35], v[72:75]
    ds_read_b64_tr_b16 a[130:131], v132 offset:53248
    buffer_load_dwordx4 v40, s[36:39], s57 offen offset:0 lds
    v_mfma_f32_16x16x32_bf16 v[76:79], a[132:135], a[36:39], v[76:79]
    ds_read_b64_tr_b16 a[132:133], v133 offset:49152
    v_mfma_f32_16x16x32_bf16 v[80:83], a[136:139], a[32:35], v[80:83]
    ds_read_b64_tr_b16 a[134:135], v133 offset:53248
    v_mfma_f32_16x16x32_bf16 v[84:87], a[136:139], a[36:39], v[84:87]
    ds_read_b64_tr_b16 a[136:137], v134 offset:49152
    buffer_load_dwordx4 v41, s[36:39], s57 offen offset:1024 lds
    v_mfma_f32_16x16x32_bf16 v[88:91], a[140:143], a[32:35], v[88:91]
    ds_read_b64_tr_b16 a[138:139], v134 offset:53248
    v_mfma_f32_16x16x32_bf16 v[92:95], a[140:143], a[36:39], v[92:95]
    ds_read_b64_tr_b16 a[140:141], v135 offset:49152
    buffer_load_dwordx4 a[16:19], v1, s[32:35], s53 offen offset:0 sc1
    v_mfma_f32_16x16x32_bf16 v[96:99], a[144:147], a[32:35], v[96:99]
    ds_read_b64_tr_b16 a[142:143], v135 offset:53248
    v_mfma_f32_16x16x32_bf16 v[100:103], a[144:147], a[36:39], v[100:103]
    ds_read_b64_tr_b16 a[144:145], v132 offset:51200
    v_mfma_f32_16x16x32_bf16 v[104:107], a[148:151], a[32:35], v[104:107]
    ds_read_b64_tr_b16 a[146:147], v132 offset:55296
    buffer_load_dwordx4 a[20:23], v1, s[32:35], s53 offen offset:1024 sc1
    v_mfma_f32_16x16x32_bf16 v[108:111], a[148:151], a[36:39], v[108:111]
    ds_read_b64_tr_b16 a[148:149], v133 offset:51200
    v_mfma_f32_16x16x32_bf16 v[112:115], a[152:155], a[32:35], v[112:115]
    ds_read_b64_tr_b16 a[150:151], v133 offset:55296
    s_waitcnt vmcnt(25)
    v_mfma_f32_16x16x32_bf16 v[116:119], a[152:155], a[36:39], v[116:119]
    ds_read_b64_tr_b16 a[152:153], v134 offset:51200
    v_mfma_f32_16x16x32_bf16 v[120:123], a[156:159], a[32:35], v[120:123]
    ds_read_b64_tr_b16 a[154:155], v134 offset:55296
    s_waitcnt lgkmcnt(14)
    v_mfma_f32_16x16x32_bf16 v[124:127], a[156:159], a[36:39], v[124:127]
    ds_read_b64_tr_b16 a[156:157], v135 offset:51200
    ds_read_b64_tr_b16 a[158:159], v135 offset:55296
    v_mfma_f32_16x16x32_bf16 v[64:67], a[160:163], a[40:43], v[64:67]
    s_mov_b32 s48, s20
    s_and_b32 s49, s21, 0xffff
    v_mfma_f32_16x16x32_bf16 v[68:71], a[160:163], a[44:47], v[68:71]
    ds_read_b64_tr_b16 a[160:161], v132 offset:57344
    s_mov_b32 s50, 4194304
    v_mfma_f32_16x16x32_bf16 v[72:75], a[164:167], a[40:43], v[72:75]
    ds_read_b64_tr_b16 a[162:163], v132 offset:61440
    s_mov_b32 s51, 0x20000
    v_mfma_f32_16x16x32_bf16 v[76:79], a[164:167], a[44:47], v[76:79]
    ds_read_b64_tr_b16 a[164:165], v133 offset:57344
    v_mfma_f32_16x16x32_bf16 v[80:83], a[168:171], a[40:43], v[80:83]
    ds_read_b64_tr_b16 a[166:167], v133 offset:61440
    buffer_load_dwordx4 v42, s[36:39], s57 offen offset:2048 lds
    v_mfma_f32_16x16x32_bf16 v[84:87], a[168:171], a[44:47], v[84:87]
    ds_read_b64_tr_b16 a[168:169], v134 offset:57344
    buffer_load_dwordx4 v43, s[36:39], s57 offen offset:3072 lds
    v_mfma_f32_16x16x32_bf16 v[88:91], a[172:175], a[40:43], v[88:91]
    ds_read_b64_tr_b16 a[170:171], v134 offset:61440
    v_mfma_f32_16x16x32_bf16 v[92:95], a[172:175], a[44:47], v[92:95]
    ds_read_b64_tr_b16 a[172:173], v135 offset:57344
    s_add_u32 s57, s57, 524288
    v_mfma_f32_16x16x32_bf16 v[96:99], a[176:179], a[40:43], v[96:99]
    ds_read_b64_tr_b16 a[174:175], v135 offset:61440
    buffer_load_dwordx4 a[24:27], v1, s[32:35], s53 offen offset:2048 sc1
    v_mfma_f32_16x16x32_bf16 v[100:103], a[176:179], a[44:47], v[100:103]
    ds_read_b64_tr_b16 a[176:177], v132 offset:59392
    v_mfma_f32_16x16x32_bf16 v[104:107], a[180:183], a[40:43], v[104:107]
    ds_read_b64_tr_b16 a[178:179], v132 offset:63488
    buffer_load_dwordx4 a[28:31], v1, s[32:35], s53 offen offset:3072 sc1
    v_mfma_f32_16x16x32_bf16 v[108:111], a[180:183], a[44:47], v[108:111]
    ds_read_b64_tr_b16 a[180:181], v133 offset:59392
    s_add_u32 s53, s53, 16384
    v_mfma_f32_16x16x32_bf16 v[112:115], a[184:187], a[40:43], v[112:115]
    ds_read_b64_tr_b16 a[182:183], v133 offset:63488
    s_waitcnt vmcnt(11)
    v_mfma_f32_16x16x32_bf16 v[116:119], a[184:187], a[44:47], v[116:119]
    ds_read_b64_tr_b16 a[184:185], v134 offset:59392
    v_mfma_f32_16x16x32_bf16 v[120:123], a[188:191], a[40:43], v[120:123]
    ds_read_b64_tr_b16 a[186:187], v134 offset:63488
    s_waitcnt lgkmcnt(14)
    v_mfma_f32_16x16x32_bf16 v[124:127], a[188:191], a[44:47], v[124:127]
    ds_read_b64_tr_b16 a[188:189], v135 offset:59392
    ds_read_b64_tr_b16 a[190:191], v135 offset:63488
    v_mfma_f32_16x16x32_bf16 v[64:67], a[128:131], a[48:51], v[64:67]
    s_barrier
    s_add_u32 m0, s66, 98304
    v_mfma_f32_16x16x32_bf16 v[68:71], a[128:131], a[52:55], v[68:71]
    ds_read_b64_tr_b16 a[128:129], v132 offset:0
    v_mfma_f32_16x16x32_bf16 v[72:75], a[132:135], a[48:51], v[72:75]
    ds_read_b64_tr_b16 a[130:131], v132 offset:4096
    buffer_load_dwordx4 v40, s[36:39], s58 offen offset:0 lds
    v_mfma_f32_16x16x32_bf16 v[76:79], a[132:135], a[52:55], v[76:79]
    ds_read_b64_tr_b16 a[132:133], v133 offset:0
    v_mfma_f32_16x16x32_bf16 v[80:83], a[136:139], a[48:51], v[80:83]
    ds_read_b64_tr_b16 a[134:135], v133 offset:4096
    v_mfma_f32_16x16x32_bf16 v[84:87], a[136:139], a[52:55], v[84:87]
    ds_read_b64_tr_b16 a[136:137], v134 offset:0
    buffer_load_dwordx4 v41, s[36:39], s58 offen offset:1024 lds
    v_mfma_f32_16x16x32_bf16 v[88:91], a[140:143], a[48:51], v[88:91]
    ds_read_b64_tr_b16 a[138:139], v134 offset:4096
    v_mfma_f32_16x16x32_bf16 v[92:95], a[140:143], a[52:55], v[92:95]
    ds_read_b64_tr_b16 a[140:141], v135 offset:0
    buffer_load_dwordx4 a[32:35], v1, s[32:35], s54 offen offset:0 sc1
    v_mfma_f32_16x16x32_bf16 v[96:99], a[144:147], a[48:51], v[96:99]
    ds_read_b64_tr_b16 a[142:143], v135 offset:4096
    v_mfma_f32_16x16x32_bf16 v[100:103], a[144:147], a[52:55], v[100:103]
    ds_read_b64_tr_b16 a[144:145], v132 offset:2048
    v_mfma_f32_16x16x32_bf16 v[104:107], a[148:151], a[48:51], v[104:107]
    ds_read_b64_tr_b16 a[146:147], v132 offset:6144
    buffer_load_dwordx4 a[36:39], v1, s[32:35], s54 offen offset:1024 sc1
    v_mfma_f32_16x16x32_bf16 v[108:111], a[148:151], a[52:55], v[108:111]
    ds_read_b64_tr_b16 a[148:149], v133 offset:2048
    v_mfma_f32_16x16x32_bf16 v[112:115], a[152:155], a[48:51], v[112:115]
    ds_read_b64_tr_b16 a[150:151], v133 offset:6144
    s_waitcnt vmcnt(21)
    v_mfma_f32_16x16x32_bf16 v[116:119], a[152:155], a[52:55], v[116:119]
    ds_read_b64_tr_b16 a[152:153], v134 offset:2048
    v_mfma_f32_16x16x32_bf16 v[120:123], a[156:159], a[48:51], v[120:123]
    ds_read_b64_tr_b16 a[154:155], v134 offset:6144
    s_waitcnt lgkmcnt(14)
    v_mfma_f32_16x16x32_bf16 v[124:127], a[156:159], a[52:55], v[124:127]
    ds_read_b64_tr_b16 a[156:157], v135 offset:2048
    ds_read_b64_tr_b16 a[158:159], v135 offset:6144
    v_mfma_f32_16x16x32_bf16 v[64:67], a[160:163], a[56:59], v[64:67]
    v_lshlrev_b32 v144, 16, v16
    v_and_b32 v145, 0xffff0000, v16
    v_lshlrev_b32 v146, 16, v17
    v_mfma_f32_16x16x32_bf16 v[68:71], a[160:163], a[60:63], v[68:71]
    ds_read_b64_tr_b16 a[160:161], v132 offset:8192
    v_and_b32 v147, 0xffff0000, v17
    v_mfma_f32_16x16x32_bf16 v[72:75], a[164:167], a[56:59], v[72:75]
    ds_read_b64_tr_b16 a[162:163], v132 offset:12288
    v_lshlrev_b32 v148, 16, v18
    v_mfma_f32_16x16x32_bf16 v[76:79], a[164:167], a[60:63], v[76:79]
    ds_read_b64_tr_b16 a[164:165], v133 offset:8192
    v_and_b32 v149, 0xffff0000, v18
    v_mfma_f32_16x16x32_bf16 v[80:83], a[168:171], a[56:59], v[80:83]
    ds_read_b64_tr_b16 a[166:167], v133 offset:12288
    v_lshlrev_b32 v150, 16, v19
    v_and_b32 v151, 0xffff0000, v19
    v_mfma_f32_16x16x32_bf16 v[84:87], a[168:171], a[60:63], v[84:87]
    ds_read_b64_tr_b16 a[168:169], v134 offset:8192
    v_lshlrev_b32 v152, 16, v20
    v_mfma_f32_16x16x32_bf16 v[88:91], a[172:175], a[56:59], v[88:91]
    ds_read_b64_tr_b16 a[170:171], v134 offset:12288
    v_and_b32 v153, 0xffff0000, v20
    v_mfma_f32_16x16x32_bf16 v[92:95], a[172:175], a[60:63], v[92:95]
    ds_read_b64_tr_b16 a[172:173], v135 offset:8192
    v_lshlrev_b32 v154, 16, v21
    v_mfma_f32_16x16x32_bf16 v[96:99], a[176:179], a[56:59], v[96:99]
    ds_read_b64_tr_b16 a[174:175], v135 offset:12288
    v_and_b32 v155, 0xffff0000, v21
    buffer_load_dwordx4 v42, s[36:39], s58 offen offset:2048 lds
    v_mfma_f32_16x16x32_bf16 v[100:103], a[176:179], a[60:63], v[100:103]
    ds_read_b64_tr_b16 a[176:177], v132 offset:10240
    buffer_load_dwordx4 v43, s[36:39], s58 offen offset:3072 lds
    v_mfma_f32_16x16x32_bf16 v[104:107], a[180:183], a[56:59], v[104:107]
    ds_read_b64_tr_b16 a[178:179], v132 offset:14336
    s_add_u32 s58, s58, 524288
    v_mfma_f32_16x16x32_bf16 v[108:111], a[180:183], a[60:63], v[108:111]
    ds_read_b64_tr_b16 a[180:181], v133 offset:10240
    buffer_load_dwordx4 a[40:43], v1, s[32:35], s54 offen offset:2048 sc1
    v_mfma_f32_16x16x32_bf16 v[112:115], a[184:187], a[56:59], v[112:115]
    ds_read_b64_tr_b16 a[182:183], v133 offset:14336
    s_waitcnt vmcnt(9)
    buffer_load_dwordx4 a[44:47], v1, s[32:35], s54 offen offset:3072 sc1
    v_mfma_f32_16x16x32_bf16 v[116:119], a[184:187], a[60:63], v[116:119]
    ds_read_b64_tr_b16 a[184:185], v134 offset:10240
    s_add_u32 s54, s54, 16384
    v_mfma_f32_16x16x32_bf16 v[120:123], a[188:191], a[56:59], v[120:123]
    ds_read_b64_tr_b16 a[186:187], v134 offset:14336
    s_waitcnt lgkmcnt(14)
    v_mfma_f32_16x16x32_bf16 v[124:127], a[188:191], a[60:63], v[124:127]
    ds_read_b64_tr_b16 a[188:189], v135 offset:10240
    ds_read_b64_tr_b16 a[190:191], v135 offset:14336
    v_mfma_f32_16x16x32_bf16 v[64:67], a[128:131], a[0:3], v[64:67]
    s_barrier
    v_lshlrev_b32 v156, 16, v22
    v_and_b32 v157, 0xffff0000, v22
    v_mfma_f32_16x16x32_bf16 v[68:71], a[128:131], a[4:7], v[68:71]
    ds_read_b64_tr_b16 a[128:129], v132 offset:16384
    v_lshlrev_b32 v158, 16, v23
    v_mfma_f32_16x16x32_bf16 v[72:75], a[132:135], a[0:3], v[72:75]
    ds_read_b64_tr_b16 a[130:131], v132 offset:20480
    v_and_b32 v159, 0xffff0000, v23
    v_mfma_f32_16x16x32_bf16 v[76:79], a[132:135], a[4:7], v[76:79]
    ds_read_b64_tr_b16 a[132:133], v133 offset:16384
    v_lshlrev_b32 v160, 16, v24
    v_mfma_f32_16x16x32_bf16 v[80:83], a[136:139], a[0:3], v[80:83]
    ds_read_b64_tr_b16 a[134:135], v133 offset:20480
    v_and_b32 v161, 0xffff0000, v24
    v_mfma_f32_16x16x32_bf16 v[84:87], a[136:139], a[4:7], v[84:87]
    ds_read_b64_tr_b16 a[136:137], v134 offset:16384
    v_lshlrev_b32 v162, 16, v25
    v_mfma_f32_16x16x32_bf16 v[88:91], a[140:143], a[0:3], v[88:91]
    ds_read_b64_tr_b16 a[138:139], v134 offset:20480
    v_and_b32 v163, 0xffff0000, v25
    v_mfma_f32_16x16x32_bf16 v[92:95], a[140:143], a[4:7], v[92:95]
    ds_read_b64_tr_b16 a[140:141], v135 offset:16384
    v_lshlrev_b32 v164, 16, v26
    v_mfma_f32_16x16x32_bf16 v[96:99], a[144:147], a[0:3], v[96:99]
    ds_read_b64_tr_b16 a[142:143], v135 offset:20480
    v_and_b32 v165, 0xffff0000, v26
    s_add_u32 m0, s66, 114688
    v_mfma_f32_16x16x32_bf16 v[100:103], a[144:147], a[4:7], v[100:103]
    ds_read_b64_tr_b16 a[144:145], v132 offset:18432
    buffer_load_dwordx4 v40, s[36:39], s59 offen offset:0 lds
    v_mfma_f32_16x16x32_bf16 v[104:107], a[148:151], a[0:3], v[104:107]
    ds_read_b64_tr_b16 a[146:147], v132 offset:22528
    buffer_load_dwordx4 v41, s[36:39], s59 offen offset:1024 lds
    v_mfma_f32_16x16x32_bf16 v[108:111], a[148:151], a[4:7], v[108:111]
    ds_read_b64_tr_b16 a[148:149], v133 offset:18432
    buffer_load_dwordx4 a[48:51], v1, s[32:35], s55 offen offset:0 sc1
    v_mfma_f32_16x16x32_bf16 v[112:115], a[152:155], a[0:3], v[112:115]
    ds_read_b64_tr_b16 a[150:151], v133 offset:22528
    s_waitcnt vmcnt(20)
    v_mfma_f32_16x16x32_bf16 v[116:119], a[152:155], a[4:7], v[116:119]
    ds_read_b64_tr_b16 a[152:153], v134 offset:18432
    buffer_load_dwordx4 a[52:55], v1, s[32:35], s55 offen offset:1024 sc1
    v_mfma_f32_16x16x32_bf16 v[120:123], a[156:159], a[0:3], v[120:123]
    ds_read_b64_tr_b16 a[154:155], v134 offset:22528
    s_waitcnt lgkmcnt(14)
    v_mfma_f32_16x16x32_bf16 v[124:127], a[156:159], a[4:7], v[124:127]
    ds_read_b64_tr_b16 a[156:157], v135 offset:18432
    ds_read_b64_tr_b16 a[158:159], v135 offset:22528
    v_mfma_f32_16x16x32_bf16 v[64:67], a[160:163], a[8:11], v[64:67]
    v_lshlrev_b32 v166, 16, v27
    v_and_b32 v167, 0xffff0000, v27
    v_lshlrev_b32 v168, 16, v28
    v_mfma_f32_16x16x32_bf16 v[68:71], a[160:163], a[12:15], v[68:71]
    ds_read_b64_tr_b16 a[160:161], v132 offset:24576
    v_and_b32 v169, 0xffff0000, v28
    v_mfma_f32_16x16x32_bf16 v[72:75], a[164:167], a[8:11], v[72:75]
    ds_read_b64_tr_b16 a[162:163], v132 offset:28672
    v_lshlrev_b32 v170, 16, v29
    v_mfma_f32_16x16x32_bf16 v[76:79], a[164:167], a[12:15], v[76:79]
    ds_read_b64_tr_b16 a[164:165], v133 offset:24576
    v_and_b32 v171, 0xffff0000, v29
    v_mfma_f32_16x16x32_bf16 v[80:83], a[168:171], a[8:11], v[80:83]
    ds_read_b64_tr_b16 a[166:167], v133 offset:28672
    v_lshlrev_b32 v172, 16, v30
    v_mfma_f32_16x16x32_bf16 v[84:87], a[168:171], a[12:15], v[84:87]
    ds_read_b64_tr_b16 a[168:169], v134 offset:24576
    v_and_b32 v173, 0xffff0000, v30
    v_mfma_f32_16x16x32_bf16 v[88:91], a[172:175], a[8:11], v[88:91]
    ds_read_b64_tr_b16 a[170:171], v134 offset:28672
    v_lshlrev_b32 v174, 16, v31
    v_mfma_f32_16x16x32_bf16 v[92:95], a[172:175], a[12:15], v[92:95]
    ds_read_b64_tr_b16 a[172:173], v135 offset:24576
    v_and_b32 v175, 0xffff0000, v31
    v_mfma_f32_16x16x32_bf16 v[96:99], a[176:179], a[8:11], v[96:99]
    ds_read_b64_tr_b16 a[174:175], v135 offset:28672
    buffer_load_dwordx4 v42, s[36:39], s59 offen offset:2048 lds
    buffer_load_dwordx4 v43, s[36:39], s59 offen offset:3072 lds
    v_mfma_f32_16x16x32_bf16 v[100:103], a[176:179], a[12:15], v[100:103]
    ds_read_b64_tr_b16 a[176:177], v132 offset:26624
    s_add_u32 s59, s59, 524288
    v_mfma_f32_16x16x32_bf16 v[104:107], a[180:183], a[8:11], v[104:107]
    ds_read_b64_tr_b16 a[178:179], v132 offset:30720
    buffer_load_dwordx4 a[56:59], v1, s[32:35], s55 offen offset:2048 sc1
    v_mfma_f32_16x16x32_bf16 v[108:111], a[180:183], a[12:15], v[108:111]
    ds_read_b64_tr_b16 a[180:181], v133 offset:26624
    buffer_load_dwordx4 a[60:63], v1, s[32:35], s55 offen offset:3072 sc1
    v_mfma_f32_16x16x32_bf16 v[112:115], a[184:187], a[8:11], v[112:115]
    ds_read_b64_tr_b16 a[182:183], v133 offset:30720
    s_waitcnt vmcnt(10)
    v_mfma_f32_16x16x32_bf16 v[116:119], a[184:187], a[12:15], v[116:119]
    ds_read_b64_tr_b16 a[184:185], v134 offset:26624
    s_add_u32 s55, s55, 16384
    v_mfma_f32_16x16x32_bf16 v[120:123], a[188:191], a[8:11], v[120:123]
    ds_read_b64_tr_b16 a[186:187], v134 offset:30720
    s_waitcnt lgkmcnt(14)
    v_mfma_f32_16x16x32_bf16 v[124:127], a[188:191], a[12:15], v[124:127]
    ds_read_b64_tr_b16 a[188:189], v135 offset:26624
    ds_read_b64_tr_b16 a[190:191], v135 offset:30720
    s_waitcnt vmcnt(24)
    v_cmp_ne_u64 vcc, s[70:71], v[10:11]
    s_mov_b32 s95, 0x40000
    s_nop 0
    s_cmp_eq_u64 vcc, 0
    s_cbranch_scc1 L_pfo_ok
L_pfo_spin:
    s_sleep 1
    buffer_load_dwordx2 v[10:11], v39, s[44:47], s94 offen sc1
    s_waitcnt vmcnt(0)
    v_cmp_ne_u64 vcc, s[70:71], v[10:11]
    s_sub_u32 s95, s95, 1
    s_cmp_eq_u32 s95, 0
    s_cbranch_scc1 L_pfo_ok
    s_cmp_lg_u64 vcc, 0
    s_cbranch_scc1 L_pfo_spin
L_pfo_ok:
    v_mfma_f32_16x16x32_bf16 v[64:67], a[128:131], a[16:19], v[64:67]
    s_barrier
    s_add_u32 m0, s66, 65536
    v_mfma_f32_16x16x32_bf16 v[68:71], a[128:131], a[20:23], v[68:71]
    ds_read_b64_tr_b16 a[128:129], v132 offset:32768
    s_xor_b32 s65, s101, 0
    v_mfma_f32_16x16x32_bf16 v[72:75], a[132:135], a[16:19], v[72:75]
    ds_read_b64_tr_b16 a[130:131], v132 offset:36864
    v_mfma_f32_16x16x32_bf16 v[76:79], a[132:135], a[20:23], v[76:79]
    ds_read_b64_tr_b16 a[132:133], v133 offset:32768
    s_add_u32 s65, s65, s29
    v_mfma_f32_16x16x32_bf16 v[80:83], a[136:139], a[16:19], v[80:83]
    ds_read_b64_tr_b16 a[134:135], v133 offset:36864
    buffer_load_dwordx4 v12, s[40:43], s65 offen offset:0 lds
    v_mfma_f32_16x16x32_bf16 v[84:87], a[136:139], a[20:23], v[84:87]
    ds_read_b64_tr_b16 a[136:137], v134 offset:32768
    v_mfma_f32_16x16x32_bf16 v[88:91], a[140:143], a[16:19], v[88:91]
    ds_read_b64_tr_b16 a[138:139], v134 offset:36864
    buffer_load_dwordx4 v13, s[40:43], s65 offen offset:1024 lds
    v_mfma_f32_16x16x32_bf16 v[92:95], a[140:143], a[20:23], v[92:95]
    ds_read_b64_tr_b16 a[140:141], v135 offset:32768
    v_mfma_f32_16x16x32_bf16 v[96:99], a[144:147], a[16:19], v[96:99]
    ds_read_b64_tr_b16 a[142:143], v135 offset:36864
    s_add_u32 s52, s52, s64
    v_mfma_f32_16x16x32_bf16 v[100:103], a[144:147], a[20:23], v[100:103]
    ds_read_b64_tr_b16 a[144:145], v132 offset:34816
    buffer_load_dwordx4 a[0:3], v1, s[32:35], s52 offen offset:0 sc1
    v_mfma_f32_16x16x32_bf16 v[104:107], a[148:151], a[16:19], v[104:107]
    ds_read_b64_tr_b16 a[146:147], v132 offset:38912
    v_mfma_f32_16x16x32_bf16 v[108:111], a[148:151], a[20:23], v[108:111]
    ds_read_b64_tr_b16 a[148:149], v133 offset:34816
    buffer_load_dwordx4 a[4:7], v1, s[32:35], s52 offen offset:1024 sc1
    v_mfma_f32_16x16x32_bf16 v[112:115], a[152:155], a[16:19], v[112:115]
    ds_read_b64_tr_b16 a[150:151], v133 offset:38912
    s_waitcnt vmcnt(20)
    v_mfma_f32_16x16x32_bf16 v[116:119], a[152:155], a[20:23], v[116:119]
    ds_read_b64_tr_b16 a[152:153], v134 offset:34816
    v_mfma_f32_16x16x32_bf16 v[120:123], a[156:159], a[16:19], v[120:123]
    ds_read_b64_tr_b16 a[154:155], v134 offset:38912
    s_waitcnt lgkmcnt(14)
    v_mfma_f32_16x16x32_bf16 v[124:127], a[156:159], a[20:23], v[124:127]
    ds_read_b64_tr_b16 a[156:157], v135 offset:34816
    ds_read_b64_tr_b16 a[158:159], v135 offset:38912
    v_mfma_f32_16x16x32_bf16 v[64:67], a[160:163], a[24:27], v[64:67]
    buffer_load_dwordx4 v14, s[40:43], s65 offen offset:2048 lds
    buffer_load_dwordx4 v15, s[40:43], s65 offen offset:3072 lds
    v_mfma_f32_16x16x32_bf16 v[68:71], a[160:163], a[28:31], v[68:71]
    ds_read_b64_tr_b16 a[160:161], v132 offset:40960
    v_mfma_f32_16x16x32_bf16 v[72:75], a[164:167], a[24:27], v[72:75]
    ds_read_b64_tr_b16 a[162:163], v132 offset:45056
    v_mfma_f32_16x16x32_bf16 v[76:79], a[164:167], a[28:31], v[76:79]
    ds_read_b64_tr_b16 a[164:165], v133 offset:40960
    buffer_load_dwordx4 a[8:11], v1, s[32:35], s52 offen offset:2048 sc1
    v_mfma_f32_16x16x32_bf16 v[80:83], a[168:171], a[24:27], v[80:83]
    ds_read_b64_tr_b16 a[166:167], v133 offset:45056
    v_mfma_f32_16x16x32_bf16 v[84:87], a[168:171], a[28:31], v[84:87]
    ds_read_b64_tr_b16 a[168:169], v134 offset:40960
    v_mfma_f32_16x16x32_bf16 v[88:91], a[172:175], a[24:27], v[88:91]
    ds_read_b64_tr_b16 a[170:171], v134 offset:45056
    buffer_load_dwordx4 a[12:15], v1, s[32:35], s52 offen offset:3072 sc1
    v_mfma_f32_16x16x32_bf16 v[92:95], a[172:175], a[28:31], v[92:95]
    ds_read_b64_tr_b16 a[172:173], v135 offset:40960
    v_mfma_f32_16x16x32_bf16 v[96:99], a[176:179], a[24:27], v[96:99]
    ds_read_b64_tr_b16 a[174:175], v135 offset:45056
    v_mfma_f32_16x16x32_bf16 v[100:103], a[176:179], a[28:31], v[100:103]
    ds_read_b64_tr_b16 a[176:177], v132 offset:43008
    s_add_u32 s52, s52, 16384
    v_mfma_f32_16x16x32_bf16 v[104:107], a[180:183], a[24:27], v[104:107]
    ds_read_b64_tr_b16 a[178:179], v132 offset:47104
    v_mfma_f32_16x16x32_bf16 v[108:111], a[180:183], a[28:31], v[108:111]
    ds_read_b64_tr_b16 a[180:181], v133 offset:43008
    v_mfma_f32_16x16x32_bf16 v[112:115], a[184:187], a[24:27], v[112:115]
    ds_read_b64_tr_b16 a[182:183], v133 offset:47104
    s_waitcnt vmcnt(10)
    v_mfma_f32_16x16x32_bf16 v[116:119], a[184:187], a[28:31], v[116:119]
    ds_read_b64_tr_b16 a[184:185], v134 offset:43008
    v_mfma_f32_16x16x32_bf16 v[120:123], a[188:191], a[24:27], v[120:123]
    ds_read_b64_tr_b16 a[186:187], v134 offset:47104
    s_waitcnt lgkmcnt(14)
    v_mfma_f32_16x16x32_bf16 v[124:127], a[188:191], a[28:31], v[124:127]
    ds_read_b64_tr_b16 a[188:189], v135 offset:43008
    ds_read_b64_tr_b16 a[190:191], v135 offset:47104
    v_mfma_f32_16x16x32_bf16 v[64:67], a[128:131], a[32:35], v[64:67]
    s_barrier
    s_add_u32 m0, s66, 81920
    v_mfma_f32_16x16x32_bf16 v[68:71], a[128:131], a[36:39], v[68:71]
    ds_read_b64_tr_b16 a[128:129], v132 offset:49152
    s_xor_b32 s65, s101, 131072
    v_mfma_f32_16x16x32_bf16 v[72:75], a[132:135], a[32:35], v[72:75]
    ds_read_b64_tr_b16 a[130:131], v132 offset:53248
    v_mfma_f32_16x16x32_bf16 v[76:79], a[132:135], a[36:39], v[76:79]
    ds_read_b64_tr_b16 a[132:133], v133 offset:49152
    s_add_u32 s65, s65, s29
    v_mfma_f32_16x16x32_bf16 v[80:83], a[136:139], a[32:35], v[80:83]
    ds_read_b64_tr_b16 a[134:135], v133 offset:53248
    buffer_load_dwordx4 v12, s[40:43], s65 offen offset:0 lds
    v_mfma_f32_16x16x32_bf16 v[84:87], a[136:139], a[36:39], v[84:87]
    ds_read_b64_tr_b16 a[136:137], v134 offset:49152
    v_mfma_f32_16x16x32_bf16 v[88:91], a[140:143], a[32:35], v[88:91]
    ds_read_b64_tr_b16 a[138:139], v134 offset:53248
    buffer_load_dwordx4 v13, s[40:43], s65 offen offset:1024 lds
    v_mfma_f32_16x16x32_bf16 v[92:95], a[140:143], a[36:39], v[92:95]
    ds_read_b64_tr_b16 a[140:141], v135 offset:49152
    v_mfma_f32_16x16x32_bf16 v[96:99], a[144:147], a[32:35], v[96:99]
    ds_read_b64_tr_b16 a[142:143], v135 offset:53248
    s_add_u32 s53, s53, s64
    v_mfma_f32_16x16x32_bf16 v[100:103], a[144:147], a[36:39], v[100:103]
    ds_read_b64_tr_b16 a[144:145], v132 offset:51200
    buffer_load_dwordx4 a[16:19], v1, s[32:35], s53 offen offset:0 sc1
    v_mfma_f32_16x16x32_bf16 v[104:107], a[148:151], a[32:35], v[104:107]
    ds_read_b64_tr_b16 a[146:147], v132 offset:55296
    v_mfma_f32_16x16x32_bf16 v[108:111], a[148:151], a[36:39], v[108:111]
    ds_read_b64_tr_b16 a[148:149], v133 offset:51200
    buffer_load_dwordx4 a[20:23], v1, s[32:35], s53 offen offset:1024 sc1
    v_mfma_f32_16x16x32_bf16 v[112:115], a[152:155], a[32:35], v[112:115]
    ds_read_b64_tr_b16 a[150:151], v133 offset:55296
    s_waitcnt vmcnt(20)
    v_mfma_f32_16x16x32_bf16 v[116:119], a[152:155], a[36:39], v[116:119]
    ds_read_b64_tr_b16 a[152:153], v134 offset:51200
    v_mfma_f32_16x16x32_bf16 v[120:123], a[156:159], a[32:35], v[120:123]
    ds_read_b64_tr_b16 a[154:155], v134 offset:55296
    s_waitcnt lgkmcnt(14)
    v_mfma_f32_16x16x32_bf16 v[124:127], a[156:159], a[36:39], v[124:127]
    ds_read_b64_tr_b16 a[156:157], v135 offset:51200
    ds_read_b64_tr_b16 a[158:159], v135 offset:55296
    v_mfma_f32_16x16x32_bf16 v[64:67], a[160:163], a[40:43], v[64:67]
    buffer_load_dwordx4 v14, s[40:43], s65 offen offset:2048 lds
    buffer_load_dwordx4 v15, s[40:43], s65 offen offset:3072 lds
    v_mfma_f32_16x16x32_bf16 v[68:71], a[160:163], a[44:47], v[68:71]
    ds_read_b64_tr_b16 a[160:161], v132 offset:57344
    v_mfma_f32_16x16x32_bf16 v[72:75], a[164:167], a[40:43], v[72:75]
    ds_read_b64_tr_b16 a[162:163], v132 offset:61440
    v_mfma_f32_16x16x32_bf16 v[76:79], a[164:167], a[44:47], v[76:79]
    ds_read_b64_tr_b16 a[164:165], v133 offset:57344
    buffer_load_dwordx4 a[24:27], v1, s[32:35], s53 offen offset:2048 sc1
    v_mfma_f32_16x16x32_bf16 v[80:83], a[168:171], a[40:43], v[80:83]
    ds_read_b64_tr_b16 a[166:167], v133 offset:61440
    v_mfma_f32_16x16x32_bf16 v[84:87], a[168:171], a[44:47], v[84:87]
    ds_read_b64_tr_b16 a[168:169], v134 offset:57344
    v_mfma_f32_16x16x32_bf16 v[88:91], a[172:175], a[40:43], v[88:91]
    ds_read_b64_tr_b16 a[170:171], v134 offset:61440
    buffer_load_dwordx4 a[28:31], v1, s[32:35], s53 offen offset:3072 sc1
    v_mfma_f32_16x16x32_bf16 v[92:95], a[172:175], a[44:47], v[92:95]
    ds_read_b64_tr_b16 a[172:173], v135 offset:57344
    v_mfma_f32_16x16x32_bf16 v[96:99], a[176:179], a[40:43], v[96:99]
    ds_read_b64_tr_b16 a[174:175], v135 offset:61440
    v_mfma_f32_16x16x32_bf16 v[100:103], a[176:179], a[44:47], v[100:103]
    ds_read_b64_tr_b16 a[176:177], v132 offset:59392
    s_add_u32 s53, s53, 16384
    v_mfma_f32_16x16x32_bf16 v[104:107], a[180:183], a[40:43], v[104:107]
    ds_read_b64_tr_b16 a[178:179], v132 offset:63488
    v_mfma_f32_16x16x32_bf16 v[108:111], a[180:183], a[44:47], v[108:111]
    ds_read_b64_tr_b16 a[180:181], v133 offset:59392
    v_mfma_f32_16x16x32_bf16 v[112:115], a[184:187], a[40:43], v[112:115]
    ds_read_b64_tr_b16 a[182:183], v133 offset:63488
    s_waitcnt vmcnt(10)
    v_mfma_f32_16x16x32_bf16 v[116:119], a[184:187], a[44:47], v[116:119]
    ds_read_b64_tr_b16 a[184:185], v134 offset:59392
    v_mfma_f32_16x16x32_bf16 v[120:123], a[188:191], a[40:43], v[120:123]
    ds_read_b64_tr_b16 a[186:187], v134 offset:63488
    s_waitcnt lgkmcnt(14)
    v_mfma_f32_16x16x32_bf16 v[124:127], a[188:191], a[44:47], v[124:127]
    ds_read_b64_tr_b16 a[188:189], v135 offset:59392
    ds_read_b64_tr_b16 a[190:191], v135 offset:63488
    v_mfma_f32_16x16x32_bf16 v[64:67], a[128:131], a[48:51], v[64:67]
    s_barrier
    s_add_u32 m0, s66, 98304
    v_mfma_f32_16x16x32_bf16 v[68:71], a[128:131], a[52:55], v[68:71]
    ds_read_b64_tr_b16 a[128:129], v132 offset:0
    s_xor_b32 s65, s101, 262144
    v_mfma_f32_16x16x32_bf16 v[72:75], a[132:135], a[48:51], v[72:75]
    ds_read_b64_tr_b16 a[130:131], v132 offset:4096
    v_mfma_f32_16x16x32_bf16 v[76:79], a[132:135], a[52:55], v[76:79]
    ds_read_b64_tr_b16 a[132:133], v133 offset:0
    s_add_u32 s65, s65, s29
    v_mfma_f32_16x16x32_bf16 v[80:83], a[136:139], a[48:51], v[80:83]
    ds_read_b64_tr_b16 a[134:135], v133 offset:4096
    buffer_load_dwordx4 v12, s[40:43], s65 offen offset:0 lds
    v_mfma_f32_16x16x32_bf16 v[84:87], a[136:139], a[52:55], v[84:87]
    ds_read_b64_tr_b16 a[136:137], v134 offset:0
    v_mfma_f32_16x16x32_bf16 v[88:91], a[140:143], a[48:51], v[88:91]
    ds_read_b64_tr_b16 a[138:139], v134 offset:4096
    buffer_load_dwordx4 v13, s[40:43], s65 offen offset:1024 lds
    v_mfma_f32_16x16x32_bf16 v[92:95], a[140:143], a[52:55], v[92:95]
    ds_read_b64_tr_b16 a[140:141], v135 offset:0
    v_mfma_f32_16x16x32_bf16 v[96:99], a[144:147], a[48:51], v[96:99]
    ds_read_b64_tr_b16 a[142:143], v135 offset:4096
    s_add_u32 s54, s54, s64
    v_mfma_f32_16x16x32_bf16 v[100:103], a[144:147], a[52:55], v[100:103]
    ds_read_b64_tr_b16 a[144:145], v132 offset:2048
    buffer_load_dwordx4 a[32:35], v1, s[32:35], s54 offen offset:0 sc1
    v_mfma_f32_16x16x32_bf16 v[104:107], a[148:151], a[48:51], v[104:107]
    ds_read_b64_tr_b16 a[146:147], v132 offset:6144
    v_mfma_f32_16x16x32_bf16 v[108:111], a[148:151], a[52:55], v[108:111]
    ds_read_b64_tr_b16 a[148:149], v133 offset:2048
    buffer_load_dwordx4 a[36:39], v1, s[32:35], s54 offen offset:1024 sc1
    v_mfma_f32_16x16x32_bf16 v[112:115], a[152:155], a[48:51], v[112:115]
    ds_read_b64_tr_b16 a[150:151], v133 offset:6144
    s_waitcnt vmcnt(20)
    v_mfma_f32_16x16x32_bf16 v[116:119], a[152:155], a[52:55], v[116:119]
    ds_read_b64_tr_b16 a[152:153], v134 offset:2048
    v_mfma_f32_16x16x32_bf16 v[120:123], a[156:159], a[48:51], v[120:123]
    ds_read_b64_tr_b16 a[154:155], v134 offset:6144
    s_waitcnt lgkmcnt(14)
    v_mfma_f32_16x16x32_bf16 v[124:127], a[156:159], a[52:55], v[124:127]
    ds_read_b64_tr_b16 a[156:157], v135 offset:2048
    ds_read_b64_tr_b16 a[158:159], v135 offset:6144
    v_mfma_f32_16x16x32_bf16 v[64:67], a[160:163], a[56:59], v[64:67]
    buffer_load_dwordx4 v14, s[40:43], s65 offen offset:2048 lds
    buffer_load_dwordx4 v15, s[40:43], s65 offen offset:3072 lds
    v_mfma_f32_16x16x32_bf16 v[68:71], a[160:163], a[60:63], v[68:71]
    ds_read_b64_tr_b16 a[160:161], v132 offset:8192
    v_mfma_f32_16x16x32_bf16 v[72:75], a[164:167], a[56:59], v[72:75]
    ds_read_b64_tr_b16 a[162:163], v132 offset:12288
    v_mfma_f32_16x16x32_bf16 v[76:79], a[164:167], a[60:63], v[76:79]
    ds_read_b64_tr_b16 a[164:165], v133 offset:8192
    buffer_load_dwordx4 a[40:43], v1, s[32:35], s54 offen offset:2048 sc1
    v_mfma_f32_16x16x32_bf16 v[80:83], a[168:171], a[56:59], v[80:83]
    ds_read_b64_tr_b16 a[166:167], v133 offset:12288
    v_mfma_f32_16x16x32_bf16 v[84:87], a[168:171], a[60:63], v[84:87]
    ds_read_b64_tr_b16 a[168:169], v134 offset:8192
    v_mfma_f32_16x16x32_bf16 v[88:91], a[172:175], a[56:59], v[88:91]
    ds_read_b64_tr_b16 a[170:171], v134 offset:12288
    buffer_load_dwordx4 a[44:47], v1, s[32:35], s54 offen offset:3072 sc1
    v_mfma_f32_16x16x32_bf16 v[92:95], a[172:175], a[60:63], v[92:95]
    ds_read_b64_tr_b16 a[172:173], v135 offset:8192
    v_mfma_f32_16x16x32_bf16 v[96:99], a[176:179], a[56:59], v[96:99]
    ds_read_b64_tr_b16 a[174:175], v135 offset:12288
    v_mfma_f32_16x16x32_bf16 v[100:103], a[176:179], a[60:63], v[100:103]
    ds_read_b64_tr_b16 a[176:177], v132 offset:10240
    s_add_u32 s54, s54, 16384
    v_mfma_f32_16x16x32_bf16 v[104:107], a[180:183], a[56:59], v[104:107]
    ds_read_b64_tr_b16 a[178:179], v132 offset:14336
    v_mfma_f32_16x16x32_bf16 v[108:111], a[180:183], a[60:63], v[108:111]
    ds_read_b64_tr_b16 a[180:181], v133 offset:10240
    v_mfma_f32_16x16x32_bf16 v[112:115], a[184:187], a[56:59], v[112:115]
    ds_read_b64_tr_b16 a[182:183], v133 offset:14336
    s_waitcnt vmcnt(10)
    v_mfma_f32_16x16x32_bf16 v[116:119], a[184:187], a[60:63], v[116:119]
    ds_read_b64_tr_b16 a[184:185], v134 offset:10240
    v_mfma_f32_16x16x32_bf16 v[120:123], a[188:191], a[56:59], v[120:123]
    ds_read_b64_tr_b16 a[186:187], v134 offset:14336
    s_waitcnt lgkmcnt(14)
    v_mfma_f32_16x16x32_bf16 v[124:127], a[188:191], a[60:63], v[124:127]
    ds_read_b64_tr_b16 a[188:189], v135 offset:10240
    ds_read_b64_tr_b16 a[190:191], v135 offset:14336
    v_mfma_f32_16x16x32_bf16 v[64:67], a[128:131], a[0:3], v[64:67]
    s_barrier
    s_add_u32 m0, s66, 114688
    v_mfma_f32_16x16x32_bf16 v[68:71], a[128:131], a[4:7], v[68:71]
    ds_read_b64_tr_b16 a[128:129], v132 offset:16384
    s_xor_b32 s65, s101, 393216
    v_mfma_f32_16x16x32_bf16 v[72:75], a[132:135], a[0:3], v[72:75]
    ds_read_b64_tr_b16 a[130:131], v132 offset:20480
    v_mfma_f32_16x16x32_bf16 v[76:79], a[132:135], a[4:7], v[76:79]
    ds_read_b64_tr_b16 a[132:133], v133 offset:16384
    s_add_u32 s65, s65, s29
    v_mfma_f32_16x16x32_bf16 v[80:83], a[136:139], a[0:3], v[80:83]
    ds_read_b64_tr_b16 a[134:135], v133 offset:20480
    buffer_load_dwordx4 v12, s[40:43], s65 offen offset:0 lds
    v_mfma_f32_16x16x32_bf16 v[84:87], a[136:139], a[4:7], v[84:87]
    ds_read_b64_tr_b16 a[136:137], v134 offset:16384
    v_mfma_f32_16x16x32_bf16 v[88:91], a[140:143], a[0:3], v[88:91]
    ds_read_b64_tr_b16 a[138:139], v134 offset:20480
    buffer_load_dwordx4 v13, s[40:43], s65 offen offset:1024 lds
    v_mfma_f32_16x16x32_bf16 v[92:95], a[140:143], a[4:7], v[92:95]
    ds_read_b64_tr_b16 a[140:141], v135 offset:16384
    v_mfma_f32_16x16x32_bf16 v[96:99], a[144:147], a[0:3], v[96:99]
    ds_read_b64_tr_b16 a[142:143], v135 offset:20480
    s_add_u32 s55, s55, s64
    v_mfma_f32_16x16x32_bf16 v[100:103], a[144:147], a[4:7], v[100:103]
    ds_read_b64_tr_b16 a[144:145], v132 offset:18432
    buffer_load_dwordx4 a[48:51], v1, s[32:35], s55 offen offset:0 sc1
    v_mfma_f32_16x16x32_bf16 v[104:107], a[148:151], a[0:3], v[104:107]
    ds_read_b64_tr_b16 a[146:147], v132 offset:22528
    v_mfma_f32_16x16x32_bf16 v[108:111], a[148:151], a[4:7], v[108:111]
    ds_read_b64_tr_b16 a[148:149], v133 offset:18432
    buffer_load_dwordx4 a[52:55], v1, s[32:35], s55 offen offset:1024 sc1
    v_mfma_f32_16x16x32_bf16 v[112:115], a[152:155], a[0:3], v[112:115]
    ds_read_b64_tr_b16 a[150:151], v133 offset:22528
    s_waitcnt vmcnt(20)
    v_mfma_f32_16x16x32_bf16 v[116:119], a[152:155], a[4:7], v[116:119]
    ds_read_b64_tr_b16 a[152:153], v134 offset:18432
    v_mfma_f32_16x16x32_bf16 v[120:123], a[156:159], a[0:3], v[120:123]
    ds_read_b64_tr_b16 a[154:155], v134 offset:22528
    s_waitcnt lgkmcnt(14)
    v_mfma_f32_16x16x32_bf16 v[124:127], a[156:159], a[4:7], v[124:127]
    ds_read_b64_tr_b16 a[156:157], v135 offset:18432
    ds_read_b64_tr_b16 a[158:159], v135 offset:22528
    v_mfma_f32_16x16x32_bf16 v[64:67], a[160:163], a[8:11], v[64:67]
    buffer_load_dwordx4 v14, s[40:43], s65 offen offset:2048 lds
    buffer_load_dwordx4 v15, s[40:43], s65 offen offset:3072 lds
    v_mfma_f32_16x16x32_bf16 v[68:71], a[160:163], a[12:15], v[68:71]
    ds_read_b64_tr_b16 a[160:161], v132 offset:24576
    v_mfma_f32_16x16x32_bf16 v[72:75], a[164:167], a[8:11], v[72:75]
    ds_read_b64_tr_b16 a[162:163], v132 offset:28672
    v_mfma_f32_16x16x32_bf16 v[76:79], a[164:167], a[12:15], v[76:79]
    ds_read_b64_tr_b16 a[164:165], v133 offset:24576
    buffer_load_dwordx4 a[56:59], v1, s[32:35], s55 offen offset:2048 sc1
    v_mfma_f32_16x16x32_bf16 v[80:83], a[168:171], a[8:11], v[80:83]
    ds_read_b64_tr_b16 a[166:167], v133 offset:28672
    v_mfma_f32_16x16x32_bf16 v[84:87], a[168:171], a[12:15], v[84:87]
    ds_read_b64_tr_b16 a[168:169], v134 offset:24576
    v_mfma_f32_16x16x32_bf16 v[88:91], a[172:175], a[8:11], v[88:91]
    ds_read_b64_tr_b16 a[170:171], v134 offset:28672
    buffer_load_dwordx4 a[60:63], v1, s[32:35], s55 offen offset:3072 sc1
    v_mfma_f32_16x16x32_bf16 v[92:95], a[172:175], a[12:15], v[92:95]
    ds_read_b64_tr_b16 a[172:173], v135 offset:24576
    v_mfma_f32_16x16x32_bf16 v[96:99], a[176:179], a[8:11], v[96:99]
    ds_read_b64_tr_b16 a[174:175], v135 offset:28672
    v_mfma_f32_16x16x32_bf16 v[100:103], a[176:179], a[12:15], v[100:103]
    ds_read_b64_tr_b16 a[176:177], v132 offset:26624
    s_add_u32 s55, s55, 16384
    v_mfma_f32_16x16x32_bf16 v[104:107], a[180:183], a[8:11], v[104:107]
    ds_read_b64_tr_b16 a[178:179], v132 offset:30720
    v_mfma_f32_16x16x32_bf16 v[108:111], a[180:183], a[12:15], v[108:111]
    ds_read_b64_tr_b16 a[180:181], v133 offset:26624
    v_mfma_f32_16x16x32_bf16 v[112:115], a[184:187], a[8:11], v[112:115]
    ds_read_b64_tr_b16 a[182:183], v133 offset:30720
    s_waitcnt vmcnt(10)
    v_mfma_f32_16x16x32_bf16 v[116:119], a[184:187], a[12:15], v[116:119]
    ds_read_b64_tr_b16 a[184:185], v134 offset:26624
    v_mfma_f32_16x16x32_bf16 v[120:123], a[188:191], a[8:11], v[120:123]
    ds_read_b64_tr_b16 a[186:187], v134 offset:30720
    s_waitcnt lgkmcnt(14)
    v_mfma_f32_16x16x32_bf16 v[124:127], a[188:191], a[12:15], v[124:127]
    ds_read_b64_tr_b16 a[188:189], v135 offset:26624
    ds_read_b64_tr_b16 a[190:191], v135 offset:30720
    v_mfma_f32_16x16x32_bf16 v[64:67], a[128:131], a[16:19], v[64:67]
    s_barrier
    s_add_u32 s52, s52, s3
    v_mfma_f32_16x16x32_bf16 v[68:71], a[128:131], a[20:23], v[68:71]
    ds_read_b64_tr_b16 a[128:129], v132 offset:32768
    buffer_load_dwordx4 a[64:67], v1, s[32:35], s52 offen offset:0 sc1
    v_mfma_f32_16x16x32_bf16 v[72:75], a[132:135], a[16:19], v[72:75]
    ds_read_b64_tr_b16 a[130:131], v132 offset:36864
    buffer_load_dwordx4 a[68:71], v1, s[32:35], s52 offen offset:1024 sc1
    v_mfma_f32_16x16x32_bf16 v[76:79], a[132:135], a[20:23], v[76:79]
    ds_read_b64_tr_b16 a[132:133], v133 offset:32768
    v_mfma_f32_16x16x32_bf16 v[80:83], a[136:139], a[16:19], v[80:83]
    ds_read_b64_tr_b16 a[134:135], v133 offset:36864
    buffer_load_dwordx4 a[72:75], v1, s[32:35], s52 offen offset:2048 sc1
    v_mfma_f32_16x16x32_bf16 v[84:87], a[136:139], a[20:23], v[84:87]
    ds_read_b64_tr_b16 a[136:137], v134 offset:32768
    buffer_load_dwordx4 a[76:79], v1, s[32:35], s52 offen offset:3072 sc1
    v_mfma_f32_16x16x32_bf16 v[88:91], a[140:143], a[16:19], v[88:91]
    ds_read_b64_tr_b16 a[138:139], v134 offset:36864
    v_mfma_f32_16x16x32_bf16 v[92:95], a[140:143], a[20:23], v[92:95]
    ds_read_b64_tr_b16 a[140:141], v135 offset:32768
    s_add_u32 s52, s52, 16384
    v_mfma_f32_16x16x32_bf16 v[96:99], a[144:147], a[16:19], v[96:99]
    ds_read_b64_tr_b16 a[142:143], v135 offset:36864
    s_add_u32 s53, s53, s3
    v_mfma_f32_16x16x32_bf16 v[100:103], a[144:147], a[20:23], v[100:103]
    ds_read_b64_tr_b16 a[144:145], v132 offset:34816
    v_mfma_f32_16x16x32_bf16 v[104:107], a[148:151], a[16:19], v[104:107]
    ds_read_b64_tr_b16 a[146:147], v132 offset:38912
    buffer_load_dwordx4 a[80:83], v1, s[32:35], s53 offen offset:0 sc1
    v_mfma_f32_16x16x32_bf16 v[108:111], a[148:151], a[20:23], v[108:111]
    ds_read_b64_tr_b16 a[148:149], v133 offset:34816
    buffer_load_dwordx4 a[84:87], v1, s[32:35], s53 offen offset:1024 sc1
    v_mfma_f32_16x16x32_bf16 v[112:115], a[152:155], a[16:19], v[112:115]
    ds_read_b64_tr_b16 a[150:151], v133 offset:38912
    s_waitcnt vmcnt(22)
    v_mfma_f32_16x16x32_bf16 v[116:119], a[152:155], a[20:23], v[116:119]
    ds_read_b64_tr_b16 a[152:153], v134 offset:34816
    v_mfma_f32_16x16x32_bf16 v[120:123], a[156:159], a[16:19], v[120:123]
    ds_read_b64_tr_b16 a[154:155], v134 offset:38912
    s_waitcnt lgkmcnt(14)
    v_mfma_f32_16x16x32_bf16 v[124:127], a[156:159], a[20:23], v[124:127]
    ds_read_b64_tr_b16 a[156:157], v135 offset:34816
    ds_read_b64_tr_b16 a[158:159], v135 offset:38912
    v_mfma_f32_16x16x32_bf16 v[64:67], a[160:163], a[24:27], v[64:67]
    buffer_load_dwordx4 a[88:91], v1, s[32:35], s53 offen offset:2048 sc1
    buffer_load_dwordx4 a[92:95], v1, s[32:35], s53 offen offset:3072 sc1
    v_mfma_f32_16x16x32_bf16 v[68:71], a[160:163], a[28:31], v[68:71]
    ds_read_b64_tr_b16 a[160:161], v132 offset:40960
    s_add_u32 s53, s53, 16384
    v_mfma_f32_16x16x32_bf16 v[72:75], a[164:167], a[24:27], v[72:75]
    ds_read_b64_tr_b16 a[162:163], v132 offset:45056
    v_mfma_f32_16x16x32_bf16 v[76:79], a[164:167], a[28:31], v[76:79]
    ds_read_b64_tr_b16 a[164:165], v133 offset:40960
    s_add_u32 s54, s54, s3
    v_mfma_f32_16x16x32_bf16 v[80:83], a[168:171], a[24:27], v[80:83]
    ds_read_b64_tr_b16 a[166:167], v133 offset:45056
    buffer_load_dwordx4 a[96:99], v1, s[32:35], s54 offen offset:0 sc1
    v_mfma_f32_16x16x32_bf16 v[84:87], a[168:171], a[28:31], v[84:87]
    ds_read_b64_tr_b16 a[168:169], v134 offset:40960
    v_mfma_f32_16x16x32_bf16 v[88:91], a[172:175], a[24:27], v[88:91]
    ds_read_b64_tr_b16 a[170:171], v134 offset:45056
    buffer_load_dwordx4 a[100:103], v1, s[32:35], s54 offen offset:1024 sc1
    v_mfma_f32_16x16x32_bf16 v[92:95], a[172:175], a[28:31], v[92:95]
    ds_read_b64_tr_b16 a[172:173], v135 offset:40960
    v_mfma_f32_16x16x32_bf16 v[96:99], a[176:179], a[24:27], v[96:99]
    ds_read_b64_tr_b16 a[174:175], v135 offset:45056
    buffer_load_dwordx4 a[104:107], v1, s[32:35], s54 offen offset:2048 sc1
    v_mfma_f32_16x16x32_bf16 v[100:103], a[176:179], a[28:31], v[100:103]
    ds_read_b64_tr_b16 a[176:177], v132 offset:43008
    buffer_load_dwordx4 a[108:111], v1, s[32:35], s54 offen offset:3072 sc1
    v_mfma_f32_16x16x32_bf16 v[104:107], a[180:183], a[24:27], v[104:107]
    ds_read_b64_tr_b16 a[178:179], v132 offset:47104
    v_mfma_f32_16x16x32_bf16 v[108:111], a[180:183], a[28:31], v[108:111]
    ds_read_b64_tr_b16 a[180:181], v133 offset:43008
    s_add_u32 s54, s54, 16384
    v_mfma_f32_16x16x32_bf16 v[112:115], a[184:187], a[24:27], v[112:115]
    ds_read_b64_tr_b16 a[182:183], v133 offset:47104
    s_waitcnt vmcnt(14)
    v_mfma_f32_16x16x32_bf16 v[116:119], a[184:187], a[28:31], v[116:119]
    ds_read_b64_tr_b16 a[184:185], v134 offset:43008
    v_mfma_f32_16x16x32_bf16 v[120:123], a[188:191], a[24:27], v[120:123]
    ds_read_b64_tr_b16 a[186:187], v134 offset:47104
    s_waitcnt lgkmcnt(14)
    v_mfma_f32_16x16x32_bf16 v[124:127], a[188:191], a[28:31], v[124:127]
    ds_read_b64_tr_b16 a[188:189], v135 offset:43008
    ds_read_b64_tr_b16 a[190:191], v135 offset:47104
    v_mfma_f32_16x16x32_bf16 v[96:99], a[144:147], a[32:35], v[96:99]
    s_barrier
    s_add_u32 s55, s55, s3
    v_mfma_f32_16x16x32_bf16 v[100:103], a[144:147], a[36:39], v[100:103]
    ds_read_b64_tr_b16 a[144:145], v132 offset:51200
    buffer_load_dwordx4 a[112:115], v1, s[32:35], s55 offen offset:0 sc1
    v_mfma_f32_16x16x32_bf16 v[104:107], a[148:151], a[32:35], v[104:107]
    ds_read_b64_tr_b16 a[146:147], v132 offset:55296
    v_mfma_f32_16x16x32_bf16 v[108:111], a[148:151], a[36:39], v[108:111]
    ds_read_b64_tr_b16 a[148:149], v133 offset:51200
    buffer_load_dwordx4 a[116:119], v1, s[32:35], s55 offen offset:1024 sc1
    v_mfma_f32_16x16x32_bf16 v[112:115], a[152:155], a[32:35], v[112:115]
    ds_read_b64_tr_b16 a[150:151], v133 offset:55296
    s_waitcnt vmcnt(22)
    v_mfma_f32_16x16x32_bf16 v[116:119], a[152:155], a[36:39], v[116:119]
    ds_read_b64_tr_b16 a[152:153], v134 offset:51200
    v_mfma_f32_16x16x32_bf16 v[120:123], a[156:159], a[32:35], v[120:123]
    ds_read_b64_tr_b16 a[154:155], v134 offset:55296
    s_waitcnt lgkmcnt(6)
    v_mfma_f32_16x16x32_bf16 v[124:127], a[156:159], a[36:39], v[124:127]
    ds_read_b64_tr_b16 a[156:157], v135 offset:51200
    ds_read_b64_tr_b16 a[158:159], v135 offset:55296
    v_mfma_f32_16x16x32_bf16 v[96:99], a[176:179], a[40:43], v[96:99]
    buffer_load_dwordx4 a[120:123], v1, s[32:35], s55 offen offset:2048 sc1
    buffer_load_dwordx4 a[124:127], v1, s[32:35], s55 offen offset:3072 sc1
    v_mfma_f32_16x16x32_bf16 v[100:103], a[176:179], a[44:47], v[100:103]
    ds_read_b64_tr_b16 a[176:177], v132 offset:59392
    v_mfma_f32_16x16x32_bf16 v[104:107], a[180:183], a[40:43], v[104:107]
    ds_read_b64_tr_b16 a[178:179], v132 offset:63488
    s_add_u32 s55, s55, 16384
    v_mfma_f32_16x16x32_bf16 v[108:111], a[180:183], a[44:47], v[108:111]
    ds_read_b64_tr_b16 a[180:181], v133 offset:59392
    v_mfma_f32_16x16x32_bf16 v[112:115], a[184:187], a[40:43], v[112:115]
    ds_read_b64_tr_b16 a[182:183], v133 offset:63488
    s_waitcnt vmcnt(20)
    v_mfma_f32_16x16x32_bf16 v[116:119], a[184:187], a[44:47], v[116:119]
    ds_read_b64_tr_b16 a[184:185], v134 offset:59392
    v_mfma_f32_16x16x32_bf16 v[120:123], a[188:191], a[40:43], v[120:123]
    ds_read_b64_tr_b16 a[186:187], v134 offset:63488
    s_waitcnt lgkmcnt(6)
    v_mfma_f32_16x16x32_bf16 v[124:127], a[188:191], a[44:47], v[124:127]
    ds_read_b64_tr_b16 a[188:189], v135 offset:59392
    ds_read_b64_tr_b16 a[190:191], v135 offset:63488
    v_mfma_f32_16x16x32_bf16 v[96:99], a[144:147], a[48:51], v[96:99]
    buffer_load_dwordx4 a[192:195], v1, s[32:35], s52 offen offset:0 sc1
    v_mfma_f32_16x16x32_bf16 v[100:103], a[144:147], a[52:55], v[100:103]
    v_mfma_f32_16x16x32_bf16 v[104:107], a[148:151], a[48:51], v[104:107]
    v_mfma_f32_16x16x32_bf16 v[108:111], a[148:151], a[52:55], v[108:111]
    buffer_load_dwordx4 a[196:199], v1, s[32:35], s52 offen offset:1024 sc1
    v_mfma_f32_16x16x32_bf16 v[112:115], a[152:155], a[48:51], v[112:115]
    s_waitcnt vmcnt(18)
    v_mfma_f32_16x16x32_bf16 v[116:119], a[152:155], a[52:55], v[116:119]
    v_mfma_f32_16x16x32_bf16 v[120:123], a[156:159], a[48:51], v[120:123]
    s_waitcnt lgkmcnt(0)
    v_mfma_f32_16x16x32_bf16 v[124:127], a[156:159], a[52:55], v[124:127]
    v_mfma_f32_16x16x32_bf16 v[96:99], a[176:179], a[56:59], v[96:99]
    buffer_load_dwordx4 a[200:203], v1, s[32:35], s52 offen offset:2048 sc1
    v_mfma_f32_16x16x32_bf16 v[100:103], a[176:179], a[60:63], v[100:103]
    v_mfma_f32_16x16x32_bf16 v[104:107], a[180:183], a[56:59], v[104:107]
    buffer_load_dwordx4 a[204:207], v1, s[32:35], s52 offen offset:3072 sc1
    v_mfma_f32_16x16x32_bf16 v[108:111], a[180:183], a[60:63], v[108:111]
    v_mfma_f32_16x16x32_bf16 v[112:115], a[184:187], a[56:59], v[112:115]
    s_add_u32 s52, s52, 16384
    v_mfma_f32_16x16x32_bf16 v[116:119], a[184:187], a[60:63], v[116:119]
    v_mfma_f32_16x16x32_bf16 v[120:123], a[188:191], a[56:59], v[120:123]
    s_waitcnt lgkmcnt(15)
    v_mfma_f32_16x16x32_bf16 v[124:127], a[188:191], a[60:63], v[124:127]
    v_mfma_f32_16x16x32_bf16 v[64:67], a[128:131], a[32:35], v[64:67]
    s_nop 3
    v_cvt_pk_bf16_f32 v96, v96, v97
    v_cvt_pk_bf16_f32 v97, v98, v99
    v_cvt_pk_bf16_f32 v100, v100, v101
    v_mfma_f32_16x16x32_bf16 v[68:71], a[128:131], a[36:39], v[68:71]
    ds_read_b64_tr_b16 a[128:129], v132 offset:49152
    v_cvt_pk_bf16_f32 v101, v102, v103
    v_cvt_pk_bf16_f32 v98, v104, v105
    v_mfma_f32_16x16x32_bf16 v[72:75], a[132:135], a[32:35], v[72:75]
    ds_read_b64_tr_b16 a[130:131], v132 offset:53248
    v_cvt_pk_bf16_f32 v99, v106, v107
    v_cvt_pk_bf16_f32 v102, v108, v109
    v_cvt_pk_bf16_f32 v103, v110, v111
    v_mfma_f32_16x16x32_bf16 v[76:79], a[132:135], a[36:39], v[76:79]
    ds_read_b64_tr_b16 a[132:133], v133 offset:49152
    v_permlane32_swap_b32 v96, v98
    v_permlane32_swap_b32 v97, v99
    v_mfma_f32_16x16x32_bf16 v[80:83], a[136:139], a[32:35], v[80:83]
    ds_read_b64_tr_b16 a[134:135], v133 offset:53248
    v_permlane32_swap_b32 v100, v102
    v_permlane32_swap_b32 v101, v103
    v_permlane16_swap_b32 v96, v98
    v_mfma_f32_16x16x32_bf16 v[84:87], a[136:139], a[36:39], v[84:87]
    ds_read_b64_tr_b16 a[136:137], v134 offset:49152
    v_permlane16_swap_b32 v97, v99
    v_permlane16_swap_b32 v100, v102
    v_mfma_f32_16x16x32_bf16 v[88:91], a[140:143], a[32:35], v[88:91]
    ds_read_b64_tr_b16 a[138:139], v134 offset:53248
    s_waitcnt lgkmcnt(15)
    v_permlane16_swap_b32 v101, v103
    buffer_store_dwordx4 v[96:99], v142, s[44:47], s75 offen offset:0 sc1
    v_mfma_f32_16x16x32_bf16 v[92:95], a[140:143], a[36:39], v[92:95]
    ds_read_b64_tr_b16 a[140:141], v135 offset:49152
    ds_read_b64_tr_b16 a[142:143], v135 offset:53248
    buffer_store_dwordx4 v[100:103], v142, s[44:47], s75 offen offset:2048 sc1
    v_mfma_f32_16x16x32_bf16 v[64:67], a[160:163], a[40:43], v[64:67]
    v_cvt_pk_bf16_f32 v112, v112, v113
    v_cvt_pk_bf16_f32 v113, v114, v115
    v_cvt_pk_bf16_f32 v116, v116, v117
    v_cvt_pk_bf16_f32 v117, v118, v119
    v_mfma_f32_16x16x32_bf16 v[68:71], a[160:163], a[44:47], v[68:71]
    ds_read_b64_tr_b16 a[160:161], v132 offset:57344
    v_cvt_pk_bf16_f32 v114, v120, v121
    v_cvt_pk_bf16_f32 v115, v122, v123
    v_mfma_f32_16x16x32_bf16 v[72:75], a[164:167], a[40:43], v[72:75]
    ds_read_b64_tr_b16 a[162:163], v132 offset:61440
    v_cvt_pk_bf16_f32 v118, v124, v125
    v_cvt_pk_bf16_f32 v119, v126, v127
    v_permlane32_swap_b32 v112, v114
    v_mfma_f32_16x16x32_bf16 v[76:79], a[164:167], a[44:47], v[76:79]
    ds_read_b64_tr_b16 a[164:165], v133 offset:57344
    v_permlane32_swap_b32 v113, v115
    v_permlane32_swap_b32 v116, v118
    v_mfma_f32_16x16x32_bf16 v[80:83], a[168:171], a[40:43], v[80:83]
    ds_read_b64_tr_b16 a[166:167], v133 offset:61440
    v_permlane32_swap_b32 v117, v119
    v_permlane16_swap_b32 v112, v114
    v_mfma_f32_16x16x32_bf16 v[84:87], a[168:171], a[44:47], v[84:87]
    ds_read_b64_tr_b16 a[168:169], v134 offset:57344
    v_permlane16_swap_b32 v113, v115
    v_permlane16_swap_b32 v116, v118
    v_permlane16_swap_b32 v117, v119
    v_mfma_f32_16x16x32_bf16 v[88:91], a[172:175], a[40:43], v[88:91]
    ds_read_b64_tr_b16 a[170:171], v134 offset:61440
    s_waitcnt lgkmcnt(6)
    buffer_store_dwordx4 v[112:115], v142, s[44:47], s75 offen offset:1024 sc1
    v_mfma_f32_16x16x32_bf16 v[92:95], a[172:175], a[44:47], v[92:95]
    ds_read_b64_tr_b16 a[172:173], v135 offset:57344
    ds_read_b64_tr_b16 a[174:175], v135 offset:61440
    buffer_store_dwordx4 v[116:119], v142, s[44:47], s75 offen offset:3072 sc1
    v_mfma_f32_16x16x32_bf16 v[64:67], a[128:131], a[48:51], v[64:67]
    buffer_load_dwordx4 a[208:211], v1, s[32:35], s53 offen offset:0 sc1
    buffer_load_dwordx4 a[212:215], v1, s[32:35], s53 offen offset:1024 sc1
    v_mfma_f32_16x16x32_bf16 v[68:71], a[128:131], a[52:55], v[68:71]
    ds_read_b64_tr_b16 a[128:129], v128 offset:0
    buffer_load_dwordx4 a[216:219], v1, s[32:35], s53 offen offset:2048 sc1
    v_mfma_f32_16x16x32_bf16 v[72:75], a[132:135], a[48:51], v[72:75]
    ds_read_b64_tr_b16 a[130:131], v128 offset:2048
    v_mfma_f32_16x16x32_bf16 v[76:79], a[132:135], a[52:55], v[76:79]
    ds_read_b64_tr_b16 a[132:133], v129 offset:0
    buffer_load_dwordx4 a[220:223], v1, s[32:35], s53 offen offset:3072 sc1
    v_mfma_f32_16x16x32_bf16 v[80:83], a[136:139], a[48:51], v[80:83]
    ds_read_b64_tr_b16 a[134:135], v129 offset:2048
    s_add_u32 s53, s53, 16384
    v_mfma_f32_16x16x32_bf16 v[84:87], a[136:139], a[52:55], v[84:87]
    ds_read_b64_tr_b16 a[136:137], v130 offset:0
    v_mfma_f32_16x16x32_bf16 v[88:91], a[140:143], a[48:51], v[88:91]
    ds_read_b64_tr_b16 a[138:139], v130 offset:2048
    s_waitcnt lgkmcnt(6)
    v_mfma_f32_16x16x32_bf16 v[92:95], a[140:143], a[52:55], v[92:95]
    ds_read_b64_tr_b16 a[140:141], v131 offset:0
    ds_read_b64_tr_b16 a[142:143], v131 offset:2048
    v_mfma_f32_16x16x32_bf16 v[64:67], a[160:163], a[56:59], v[64:67]
    buffer_load_dwordx4 a[224:227], v1, s[32:35], s54 offen offset:0 sc1
    buffer_load_dwordx4 a[228:231], v1, s[32:35], s54 offen offset:1024 sc1
    v_mfma_f32_16x16x32_bf16 v[68:71], a[160:163], a[60:63], v[68:71]
    ds_read_b64_tr_b16 a[160:161], v128 offset:4096
    buffer_load_dwordx4 a[232:235], v1, s[32:35], s54 offen offset:2048 sc1
    v_mfma_f32_16x16x32_bf16 v[72:75], a[164:167], a[56:59], v[72:75]
    ds_read_b64_tr_b16 a[162:163], v128 offset:6144
    buffer_load_dwordx4 a[236:239], v1, s[32:35], s54 offen offset:3072 sc1
    v_mfma_f32_16x16x32_bf16 v[76:79], a[164:167], a[60:63], v[76:79]
    ds_read_b64_tr_b16 a[164:165], v129 offset:4096
    s_add_u32 s54, s54, 16384
    v_mfma_f32_16x16x32_bf16 v[80:83], a[168:171], a[56:59], v[80:83]
    ds_read_b64_tr_b16 a[166:167], v129 offset:6144
    s_waitcnt vmcnt(30)
    v_mfma_f32_16x16x32_bf16 v[84:87], a[168:171], a[60:63], v[84:87]
    ds_read_b64_tr_b16 a[168:169], v130 offset:4096
    v_mfma_f32_16x16x32_bf16 v[88:91], a[172:175], a[56:59], v[88:91]
    ds_read_b64_tr_b16 a[170:171], v130 offset:6144
    s_waitcnt lgkmcnt(6)
    v_mfma_f32_16x16x32_bf16 v[92:95], a[172:175], a[60:63], v[92:95]
    ds_read_b64_tr_b16 a[172:173], v131 offset:4096
    ds_read_b64_tr_b16 a[174:175], v131 offset:6144
    v_mfma_f32_16x16x32_bf16 v[64:67], a[128:131], a[64:67], v[64:67]
    buffer_load_dwordx4 a[240:243], v1, s[32:35], s55 offen offset:0 sc1
    buffer_load_dwordx4 a[244:247], v1, s[32:35], s55 offen offset:1024 sc1
    v_mfma_f32_16x16x32_bf16 v[68:71], a[128:131], a[68:71], v[68:71]
    ds_read_b64_tr_b16 a[128:129], v128 offset:8192
    buffer_load_dwordx4 a[248:251], v1, s[32:35], s55 offen offset:2048 sc1
    v_mfma_f32_16x16x32_bf16 v[72:75], a[132:135], a[64:67], v[72:75]
    ds_read_b64_tr_b16 a[130:131], v128 offset:10240
    buffer_load_dwordx4 a[252:255], v1, s[32:35], s55 offen offset:3072 sc1
    v_mfma_f32_16x16x32_bf16 v[76:79], a[132:135], a[68:71], v[76:79]
    ds_read_b64_tr_b16 a[132:133], v129 offset:8192
    s_add_u32 s55, s55, 16384
    v_mfma_f32_16x16x32_bf16 v[80:83], a[136:139], a[64:67], v[80:83]
    ds_read_b64_tr_b16 a[134:135], v129 offset:10240
    s_waitcnt vmcnt(32)
    v_mfma_f32_16x16x32_bf16 v[84:87], a[136:139], a[68:71], v[84:87]
    ds_read_b64_tr_b16 a[136:137], v130 offset:8192
    v_mfma_f32_16x16x32_bf16 v[88:91], a[140:143], a[64:67], v[88:91]
    ds_read_b64_tr_b16 a[138:139], v130 offset:10240
    s_waitcnt lgkmcnt(6)
    v_mfma_f32_16x16x32_bf16 v[92:95], a[140:143], a[68:71], v[92:95]
    ds_read_b64_tr_b16 a[140:141], v131 offset:8192
    ds_read_b64_tr_b16 a[142:143], v131 offset:10240
    s_waitcnt vmcnt(12)
    s_mov_b64 exec, 1
    buffer_store_dwordx2 v[44:45], v46, s[44:47], s77 offen sc1
    s_mov_b64 exec, -1
    v_mfma_f32_16x16x32_bf16 v[64:67], a[160:163], a[72:75], v[64:67]
    v_mfma_f32_16x16x32_bf16 v[68:71], a[160:163], a[76:79], v[68:71]
    ds_read_b64_tr_b16 a[160:161], v128 offset:12288
    v_mfma_f32_16x16x32_bf16 v[72:75], a[164:167], a[72:75], v[72:75]
    ds_read_b64_tr_b16 a[162:163], v128 offset:14336
    v_mfma_f32_16x16x32_bf16 v[76:79], a[164:167], a[76:79], v[76:79]
    ds_read_b64_tr_b16 a[164:165], v129 offset:12288
    v_mfma_f32_16x16x32_bf16 v[80:83], a[168:171], a[72:75], v[80:83]
    ds_read_b64_tr_b16 a[166:167], v129 offset:14336
    s_waitcnt vmcnt(31)
    v_mfma_f32_16x16x32_bf16 v[84:87], a[168:171], a[76:79], v[84:87]
    ds_read_b64_tr_b16 a[168:169], v130 offset:12288
    v_mfma_f32_16x16x32_bf16 v[88:91], a[172:175], a[72:75], v[88:91]
    ds_read_b64_tr_b16 a[170:171], v130 offset:14336
    s_waitcnt lgkmcnt(6)
    v_mfma_f32_16x16x32_bf16 v[92:95], a[172:175], a[76:79], v[92:95]
    ds_read_b64_tr_b16 a[172:173], v131 offset:12288
    ds_read_b64_tr_b16 a[174:175], v131 offset:14336
    v_mfma_f32_16x16x32_bf16 v[64:67], a[128:131], a[80:83], v[64:67]
    v_mfma_f32_16x16x32_bf16 v[68:71], a[128:131], a[84:87], v[68:71]
    ds_read_b64_tr_b16 a[128:129], v128 offset:16384
    v_mfma_f32_16x16x32_bf16 v[72:75], a[132:135], a[80:83], v[72:75]
    ds_read_b64_tr_b16 a[130:131], v128 offset:18432
    v_mfma_f32_16x16x32_bf16 v[76:79], a[132:135], a[84:87], v[76:79]
    ds_read_b64_tr_b16 a[132:133], v129 offset:16384
    v_mfma_f32_16x16x32_bf16 v[80:83], a[136:139], a[80:83], v[80:83]
    ds_read_b64_tr_b16 a[134:135], v129 offset:18432
    s_waitcnt vmcnt(29)
    v_mfma_f32_16x16x32_bf16 v[84:87], a[136:139], a[84:87], v[84:87]
    ds_read_b64_tr_b16 a[136:137], v130 offset:16384
    v_mfma_f32_16x16x32_bf16 v[88:91], a[140:143], a[80:83], v[88:91]
    ds_read_b64_tr_b16 a[138:139], v130 offset:18432
    s_waitcnt lgkmcnt(6)
    v_mfma_f32_16x16x32_bf16 v[92:95], a[140:143], a[84:87], v[92:95]
    ds_read_b64_tr_b16 a[140:141], v131 offset:16384
    ds_read_b64_tr_b16 a[142:143], v131 offset:18432
    v_mfma_f32_16x16x32_bf16 v[64:67], a[160:163], a[88:91], v[64:67]
    v_mfma_f32_16x16x32_bf16 v[68:71], a[160:163], a[92:95], v[68:71]
    ds_read_b64_tr_b16 a[160:161], v128 offset:20480
    v_mfma_f32_16x16x32_bf16 v[72:75], a[164:167], a[88:91], v[72:75]
    ds_read_b64_tr_b16 a[162:163], v128 offset:22528
    v_mfma_f32_16x16x32_bf16 v[76:79], a[164:167], a[92:95], v[76:79]
    ds_read_b64_tr_b16 a[164:165], v129 offset:20480
    v_mfma_f32_16x16x32_bf16 v[80:83], a[168:171], a[88:91], v[80:83]
    ds_read_b64_tr_b16 a[166:167], v129 offset:22528
    s_waitcnt vmcnt(27)
    v_mfma_f32_16x16x32_bf16 v[84:87], a[168:171], a[92:95], v[84:87]
    ds_read_b64_tr_b16 a[168:169], v130 offset:20480
    v_mfma_f32_16x16x32_bf16 v[88:91], a[172:175], a[88:91], v[88:91]
    ds_read_b64_tr_b16 a[170:171], v130 offset:22528
    s_waitcnt lgkmcnt(6)
    v_mfma_f32_16x16x32_bf16 v[92:95], a[172:175], a[92:95], v[92:95]
    ds_read_b64_tr_b16 a[172:173], v131 offset:20480
    ds_read_b64_tr_b16 a[174:175], v131 offset:22528
    v_mfma_f32_16x16x32_bf16 v[64:67], a[128:131], a[96:99], v[64:67]
    v_mfma_f32_16x16x32_bf16 v[68:71], a[128:131], a[100:103], v[68:71]
    ds_read_b64_tr_b16 a[128:129], v128 offset:24576
    v_mfma_f32_16x16x32_bf16 v[72:75], a[132:135], a[96:99], v[72:75]
    ds_read_b64_tr_b16 a[130:131], v128 offset:26624
    v_mfma_f32_16x16x32_bf16 v[76:79], a[132:135], a[100:103], v[76:79]
    ds_read_b64_tr_b16 a[132:133], v129 offset:24576
    v_mfma_f32_16x16x32_bf16 v[80:83], a[136:139], a[96:99], v[80:83]
    ds_read_b64_tr_b16 a[134:135], v129 offset:26624
    s_waitcnt vmcnt(25)
    v_mfma_f32_16x16x32_bf16 v[84:87], a[136:139], a[100:103], v[84:87]
    ds_read_b64_tr_b16 a[136:137], v130 offset:24576
    v_mfma_f32_16x16x32_bf16 v[88:91], a[140:143], a[96:99], v[88:91]
    ds_read_b64_tr_b16 a[138:139], v130 offset:26624
    s_waitcnt lgkmcnt(6)
    v_mfma_f32_16x16x32_bf16 v[92:95], a[140:143], a[100:103], v[92:95]
    ds_read_b64_tr_b16 a[140:141], v131 offset:24576
    ds_read_b64_tr_b16 a[142:143], v131 offset:26624
    v_mfma_f32_16x16x32_bf16 v[64:67], a[160:163], a[104:107], v[64:67]
    v_mfma_f32_16x16x32_bf16 v[68:71], a[160:163], a[108:111], v[68:71]
    ds_read_b64_tr_b16 a[160:161], v128 offset:28672
    v_mfma_f32_16x16x32_bf16 v[72:75], a[164:167], a[104:107], v[72:75]
    ds_read_b64_tr_b16 a[162:163], v128 offset:30720
    v_mfma_f32_16x16x32_bf16 v[76:79], a[164:167], a[108:111], v[76:79]
    ds_read_b64_tr_b16 a[164:165], v129 offset:28672
    v_mfma_f32_16x16x32_bf16 v[80:83], a[168:171], a[104:107], v[80:83]
    ds_read_b64_tr_b16 a[166:167], v129 offset:30720
    s_waitcnt vmcnt(23)
    v_mfma_f32_16x16x32_bf16 v[84:87], a[168:171], a[108:111], v[84:87]
    ds_read_b64_tr_b16 a[168:169], v130 offset:28672
    v_mfma_f32_16x16x32_bf16 v[88:91], a[172:175], a[104:107], v[88:91]
    ds_read_b64_tr_b16 a[170:171], v130 offset:30720
    s_waitcnt lgkmcnt(6)
    v_mfma_f32_16x16x32_bf16 v[92:95], a[172:175], a[108:111], v[92:95]
    ds_read_b64_tr_b16 a[172:173], v131 offset:28672
    ds_read_b64_tr_b16 a[174:175], v131 offset:30720
    v_mfma_f32_16x16x32_bf16 v[64:67], a[128:131], a[112:115], v[64:67]
    v_mfma_f32_16x16x32_bf16 v[68:71], a[128:131], a[116:119], v[68:71]
    ds_read_b64_tr_b16 a[128:129], v128 offset:32768
    v_mfma_f32_16x16x32_bf16 v[72:75], a[132:135], a[112:115], v[72:75]
    ds_read_b64_tr_b16 a[130:131], v128 offset:34816
    v_mfma_f32_16x16x32_bf16 v[76:79], a[132:135], a[116:119], v[76:79]
    ds_read_b64_tr_b16 a[132:133], v129 offset:32768
    v_mfma_f32_16x16x32_bf16 v[80:83], a[136:139], a[112:115], v[80:83]
    ds_read_b64_tr_b16 a[134:135], v129 offset:34816
    s_waitcnt vmcnt(21)
    v_mfma_f32_16x16x32_bf16 v[84:87], a[136:139], a[116:119], v[84:87]
    ds_read_b64_tr_b16 a[136:137], v130 offset:32768
    v_mfma_f32_16x16x32_bf16 v[88:91], a[140:143], a[112:115], v[88:91]
    ds_read_b64_tr_b16 a[138:139], v130 offset:34816
    s_waitcnt lgkmcnt(6)
    v_mfma_f32_16x16x32_bf16 v[92:95], a[140:143], a[116:119], v[92:95]
    ds_read_b64_tr_b16 a[140:141], v131 offset:32768
    ds_read_b64_tr_b16 a[142:143], v131 offset:34816
    v_mfma_f32_16x16x32_bf16 v[64:67], a[160:163], a[120:123], v[64:67]
    v_mfma_f32_16x16x32_bf16 v[68:71], a[160:163], a[124:127], v[68:71]
    ds_read_b64_tr_b16 a[160:161], v128 offset:36864
    v_mfma_f32_16x16x32_bf16 v[72:75], a[164:167], a[120:123], v[72:75]
    ds_read_b64_tr_b16 a[162:163], v128 offset:38912
    v_mfma_f32_16x16x32_bf16 v[76:79], a[164:167], a[124:127], v[76:79]
    ds_read_b64_tr_b16 a[164:165], v129 offset:36864
    v_mfma_f32_16x16x32_bf16 v[80:83], a[168:171], a[120:123], v[80:83]
    ds_read_b64_tr_b16 a[166:167], v129 offset:38912
    s_waitcnt vmcnt(19)
    v_mfma_f32_16x16x32_bf16 v[84:87], a[168:171], a[124:127], v[84:87]
    ds_read_b64_tr_b16 a[168:169], v130 offset:36864
    v_mfma_f32_16x16x32_bf16 v[88:91], a[172:175], a[120:123], v[88:91]
    ds_read_b64_tr_b16 a[170:171], v130 offset:38912
    s_waitcnt lgkmcnt(6)
    v_mfma_f32_16x16x32_bf16 v[92:95], a[172:175], a[124:127], v[92:95]
    ds_read_b64_tr_b16 a[172:173], v131 offset:36864
    ds_read_b64_tr_b16 a[174:175], v131 offset:38912
    buffer_load_dwordx2 v[10:11], v46, s[44:47], s60 offen sc1
    v_mfma_f32_16x16x32_bf16 v[64:67], a[128:131], a[192:195], v[64:67]
    v_mfma_f32_16x16x32_bf16 v[68:71], a[128:131], a[196:199], v[68:71]
    ds_read_b64_tr_b16 a[128:129], v128 offset:40960
    v_mfma_f32_16x16x32_bf16 v[72:75], a[132:135], a[192:195], v[72:75]
    ds_read_b64_tr_b16 a[130:131], v128 offset:43008
    v_mfma_f32_16x16x32_bf16 v[76:79], a[132:135], a[196:199], v[76:79]
    ds_read_b64_tr_b16 a[132:133], v129 offset:40960
    v_mfma_f32_16x16x32_bf16 v[80:83], a[136:139], a[192:195], v[80:83]
    ds_read_b64_tr_b16 a[134:135], v129 offset:43008
    s_waitcnt vmcnt(18)
    v_mfma_f32_16x16x32_bf16 v[84:87], a[136:139], a[196:199], v[84:87]
    ds_read_b64_tr_b16 a[136:137], v130 offset:40960
    v_mfma_f32_16x16x32_bf16 v[88:91], a[140:143], a[192:195], v[88:91]
    ds_read_b64_tr_b16 a[138:139], v130 offset:43008
    s_waitcnt lgkmcnt(6)
    v_mfma_f32_16x16x32_bf16 v[92:95], a[140:143], a[196:199], v[92:95]
    ds_read_b64_tr_b16 a[140:141], v131 offset:40960
    ds_read_b64_tr_b16 a[142:143], v131 offset:43008
    v_mfma_f32_16x16x32_bf16 v[64:67], a[160:163], a[200:203], v[64:67]
    v_mfma_f32_16x16x32_bf16 v[68:71], a[160:163], a[204:207], v[68:71]
    ds_read_b64_tr_b16 a[160:161], v128 offset:45056
    v_mfma_f32_16x16x32_bf16 v[72:75], a[164:167], a[200:203], v[72:75]
    ds_read_b64_tr_b16 a[162:163], v128 offset:47104
    v_mfma_f32_16x16x32_bf16 v[76:79], a[164:167], a[204:207], v[76:79]
    ds_read_b64_tr_b16 a[164:165], v129 offset:45056
    v_mfma_f32_16x16x32_bf16 v[80:83], a[168:171], a[200:203], v[80:83]
    ds_read_b64_tr_b16 a[166:167], v129 offset:47104
    s_waitcnt vmcnt(12)
    v_mfma_f32_16x16x32_bf16 v[84:87], a[168:171], a[204:207], v[84:87]
    ds_read_b64_tr_b16 a[168:169], v130 offset:45056
    v_mfma_f32_16x16x32_bf16 v[88:91], a[172:175], a[200:203], v[88:91]
    ds_read_b64_tr_b16 a[170:171], v130 offset:47104
    s_waitcnt lgkmcnt(6)
    v_mfma_f32_16x16x32_bf16 v[92:95], a[172:175], a[204:207], v[92:95]
    ds_read_b64_tr_b16 a[172:173], v131 offset:45056
    ds_read_b64_tr_b16 a[174:175], v131 offset:47104
    v_mfma_f32_16x16x32_bf16 v[64:67], a[128:131], a[208:211], v[64:67]
    v_mfma_f32_16x16x32_bf16 v[68:71], a[128:131], a[212:215], v[68:71]
    ds_read_b64_tr_b16 a[128:129], v128 offset:49152
    v_mfma_f32_16x16x32_bf16 v[72:75], a[132:135], a[208:211], v[72:75]
    ds_read_b64_tr_b16 a[130:131], v128 offset:51200
    v_mfma_f32_16x16x32_bf16 v[76:79], a[132:135], a[212:215], v[76:79]
    ds_read_b64_tr_b16 a[132:133], v129 offset:49152
    v_mfma_f32_16x16x32_bf16 v[80:83], a[136:139], a[208:211], v[80:83]
    ds_read_b64_tr_b16 a[134:135], v129 offset:51200
    s_waitcnt vmcnt(10)
    v_mfma_f32_16x16x32_bf16 v[84:87], a[136:139], a[212:215], v[84:87]
    ds_read_b64_tr_b16 a[136:137], v130 offset:49152
    v_mfma_f32_16x16x32_bf16 v[88:91], a[140:143], a[208:211], v[88:91]
    ds_read_b64_tr_b16 a[138:139], v130 offset:51200
    s_waitcnt lgkmcnt(6)
    v_mfma_f32_16x16x32_bf16 v[92:95], a[140:143], a[212:215], v[92:95]
    ds_read_b64_tr_b16 a[140:141], v131 offset:49152
    ds_read_b64_tr_b16 a[142:143], v131 offset:51200
    s_waitcnt vmcnt(0)
    v_cmp_ne_u64 vcc, s[70:71], v[10:11]
    s_mov_b32 s95, 0x40000
    s_nop 0
    s_cmp_eq_u64 vcc, 0
    s_cbranch_scc1 L_pp_ok
L_pp_spin:
    s_sleep 1
    buffer_load_dwordx2 v[10:11], v46, s[44:47], s60 offen sc1
    s_waitcnt vmcnt(0)
    v_cmp_ne_u64 vcc, s[70:71], v[10:11]
    s_sub_u32 s95, s95, 1
    s_cmp_eq_u32 s95, 0
    s_cbranch_scc1 L_pp_ok
    s_cmp_lg_u64 vcc, 0
    s_cbranch_scc1 L_pp_spin
L_pp_ok:
    v_mfma_f32_16x16x32_bf16 v[64:67], a[160:163], a[216:219], v[64:67]
    buffer_load_dwordx4 v[224:227], v143, s[44:47], s76 offen offset:0 sc1
    buffer_load_dwordx4 v[228:231], v143, s[44:47], s76 offen offset:512 sc1
    v_mfma_f32_16x16x32_bf16 v[68:71], a[160:163], a[220:223], v[68:71]
    ds_read_b64_tr_b16 a[160:161], v128 offset:53248
    buffer_load_dwordx4 v[232:235], v143, s[44:47], s76 offen offset:2048 sc1
    v_mfma_f32_16x16x32_bf16 v[72:75], a[164:167], a[216:219], v[72:75]
    ds_read_b64_tr_b16 a[162:163], v128 offset:55296
    v_mfma_f32_16x16x32_bf16 v[76:79], a[164:167], a[220:223], v[76:79]
    ds_read_b64_tr_b16 a[164:165], v129 offset:53248
    buffer_load_dwordx4 v[236:239], v143, s[44:47], s76 offen offset:2560 sc1
    v_mfma_f32_16x16x32_bf16 v[80:83], a[168:171], a[216:219], v[80:83]
    ds_read_b64_tr_b16 a[166:167], v129 offset:55296
    s_waitcnt vmcnt(12)
    v_mfma_f32_16x16x32_bf16 v[84:87], a[168:171], a[220:223], v[84:87]
    ds_read_b64_tr_b16 a[168:169], v130 offset:53248
    v_mfma_f32_16x16x32_bf16 v[88:91], a[172:175], a[216:219], v[88:91]
    ds_read_b64_tr_b16 a[170:171], v130 offset:55296
    s_waitcnt lgkmcnt(6)
    v_mfma_f32_16x16x32_bf16 v[92:95], a[172:175], a[220:223], v[92:95]
    ds_read_b64_tr_b16 a[172:173], v131 offset:53248
    ds_read_b64_tr_b16 a[174:175], v131 offset:55296
    v_mfma_f32_16x16x32_bf16 v[64:67], a[128:131], a[224:227], v[64:67]
    s_barrier
    v_mfma_f32_16x16x32_bf16 v[68:71], a[128:131], a[228:231], v[68:71]
    ds_read_b64_tr_b16 a[128:129], v128 offset:57344
    v_mfma_f32_16x16x32_bf16 v[72:75], a[132:135], a[224:227], v[72:75]
    ds_read_b64_tr_b16 a[130:131], v128 offset:59392
    v_mfma_f32_16x16x32_bf16 v[76:79], a[132:135], a[228:231], v[76:79]
    ds_read_b64_tr_b16 a[132:133], v129 offset:57344
    v_mfma_f32_16x16x32_bf16 v[80:83], a[136:139], a[224:227], v[80:83]
    ds_read_b64_tr_b16 a[134:135], v129 offset:59392
    s_waitcnt vmcnt(10)
    v_mfma_f32_16x16x32_bf16 v[84:87], a[136:139], a[228:231], v[84:87]
    ds_read_b64_tr_b16 a[136:137], v130 offset:57344
    v_mfma_f32_16x16x32_bf16 v[88:91], a[140:143], a[224:227], v[88:91]
    ds_read_b64_tr_b16 a[138:139], v130 offset:59392
    s_waitcnt lgkmcnt(6)
    v_mfma_f32_16x16x32_bf16 v[92:95], a[140:143], a[228:231], v[92:95]
    ds_read_b64_tr_b16 a[140:141], v131 offset:57344
    ds_read_b64_tr_b16 a[142:143], v131 offset:59392
    v_mfma_f32_16x16x32_bf16 v[64:67], a[160:163], a[232:235], v[64:67]
    v_mfma_f32_16x16x32_bf16 v[68:71], a[160:163], a[236:239], v[68:71]
    ds_read_b64_tr_b16 a[160:161], v128 offset:61440
    v_mfma_f32_16x16x32_bf16 v[72:75], a[164:167], a[232:235], v[72:75]
    ds_read_b64_tr_b16 a[162:163], v128 offset:63488
    v_mfma_f32_16x16x32_bf16 v[76:79], a[164:167], a[236:239], v[76:79]
    ds_read_b64_tr_b16 a[164:165], v129 offset:61440
    v_mfma_f32_16x16x32_bf16 v[80:83], a[168:171], a[232:235], v[80:83]
    ds_read_b64_tr_b16 a[166:167], v129 offset:63488
    s_waitcnt vmcnt(8)
    v_mfma_f32_16x16x32_bf16 v[84:87], a[168:171], a[236:239], v[84:87]
    ds_read_b64_tr_b16 a[168:169], v130 offset:61440
    v_mfma_f32_16x16x32_bf16 v[88:91], a[172:175], a[232:235], v[88:91]
    ds_read_b64_tr_b16 a[170:171], v130 offset:63488
    s_waitcnt lgkmcnt(6)
    v_mfma_f32_16x16x32_bf16 v[92:95], a[172:175], a[236:239], v[92:95]
    ds_read_b64_tr_b16 a[172:173], v131 offset:61440
    ds_read_b64_tr_b16 a[174:175], v131 offset:63488
    v_mfma_f32_16x16x32_bf16 v[64:67], a[128:131], a[240:243], v[64:67]
    v_mfma_f32_16x16x32_bf16 v[68:71], a[128:131], a[244:247], v[68:71]
    v_mfma_f32_16x16x32_bf16 v[72:75], a[132:135], a[240:243], v[72:75]
    v_mfma_f32_16x16x32_bf16 v[76:79], a[132:135], a[244:247], v[76:79]
    v_mfma_f32_16x16x32_bf16 v[80:83], a[136:139], a[240:243], v[80:83]
    s_waitcnt vmcnt(6)
    v_mfma_f32_16x16x32_bf16 v[84:87], a[136:139], a[244:247], v[84:87]
    v_mfma_f32_16x16x32_bf16 v[88:91], a[140:143], a[240:243], v[88:91]
    s_waitcnt lgkmcnt(0)
    v_mfma_f32_16x16x32_bf16 v[92:95], a[140:143], a[244:247], v[92:95]
    v_mfma_f32_16x16x32_bf16 v[64:67], a[160:163], a[248:251], v[64:67]
    v_mfma_f32_16x16x32_bf16 v[68:71], a[160:163], a[252:255], v[68:71]
    v_mfma_f32_16x16x32_bf16 v[72:75], a[164:167], a[248:251], v[72:75]
    v_mfma_f32_16x16x32_bf16 v[76:79], a[164:167], a[252:255], v[76:79]
    v_mfma_f32_16x16x32_bf16 v[80:83], a[168:171], a[248:251], v[80:83]
    v_mfma_f32_16x16x32_bf16 v[84:87], a[168:171], a[252:255], v[84:87]
    v_mfma_f32_16x16x32_bf16 v[88:91], a[172:175], a[248:251], v[88:91]
    v_mfma_f32_16x16x32_bf16 v[92:95], a[172:175], a[252:255], v[92:95]
    s_nop 1
    ds_write_b128 v136, v[64:67] offset:0
    ds_write_b128 v136, v[68:71] offset:4096
    ds_write_b128 v137, v[72:75] offset:0
    ds_write_b128 v137, v[76:79] offset:4096
    ds_write_b128 v136, v[80:83] offset:128
    ds_write_b128 v136, v[84:87] offset:4224
    ds_write_b128 v137, v[88:91] offset:128
    ds_write_b128 v137, v[92:95] offset:4224
    s_waitcnt lgkmcnt(0)
    ds_read_b128 v[192:195], v138 offset:0
    ds_read_b128 v[196:199], v139 offset:0
    ds_read_b128 v[200:203], v138 offset:2048
    ds_read_b128 v[204:207], v139 offset:2048
    ds_read_b128 v[208:211], v138 offset:4096
    ds_read_b128 v[212:215], v139 offset:4096
    ds_read_b128 v[216:219], v138 offset:6144
    ds_read_b128 v[220:223], v139 offset:6144
    s_add_u32 s31, s30, 0
    s_waitcnt vmcnt(3)
    v_lshlrev_b32 v64, 16, v224
    v_and_b32 v65, 0xffff0000, v224
    v_lshlrev_b32 v66, 16, v225
    v_and_b32 v67, 0xffff0000, v225
    v_lshlrev_b32 v68, 16, v226
    v_and_b32 v69, 0xffff0000, v226
    v_lshlrev_b32 v70, 16, v227
    v_and_b32 v71, 0xffff0000, v227
    v_pk_add_f32 v[64:65], v[64:65], v[144:145]
    v_pk_add_f32 v[66:67], v[66:67], v[146:147]
    v_pk_add_f32 v[68:69], v[68:69], v[148:149]
    v_pk_add_f32 v[70:71], v[70:71], v[150:151]
    s_waitcnt lgkmcnt(6)
    v_pk_add_f32 v[192:193], v[192:193], v[64:65]
    v_pk_add_f32 v[194:195], v[194:195], v[66:67]
    v_pk_add_f32 v[196:197], v[196:197], v[68:69]
    v_pk_add_f32 v[198:199], v[198:199], v[70:71]
    v_cvt_pk_bf16_f32 v16, v192, v193
    v_cvt_pk_bf16_f32 v17, v194, v195
    v_cvt_pk_bf16_f32 v18, v196, v197
    v_cvt_pk_bf16_f32 v19, v198, v199
    buffer_store_dwordx4 v[16:19], v140, s[48:51], s31 offen sc1
    s_add_u32 s31, s30, 16384
    s_waitcnt vmcnt(3)
    v_lshlrev_b32 v72, 16, v228
    v_and_b32 v73, 0xffff0000, v228
    v_lshlrev_b32 v74, 16, v229
    v_and_b32 v75, 0xffff0000, v229
    v_lshlrev_b32 v76, 16, v230
    v_and_b32 v77, 0xffff0000, v230
    v_lshlrev_b32 v78, 16, v231
    v_and_b32 v79, 0xffff0000, v231
    v_pk_add_f32 v[72:73], v[72:73], v[152:153]
    v_pk_add_f32 v[74:75], v[74:75], v[154:155]
    v_pk_add_f32 v[76:77], v[76:77], v[156:157]
    v_pk_add_f32 v[78:79], v[78:79], v[158:159]
    s_waitcnt lgkmcnt(4)
    v_pk_add_f32 v[200:201], v[200:201], v[72:73]
    v_pk_add_f32 v[202:203], v[202:203], v[74:75]
    v_pk_add_f32 v[204:205], v[204:205], v[76:77]
    v_pk_add_f32 v[206:207], v[206:207], v[78:79]
    v_cvt_pk_bf16_f32 v20, v200, v201
    v_cvt_pk_bf16_f32 v21, v202, v203
    v_cvt_pk_bf16_f32 v22, v204, v205
    v_cvt_pk_bf16_f32 v23, v206, v207
    buffer_store_dwordx4 v[20:23], v140, s[48:51], s31 offen sc1
    s_add_u32 s31, s30, 32768
    s_waitcnt vmcnt(3)
    v_lshlrev_b32 v80, 16, v232
    v_and_b32 v81, 0xffff0000, v232
    v_lshlrev_b32 v82, 16, v233
    v_and_b32 v83, 0xffff0000, v233
    v_lshlrev_b32 v84, 16, v234
    v_and_b32 v85, 0xffff0000, v234
    v_lshlrev_b32 v86, 16, v235
    v_and_b32 v87, 0xffff0000, v235
    v_pk_add_f32 v[80:81], v[80:81], v[160:161]
    v_pk_add_f32 v[82:83], v[82:83], v[162:163]
    v_pk_add_f32 v[84:85], v[84:85], v[164:165]
    v_pk_add_f32 v[86:87], v[86:87], v[166:167]
    s_waitcnt lgkmcnt(2)
    v_pk_add_f32 v[208:209], v[208:209], v[80:81]
    v_pk_add_f32 v[210:211], v[210:211], v[82:83]
    v_pk_add_f32 v[212:213], v[212:213], v[84:85]
    v_pk_add_f32 v[214:215], v[214:215], v[86:87]
    v_cvt_pk_bf16_f32 v24, v208, v209
    v_cvt_pk_bf16_f32 v25, v210, v211
    v_cvt_pk_bf16_f32 v26, v212, v213
    v_cvt_pk_bf16_f32 v27, v214, v215
    buffer_store_dwordx4 v[24:27], v140, s[48:51], s31 offen sc1
    s_add_u32 s31, s30, 49152
    s_waitcnt vmcnt(3)
    v_lshlrev_b32 v88, 16, v236
    v_and_b32 v89, 0xffff0000, v236
    v_lshlrev_b32 v90, 16, v237
    v_and_b32 v91, 0xffff0000, v237
    v_lshlrev_b32 v92, 16, v238
    v_and_b32 v93, 0xffff0000, v238
    v_lshlrev_b32 v94, 16, v239
    v_and_b32 v95, 0xffff0000, v239
    v_pk_add_f32 v[88:89], v[88:89], v[168:169]
    v_pk_add_f32 v[90:91], v[90:91], v[170:171]
    v_pk_add_f32 v[92:93], v[92:93], v[172:173]
    v_pk_add_f32 v[94:95], v[94:95], v[174:175]
    s_waitcnt lgkmcnt(0)
    v_pk_add_f32 v[216:217], v[216:217], v[88:89]
    v_pk_add_f32 v[218:219], v[218:219], v[90:91]
    v_pk_add_f32 v[220:221], v[220:221], v[92:93]
    v_pk_add_f32 v[222:223], v[222:223], v[94:95]
    v_cvt_pk_bf16_f32 v28, v216, v217
    v_cvt_pk_bf16_f32 v29, v218, v219
    v_cvt_pk_bf16_f32 v30, v220, v221
    v_cvt_pk_bf16_f32 v31, v222, v223
    buffer_store_dwordx4 v[28:31], v140, s[48:51], s31 offen sc1
L_end:
    s_endpgm
.section .rodata,"a"
.p2align 6
.amdhsa_kernel parallel_sum__sliding_block__dense_activation_gelu__prompt_kernel
  .amdhsa_next_free_vgpr 512
  .amdhsa_next_free_sgpr 102
  .amdhsa_accum_offset 256
  .amdhsa_group_segment_fixed_size 0
  .amdhsa_kernarg_size 88
  .amdhsa_user_sgpr_count 2
  .amdhsa_user_sgpr_kernarg_segment_ptr 1
  .amdhsa_system_sgpr_workgroup_id_x 1
.end_amdhsa_kernel
```
